```python
import torch

def _softmax(x, axis=-1):
    return torch.softmax(x, dim=axis)

def _gelu(x):
    return torch.nn.functional.gelu(x, approximate='tanh')

def _silu(x):
    return torch.nn.functional.silu(x)

def _sigmoid(x):
    return torch.sigmoid(x)

def _layernorm(x, axis=-1, eps=1e-05):
    m = x.mean(dim=axis, keepdim=True)
    v = x.var(dim=axis, keepdim=True, unbiased=False)
    return (x - m) / torch.sqrt(v + eps)

def _scatter_add(tgt, idx, src, axis=0):
    return tgt.clone().index_add_(axis, idx, src)

def _segment_sum(src, seg, n):
    out = torch.zeros((n,) + src.shape[1:], dtype=src.dtype)
    return out.index_add_(0, seg, src)

def _pad(x, pw):
    flat = tuple((v for pair in reversed(pw) for v in pair))
    return torch.nn.functional.pad(x, flat)
kernel_name = 'sequential_preLN__memory_aug_recurrent_mem_tr__dense_activation_squared_relu__prompt'

def setup_inputs():

    _w = lambda a: (lambda t: t.to(torch.bfloat16) if t.is_floating_point() else t)(torch.as_tensor(a))

    def _A_setup():
        B, S, Dm = (1, 2048, 448)
        H, Dh = (16, 256)
        M, seg = (8, 32)
        seg = min(seg, S)
        S = S // seg * seg
        return {'x': _w((lambda *s: torch.randn(*s, dtype=torch.bfloat16) * 0.05)(B, S, Dm)), 'mem0': _w((lambda *s: torch.randn(*s, dtype=torch.bfloat16) * 0.2)(B, M, Dm)), 'Wq': _w((lambda *s: torch.randn(*s, dtype=torch.bfloat16) * 1.6)(Dm, H, Dh) * Dm ** (-0.5)), 'Wk': _w((lambda *s: torch.randn(*s, dtype=torch.bfloat16) * 1.6)(Dm, H, Dh) * Dm ** (-0.5)), 'Wv': _w((lambda *s: torch.randn(*s, dtype=torch.bfloat16) * 0.2)(Dm, H, Dh) * Dm ** (-0.5)), 'Wo': _w((lambda *s: torch.randn(*s, dtype=torch.bfloat16) * 0.2)(H, Dh, Dm) * (H * Dh) ** (-0.5)), 'seg_len': seg}
    _A_in = _A_setup()

    def _B_setup():
        B, S, D, F = (1, 2048, 448, 1792)
        return {'x': _w((lambda *s: torch.randn(*s, dtype=torch.bfloat16) * 0.05)(B, S, D)), 'w1': _w((lambda *s: torch.randn(*s, dtype=torch.bfloat16) * 0.05)(D, F)), 'b1': _w((lambda *s: torch.randn(*s, dtype=torch.bfloat16) * 0.2)(F)), 'w2': _w((lambda *s: torch.randn(*s, dtype=torch.bfloat16) * 0.05)(F, D)), 'b2': _w((lambda *s: torch.randn(*s, dtype=torch.bfloat16) * 0.8)(D))}
    _B_in = _B_setup()
    return {'A_x': _A_in['x'], 'A_mem0': _A_in['mem0'], 'A_Wq': _A_in['Wq'], 'A_Wk': _A_in['Wk'], 'A_Wv': _A_in['Wv'], 'A_Wo': _A_in['Wo'], 'A_seg_len': _A_in['seg_len'], 'B_x': _B_in['x'], 'B_w1': _B_in['w1'], 'B_b1': _B_in['b1'], 'B_w2': _B_in['w2'], 'B_b2': _B_in['b2']}

def reference(A_x, A_mem0, A_Wq, A_Wk, A_Wv, A_Wo, A_seg_len, B_x, B_w1, B_b1, B_w2, B_b2):

    def _A_ref(x, mem0, Wq, Wk, Wv, Wo, seg_len):
        B, S, Dm = x.shape
        H, Dh = (Wq.shape[1], Wq.shape[2])
        M = mem0.shape[1]
        scale = Dh ** (-0.5)
        n_seg = S // seg_len
        L = M + seg_len
        idx = torch.arange(L)
        mask = (idx[:, None] < M) | (idx[:, None] >= idx[None, :])
        mem = mem0
        outs = []
        for s in range(n_seg):
            xs = x[:, s * seg_len:(s + 1) * seg_len, :].clone()
            h = torch.concatenate([mem, xs], axis=1)
            q = torch.einsum('btd,dhe->bhte', h, Wq)
            k = torch.einsum('btd,dhe->bhte', h, Wk)
            v = torch.einsum('btd,dhe->bhte', h, Wv)
            scores = torch.einsum('bhqe,bhke->bhqk', q, k) * scale
            scores = torch.where(mask[None, None], scores, -1000000000.0)
            p = _softmax(scores, axis=-1)
            o = torch.einsum('bhqk,bhke->bhqe', p, v)
            o = torch.einsum('bhte,hed->btd', o, Wo)
            mem = o[:, :M, :].clone()
            outs.append(o[:, M:, :])
        return torch.concatenate(outs, axis=1)

    def _B_ref(x, w1, b1, w2, b2):
        h = torch.einsum('bsd,df->bsf', x, w1) + b1
        zero = torch.zeros_like(h)
        r = torch.where(h > zero, h, zero)
        h = r * r
        out = torch.einsum('bsf,fd->bsd', h, w2) + b2
        return out
    x = A_x
    h = x + _A_ref(_layernorm(x, axis=-1), A_mem0, A_Wq, A_Wk, A_Wv, A_Wo, A_seg_len)
    h2 = h + _B_ref(_layernorm(h, axis=-1), B_w1, B_b1, B_w2, B_b2)
    return h2
```

```asm
; @launch kernel=prep_kernel grid=(400,1,1) block=(256,1,1) lds=66560
; @launch kernel=mega_kernel grid=(256,1,1) block=(256,1,1) lds=163840
.amdgcn_target "amdgcn-amd-amdhsa--gfx950"
.text
.globl prep_kernel
.p2align 8
.type prep_kernel,@function
prep_kernel:
    s_cmp_ge_u32 s2, 400
    s_cbranch_scc1 PREP_EXIT
    s_load_dwordx2 s[4:5], s[0:1], 112
    v_lshrrev_b32 v1, 6, v0
    s_nop 0
    v_readfirstlane_b32 s18, v1
    v_and_b32 v1, 63, v0
    s_waitcnt lgkmcnt(0)
    s_mov_b32 s8, s4
    s_and_b32 s9, s5, 0xffff
    s_mov_b32 s10, 0x10000000
    s_mov_b32 s11, 0x00020000
    s_cmp_ge_u32 s2, 384
    s_cbranch_scc1 PREP_S
    s_cmp_ge_u32 s2, 256
    s_cbranch_scc1 PREP_LN
PREP_W:
    s_sub_u32 s20, s2, 0
    s_and_b32 s25, s20, 7
    s_lshr_b32 s26, s20, 3
    s_lshr_b32 s27, s26, 3
    s_lshl_b32 s27, s27, 3
    s_add_u32 s27, s27, s25
    s_lshr_b32 s21, s27, 4
    s_and_b32 s22, s27, 15
    s_and_b32 s26, s26, 7
    s_lshr_b32 s23, s26, 1
    s_and_b32 s24, s26, 1
    s_load_dwordx2 s[16:17], s[0:1], 16
    s_load_dwordx2 s[28:29], s[0:1], 24
    s_load_dwordx2 s[30:31], s[0:1], 32
    s_load_dwordx2 s[32:33], s[0:1], 40
    v_and_b32 v5, 15, v1
    v_lshrrev_b32 v6, 4, v1
    v_lshlrev_b32 v2, 4, v1
    v_lshrrev_b32 v7, 3, v5
    v_lshlrev_b32 v7, 4, v7
    v_lshrrev_b32 v8, 2, v5
    v_and_b32 v8, 1, v8
    v_lshl_add_u32 v7, v8, 2, v7
    v_and_b32 v8, 1, v5
    v_add_u32 v7, v7, v8
    v_lshrrev_b32 v8, 1, v5
    v_and_b32 v8, 1, v8
    v_lshl_add_u32 v7, v8, 3, v7
    v_lshlrev_b32 v7, 13, v7
    v_lshl_add_u32 v7, v6, 4, v7
    s_waitcnt lgkmcnt(0)
    s_cmp_eq_u32 s21, 0
    s_cselect_b32 s16, s16, s30
    s_cselect_b32 s17, s17, s31
    s_cselect_b32 s28, s28, s32
    s_cselect_b32 s29, s29, s33
    s_mov_b32 s12, s16
    s_and_b32 s13, s17, 0xffff
    s_mov_b32 s14, 3670016
    s_mov_b32 s15, 0x00020000
    s_mov_b32 s36, s28
    s_and_b32 s37, s29, 0xffff
    s_mov_b32 s38, 3670016
    s_mov_b32 s39, 0x00020000
    s_mul_i32 s25, s24, 7
    s_add_u32 s25, s25, s18
    s_add_u32 s34, s25, 4
    s_min_u32 s34, s34, 13
    s_lshl_b32 s26, s25, 18
    s_lshl_b32 s27, s22, 9
    s_add_u32 s26, s26, s27
    s_add_u32 s27, s26, 16384
    buffer_load_dwordx4 v[16:19], v7, s[12:15], s26 offen offset:0
    buffer_load_dwordx4 v[20:23], v7, s[12:15], s26 offen offset:64
    buffer_load_dwordx4 v[24:27], v7, s[12:15], s26 offen offset:128
    buffer_load_dwordx4 v[28:31], v7, s[12:15], s26 offen offset:192
    buffer_load_dwordx4 v[32:35], v7, s[12:15], s26 offen offset:256
    buffer_load_dwordx4 v[36:39], v7, s[12:15], s26 offen offset:320
    buffer_load_dwordx4 v[40:43], v7, s[12:15], s26 offen offset:384
    buffer_load_dwordx4 v[44:47], v7, s[12:15], s26 offen offset:448
    buffer_load_dwordx4 v[48:51], v7, s[12:15], s27 offen offset:0
    buffer_load_dwordx4 v[52:55], v7, s[12:15], s27 offen offset:64
    buffer_load_dwordx4 v[56:59], v7, s[12:15], s27 offen offset:128
    buffer_load_dwordx4 v[60:63], v7, s[12:15], s27 offen offset:192
    buffer_load_dwordx4 v[64:67], v7, s[12:15], s27 offen offset:256
    buffer_load_dwordx4 v[68:71], v7, s[12:15], s27 offen offset:320
    buffer_load_dwordx4 v[72:75], v7, s[12:15], s27 offen offset:384
    buffer_load_dwordx4 v[76:79], v7, s[12:15], s27 offen offset:448
    s_lshl_b32 s26, s34, 18
    s_lshl_b32 s27, s22, 9
    s_add_u32 s26, s26, s27
    s_add_u32 s27, s26, 16384
    buffer_load_dwordx4 v[80:83], v7, s[12:15], s26 offen offset:0
    buffer_load_dwordx4 v[84:87], v7, s[12:15], s26 offen offset:64
    buffer_load_dwordx4 v[88:91], v7, s[12:15], s26 offen offset:128
    buffer_load_dwordx4 v[92:95], v7, s[12:15], s26 offen offset:192
    buffer_load_dwordx4 v[96:99], v7, s[12:15], s26 offen offset:256
    buffer_load_dwordx4 v[100:103], v7, s[12:15], s26 offen offset:320
    buffer_load_dwordx4 v[104:107], v7, s[12:15], s26 offen offset:384
    buffer_load_dwordx4 v[108:111], v7, s[12:15], s26 offen offset:448
    buffer_load_dwordx4 v[112:115], v7, s[12:15], s27 offen offset:0
    buffer_load_dwordx4 v[116:119], v7, s[12:15], s27 offen offset:64
    buffer_load_dwordx4 v[120:123], v7, s[12:15], s27 offen offset:128
    buffer_load_dwordx4 v[124:127], v7, s[12:15], s27 offen offset:192
    buffer_load_dwordx4 v[128:131], v7, s[12:15], s27 offen offset:256
    buffer_load_dwordx4 v[132:135], v7, s[12:15], s27 offen offset:320
    buffer_load_dwordx4 v[136:139], v7, s[12:15], s27 offen offset:384
    buffer_load_dwordx4 v[140:143], v7, s[12:15], s27 offen offset:448
    s_cmp_eq_u32 s21, 0
    s_cbranch_scc0 PW_BC
    v_lshlrev_b32 v9, 13, v5
    v_lshl_add_u32 v9, v6, 4, v9
    s_mul_i32 s35, s23, 917504
    s_lshl_b32 s26, s22, 9
    s_add_u32 s35, s35, s26
    s_mul_i32 s40, s18, 14
    s_add_u32 s41, s40, 0
    s_lshr_b32 s42, s41, 3
    s_lshl_b32 s42, s42, 17
    s_and_b32 s43, s41, 7
    s_lshl_b32 s43, s43, 6
    s_add_u32 s42, s42, s43
    s_add_u32 s42, s42, s35
    s_lshl_b32 m0, s41, 10
    s_nop 0
    buffer_load_dwordx4 v9, s[36:39], s42 offen lds
    s_add_u32 s41, s40, 1
    s_lshr_b32 s42, s41, 3
    s_lshl_b32 s42, s42, 17
    s_and_b32 s43, s41, 7
    s_lshl_b32 s43, s43, 6
    s_add_u32 s42, s42, s43
    s_add_u32 s42, s42, s35
    s_lshl_b32 m0, s41, 10
    s_nop 0
    buffer_load_dwordx4 v9, s[36:39], s42 offen lds
    s_add_u32 s41, s40, 2
    s_lshr_b32 s42, s41, 3
    s_lshl_b32 s42, s42, 17
    s_and_b32 s43, s41, 7
    s_lshl_b32 s43, s43, 6
    s_add_u32 s42, s42, s43
    s_add_u32 s42, s42, s35
    s_lshl_b32 m0, s41, 10
    s_nop 0
    buffer_load_dwordx4 v9, s[36:39], s42 offen lds
    s_add_u32 s41, s40, 3
    s_lshr_b32 s42, s41, 3
    s_lshl_b32 s42, s42, 17
    s_and_b32 s43, s41, 7
    s_lshl_b32 s43, s43, 6
    s_add_u32 s42, s42, s43
    s_add_u32 s42, s42, s35
    s_lshl_b32 m0, s41, 10
    s_nop 0
    buffer_load_dwordx4 v9, s[36:39], s42 offen lds
    s_add_u32 s41, s40, 4
    s_lshr_b32 s42, s41, 3
    s_lshl_b32 s42, s42, 17
    s_and_b32 s43, s41, 7
    s_lshl_b32 s43, s43, 6
    s_add_u32 s42, s42, s43
    s_add_u32 s42, s42, s35
    s_lshl_b32 m0, s41, 10
    s_nop 0
    buffer_load_dwordx4 v9, s[36:39], s42 offen lds
    s_add_u32 s41, s40, 5
    s_lshr_b32 s42, s41, 3
    s_lshl_b32 s42, s42, 17
    s_and_b32 s43, s41, 7
    s_lshl_b32 s43, s43, 6
    s_add_u32 s42, s42, s43
    s_add_u32 s42, s42, s35
    s_lshl_b32 m0, s41, 10
    s_nop 0
    buffer_load_dwordx4 v9, s[36:39], s42 offen lds
    s_add_u32 s41, s40, 6
    s_lshr_b32 s42, s41, 3
    s_lshl_b32 s42, s42, 17
    s_and_b32 s43, s41, 7
    s_lshl_b32 s43, s43, 6
    s_add_u32 s42, s42, s43
    s_add_u32 s42, s42, s35
    s_lshl_b32 m0, s41, 10
    s_nop 0
    buffer_load_dwordx4 v9, s[36:39], s42 offen lds
    s_add_u32 s41, s40, 7
    s_lshr_b32 s42, s41, 3
    s_lshl_b32 s42, s42, 17
    s_and_b32 s43, s41, 7
    s_lshl_b32 s43, s43, 6
    s_add_u32 s42, s42, s43
    s_add_u32 s42, s42, s35
    s_lshl_b32 m0, s41, 10
    s_nop 0
    buffer_load_dwordx4 v9, s[36:39], s42 offen lds
    s_add_u32 s41, s40, 8
    s_lshr_b32 s42, s41, 3
    s_lshl_b32 s42, s42, 17
    s_and_b32 s43, s41, 7
    s_lshl_b32 s43, s43, 6
    s_add_u32 s42, s42, s43
    s_add_u32 s42, s42, s35
    s_lshl_b32 m0, s41, 10
    s_nop 0
    buffer_load_dwordx4 v9, s[36:39], s42 offen lds
    s_add_u32 s41, s40, 9
    s_lshr_b32 s42, s41, 3
    s_lshl_b32 s42, s42, 17
    s_and_b32 s43, s41, 7
    s_lshl_b32 s43, s43, 6
    s_add_u32 s42, s42, s43
    s_add_u32 s42, s42, s35
    s_lshl_b32 m0, s41, 10
    s_nop 0
    buffer_load_dwordx4 v9, s[36:39], s42 offen lds
    s_add_u32 s41, s40, 10
    s_lshr_b32 s42, s41, 3
    s_lshl_b32 s42, s42, 17
    s_and_b32 s43, s41, 7
    s_lshl_b32 s43, s43, 6
    s_add_u32 s42, s42, s43
    s_add_u32 s42, s42, s35
    s_lshl_b32 m0, s41, 10
    s_nop 0
    buffer_load_dwordx4 v9, s[36:39], s42 offen lds
    s_add_u32 s41, s40, 11
    s_lshr_b32 s42, s41, 3
    s_lshl_b32 s42, s42, 17
    s_and_b32 s43, s41, 7
    s_lshl_b32 s43, s43, 6
    s_add_u32 s42, s42, s43
    s_add_u32 s42, s42, s35
    s_lshl_b32 m0, s41, 10
    s_nop 0
    buffer_load_dwordx4 v9, s[36:39], s42 offen lds
    s_add_u32 s41, s40, 12
    s_lshr_b32 s42, s41, 3
    s_lshl_b32 s42, s42, 17
    s_and_b32 s43, s41, 7
    s_lshl_b32 s43, s43, 6
    s_add_u32 s42, s42, s43
    s_add_u32 s42, s42, s35
    s_lshl_b32 m0, s41, 10
    s_nop 0
    buffer_load_dwordx4 v9, s[36:39], s42 offen lds
    s_add_u32 s41, s40, 13
    s_lshr_b32 s42, s41, 3
    s_lshl_b32 s42, s42, 17
    s_and_b32 s43, s41, 7
    s_lshl_b32 s43, s43, 6
    s_add_u32 s42, s42, s43
    s_add_u32 s42, s42, s35
    s_lshl_b32 m0, s41, 10
    s_nop 0
    buffer_load_dwordx4 v9, s[36:39], s42 offen lds
    s_waitcnt vmcnt(0)
    s_barrier
    s_branch PW_GA
PW_BC:
    s_lshl_b32 s35, s18, 6
    v_add_u32 v9, s35, v1
    v_mul_u32_u24 v10, 896, v9
    v_mul_u32_u24 v11, 224, v9
    s_mul_i32 s35, s22, 229376
    s_mul_i32 s26, s23, 224
    s_add_u32 s35, s35, s26
    buffer_load_dwordx4 v[144:147], v10, s[36:39], s35 offen offset:0
    buffer_load_dwordx4 v[148:151], v10, s[36:39], s35 offen offset:16
    buffer_load_dwordx4 v[152:155], v10, s[36:39], s35 offen offset:32
    buffer_load_dwordx4 v[156:159], v10, s[36:39], s35 offen offset:48
    buffer_load_dwordx4 v[160:163], v10, s[36:39], s35 offen offset:64
    buffer_load_dwordx4 v[164:167], v10, s[36:39], s35 offen offset:80
    buffer_load_dwordx4 v[168:171], v10, s[36:39], s35 offen offset:96
    buffer_load_dwordx4 v[172:175], v10, s[36:39], s35 offen offset:112
    buffer_load_dwordx4 v[176:179], v10, s[36:39], s35 offen offset:128
    buffer_load_dwordx4 v[180:183], v10, s[36:39], s35 offen offset:144
    buffer_load_dwordx4 v[184:187], v10, s[36:39], s35 offen offset:160
    buffer_load_dwordx4 v[188:191], v10, s[36:39], s35 offen offset:176
    buffer_load_dwordx4 v[192:195], v10, s[36:39], s35 offen offset:192
    buffer_load_dwordx4 v[196:199], v10, s[36:39], s35 offen offset:208
    s_waitcnt vmcnt(13)
    ds_write_b128 v11, v[144:147] offset:0
    s_waitcnt vmcnt(12)
    ds_write_b128 v11, v[148:151] offset:16
    s_waitcnt vmcnt(11)
    ds_write_b128 v11, v[152:155] offset:32
    s_waitcnt vmcnt(10)
    ds_write_b128 v11, v[156:159] offset:48
    s_waitcnt vmcnt(9)
    ds_write_b128 v11, v[160:163] offset:64
    s_waitcnt vmcnt(8)
    ds_write_b128 v11, v[164:167] offset:80
    s_waitcnt vmcnt(7)
    ds_write_b128 v11, v[168:171] offset:96
    s_waitcnt vmcnt(6)
    ds_write_b128 v11, v[172:175] offset:112
    s_waitcnt vmcnt(5)
    ds_write_b128 v11, v[176:179] offset:128
    s_waitcnt vmcnt(4)
    ds_write_b128 v11, v[180:183] offset:144
    s_waitcnt vmcnt(3)
    ds_write_b128 v11, v[184:187] offset:160
    s_waitcnt vmcnt(2)
    ds_write_b128 v11, v[188:191] offset:176
    s_waitcnt vmcnt(1)
    ds_write_b128 v11, v[192:195] offset:192
    s_waitcnt vmcnt(0)
    ds_write_b128 v11, v[196:199] offset:208
    s_waitcnt lgkmcnt(0)
    s_barrier
    v_lshrrev_b32 v9, 2, v5
    v_lshl_add_u32 v9, v6, 3, v9
    v_mul_u32_u24 v9, 224, v9
    v_and_b32 v8, 3, v1
    v_lshl_add_u32 v9, v8, 3, v9
    s_waitcnt vmcnt(0)
    v_mov_b32 v144, 0
    v_mov_b32 v145, 0
    v_mov_b32 v146, 0
    v_mov_b32 v147, 0
    v_mov_b32 v148, 0
    v_mov_b32 v149, 0
    v_mov_b32 v150, 0
    v_mov_b32 v151, 0
    v_mov_b32 v152, 0
    v_mov_b32 v153, 0
    v_mov_b32 v154, 0
    v_mov_b32 v155, 0
    v_mov_b32 v156, 0
    v_mov_b32 v157, 0
    v_mov_b32 v158, 0
    v_mov_b32 v159, 0
    v_mov_b32 v160, 0
    v_mov_b32 v161, 0
    v_mov_b32 v162, 0
    v_mov_b32 v163, 0
    v_mov_b32 v164, 0
    v_mov_b32 v165, 0
    v_mov_b32 v166, 0
    v_mov_b32 v167, 0
    v_mov_b32 v168, 0
    v_mov_b32 v169, 0
    v_mov_b32 v170, 0
    v_mov_b32 v171, 0
    v_mov_b32 v172, 0
    v_mov_b32 v173, 0
    v_mov_b32 v174, 0
    v_mov_b32 v175, 0
    v_mov_b32 v176, 0
    v_mov_b32 v177, 0
    v_mov_b32 v178, 0
    v_mov_b32 v179, 0
    v_mov_b32 v180, 0
    v_mov_b32 v181, 0
    v_mov_b32 v182, 0
    v_mov_b32 v183, 0
    v_mov_b32 v184, 0
    v_mov_b32 v185, 0
    v_mov_b32 v186, 0
    v_mov_b32 v187, 0
    v_mov_b32 v188, 0
    v_mov_b32 v189, 0
    v_mov_b32 v190, 0
    v_mov_b32 v191, 0
    v_mov_b32 v192, 0
    v_mov_b32 v193, 0
    v_mov_b32 v194, 0
    v_mov_b32 v195, 0
    v_mov_b32 v196, 0
    v_mov_b32 v197, 0
    v_mov_b32 v198, 0
    v_mov_b32 v199, 0
    ds_read_b64_tr_b16 v[200:201], v9 offset:0
    ds_read_b64_tr_b16 v[202:203], v9 offset:896
    ds_read_b64_tr_b16 v[204:205], v9 offset:32
    ds_read_b64_tr_b16 v[206:207], v9 offset:928
    ds_read_b64_tr_b16 v[208:209], v9 offset:64
    ds_read_b64_tr_b16 v[210:211], v9 offset:960
    ds_read_b64_tr_b16 v[212:213], v9 offset:96
    ds_read_b64_tr_b16 v[214:215], v9 offset:992
    ds_read_b64_tr_b16 v[216:217], v9 offset:128
    ds_read_b64_tr_b16 v[218:219], v9 offset:1024
    ds_read_b64_tr_b16 v[220:221], v9 offset:160
    ds_read_b64_tr_b16 v[222:223], v9 offset:1056
    ds_read_b64_tr_b16 v[224:225], v9 offset:192
    ds_read_b64_tr_b16 v[226:227], v9 offset:1088
    s_waitcnt lgkmcnt(12)
    v_mfma_f32_16x16x32_bf16 v[144:147], v[16:19], v[200:203], v[144:147]
    v_mfma_f32_16x16x32_bf16 v[172:175], v[48:51], v[200:203], v[172:175]
    ds_read_b64_tr_b16 v[228:229], v9 offset:7168
    ds_read_b64_tr_b16 v[230:231], v9 offset:8064
    s_waitcnt lgkmcnt(12)
    v_mfma_f32_16x16x32_bf16 v[148:151], v[16:19], v[204:207], v[148:151]
    v_mfma_f32_16x16x32_bf16 v[176:179], v[48:51], v[204:207], v[176:179]
    ds_read_b64_tr_b16 v[200:201], v9 offset:7200
    ds_read_b64_tr_b16 v[202:203], v9 offset:8096
    s_waitcnt lgkmcnt(12)
    v_mfma_f32_16x16x32_bf16 v[152:155], v[16:19], v[208:211], v[152:155]
    v_mfma_f32_16x16x32_bf16 v[180:183], v[48:51], v[208:211], v[180:183]
    ds_read_b64_tr_b16 v[204:205], v9 offset:7232
    ds_read_b64_tr_b16 v[206:207], v9 offset:8128
    s_waitcnt lgkmcnt(12)
    v_mfma_f32_16x16x32_bf16 v[156:159], v[16:19], v[212:215], v[156:159]
    v_mfma_f32_16x16x32_bf16 v[184:187], v[48:51], v[212:215], v[184:187]
    ds_read_b64_tr_b16 v[208:209], v9 offset:7264
    ds_read_b64_tr_b16 v[210:211], v9 offset:8160
    s_waitcnt lgkmcnt(12)
    v_mfma_f32_16x16x32_bf16 v[160:163], v[16:19], v[216:219], v[160:163]
    v_mfma_f32_16x16x32_bf16 v[188:191], v[48:51], v[216:219], v[188:191]
    ds_read_b64_tr_b16 v[212:213], v9 offset:7296
    ds_read_b64_tr_b16 v[214:215], v9 offset:8192
    s_waitcnt lgkmcnt(12)
    v_mfma_f32_16x16x32_bf16 v[164:167], v[16:19], v[220:223], v[164:167]
    v_mfma_f32_16x16x32_bf16 v[192:195], v[48:51], v[220:223], v[192:195]
    ds_read_b64_tr_b16 v[216:217], v9 offset:7328
    ds_read_b64_tr_b16 v[218:219], v9 offset:8224
    s_waitcnt lgkmcnt(12)
    v_mfma_f32_16x16x32_bf16 v[168:171], v[16:19], v[224:227], v[168:171]
    v_mfma_f32_16x16x32_bf16 v[196:199], v[48:51], v[224:227], v[196:199]
    ds_read_b64_tr_b16 v[220:221], v9 offset:7360
    ds_read_b64_tr_b16 v[222:223], v9 offset:8256
    s_waitcnt lgkmcnt(12)
    v_mfma_f32_16x16x32_bf16 v[144:147], v[20:23], v[228:231], v[144:147]
    v_mfma_f32_16x16x32_bf16 v[172:175], v[52:55], v[228:231], v[172:175]
    ds_read_b64_tr_b16 v[224:225], v9 offset:14336
    ds_read_b64_tr_b16 v[226:227], v9 offset:15232
    s_waitcnt lgkmcnt(12)
    v_mfma_f32_16x16x32_bf16 v[148:151], v[20:23], v[200:203], v[148:151]
    v_mfma_f32_16x16x32_bf16 v[176:179], v[52:55], v[200:203], v[176:179]
    ds_read_b64_tr_b16 v[228:229], v9 offset:14368
    ds_read_b64_tr_b16 v[230:231], v9 offset:15264
    s_waitcnt lgkmcnt(12)
    v_mfma_f32_16x16x32_bf16 v[152:155], v[20:23], v[204:207], v[152:155]
    v_mfma_f32_16x16x32_bf16 v[180:183], v[52:55], v[204:207], v[180:183]
    ds_read_b64_tr_b16 v[200:201], v9 offset:14400
    ds_read_b64_tr_b16 v[202:203], v9 offset:15296
    s_waitcnt lgkmcnt(12)
    v_mfma_f32_16x16x32_bf16 v[156:159], v[20:23], v[208:211], v[156:159]
    v_mfma_f32_16x16x32_bf16 v[184:187], v[52:55], v[208:211], v[184:187]
    ds_read_b64_tr_b16 v[204:205], v9 offset:14432
    ds_read_b64_tr_b16 v[206:207], v9 offset:15328
    s_waitcnt lgkmcnt(12)
    v_mfma_f32_16x16x32_bf16 v[160:163], v[20:23], v[212:215], v[160:163]
    v_mfma_f32_16x16x32_bf16 v[188:191], v[52:55], v[212:215], v[188:191]
    ds_read_b64_tr_b16 v[208:209], v9 offset:14464
    ds_read_b64_tr_b16 v[210:211], v9 offset:15360
    s_waitcnt lgkmcnt(12)
    v_mfma_f32_16x16x32_bf16 v[164:167], v[20:23], v[216:219], v[164:167]
    v_mfma_f32_16x16x32_bf16 v[192:195], v[52:55], v[216:219], v[192:195]
    ds_read_b64_tr_b16 v[212:213], v9 offset:14496
    ds_read_b64_tr_b16 v[214:215], v9 offset:15392
    s_waitcnt lgkmcnt(12)
    v_mfma_f32_16x16x32_bf16 v[168:171], v[20:23], v[220:223], v[168:171]
    v_mfma_f32_16x16x32_bf16 v[196:199], v[52:55], v[220:223], v[196:199]
    ds_read_b64_tr_b16 v[216:217], v9 offset:14528
    ds_read_b64_tr_b16 v[218:219], v9 offset:15424
    s_waitcnt lgkmcnt(12)
    v_mfma_f32_16x16x32_bf16 v[144:147], v[24:27], v[224:227], v[144:147]
    v_mfma_f32_16x16x32_bf16 v[172:175], v[56:59], v[224:227], v[172:175]
    ds_read_b64_tr_b16 v[220:221], v9 offset:21504
    ds_read_b64_tr_b16 v[222:223], v9 offset:22400
    s_waitcnt lgkmcnt(12)
    v_mfma_f32_16x16x32_bf16 v[148:151], v[24:27], v[228:231], v[148:151]
    v_mfma_f32_16x16x32_bf16 v[176:179], v[56:59], v[228:231], v[176:179]
    ds_read_b64_tr_b16 v[224:225], v9 offset:21536
    ds_read_b64_tr_b16 v[226:227], v9 offset:22432
    s_waitcnt lgkmcnt(12)
    v_mfma_f32_16x16x32_bf16 v[152:155], v[24:27], v[200:203], v[152:155]
    v_mfma_f32_16x16x32_bf16 v[180:183], v[56:59], v[200:203], v[180:183]
    ds_read_b64_tr_b16 v[228:229], v9 offset:21568
    ds_read_b64_tr_b16 v[230:231], v9 offset:22464
    s_waitcnt lgkmcnt(12)
    v_mfma_f32_16x16x32_bf16 v[156:159], v[24:27], v[204:207], v[156:159]
    v_mfma_f32_16x16x32_bf16 v[184:187], v[56:59], v[204:207], v[184:187]
    ds_read_b64_tr_b16 v[200:201], v9 offset:21600
    ds_read_b64_tr_b16 v[202:203], v9 offset:22496
    s_waitcnt lgkmcnt(12)
    v_mfma_f32_16x16x32_bf16 v[160:163], v[24:27], v[208:211], v[160:163]
    v_mfma_f32_16x16x32_bf16 v[188:191], v[56:59], v[208:211], v[188:191]
    ds_read_b64_tr_b16 v[204:205], v9 offset:21632
    ds_read_b64_tr_b16 v[206:207], v9 offset:22528
    s_waitcnt lgkmcnt(12)
    v_mfma_f32_16x16x32_bf16 v[164:167], v[24:27], v[212:215], v[164:167]
    v_mfma_f32_16x16x32_bf16 v[192:195], v[56:59], v[212:215], v[192:195]
    ds_read_b64_tr_b16 v[208:209], v9 offset:21664
    ds_read_b64_tr_b16 v[210:211], v9 offset:22560
    s_waitcnt lgkmcnt(12)
    v_mfma_f32_16x16x32_bf16 v[168:171], v[24:27], v[216:219], v[168:171]
    v_mfma_f32_16x16x32_bf16 v[196:199], v[56:59], v[216:219], v[196:199]
    ds_read_b64_tr_b16 v[212:213], v9 offset:21696
    ds_read_b64_tr_b16 v[214:215], v9 offset:22592
    s_waitcnt lgkmcnt(12)
    v_mfma_f32_16x16x32_bf16 v[144:147], v[28:31], v[220:223], v[144:147]
    v_mfma_f32_16x16x32_bf16 v[172:175], v[60:63], v[220:223], v[172:175]
    ds_read_b64_tr_b16 v[216:217], v9 offset:28672
    ds_read_b64_tr_b16 v[218:219], v9 offset:29568
    s_waitcnt lgkmcnt(12)
    v_mfma_f32_16x16x32_bf16 v[148:151], v[28:31], v[224:227], v[148:151]
    v_mfma_f32_16x16x32_bf16 v[176:179], v[60:63], v[224:227], v[176:179]
    ds_read_b64_tr_b16 v[220:221], v9 offset:28704
    ds_read_b64_tr_b16 v[222:223], v9 offset:29600
    s_waitcnt lgkmcnt(12)
    v_mfma_f32_16x16x32_bf16 v[152:155], v[28:31], v[228:231], v[152:155]
    v_mfma_f32_16x16x32_bf16 v[180:183], v[60:63], v[228:231], v[180:183]
    ds_read_b64_tr_b16 v[224:225], v9 offset:28736
    ds_read_b64_tr_b16 v[226:227], v9 offset:29632
    s_waitcnt lgkmcnt(12)
    v_mfma_f32_16x16x32_bf16 v[156:159], v[28:31], v[200:203], v[156:159]
    v_mfma_f32_16x16x32_bf16 v[184:187], v[60:63], v[200:203], v[184:187]
    ds_read_b64_tr_b16 v[228:229], v9 offset:28768
    ds_read_b64_tr_b16 v[230:231], v9 offset:29664
    s_waitcnt lgkmcnt(12)
    v_mfma_f32_16x16x32_bf16 v[160:163], v[28:31], v[204:207], v[160:163]
    v_mfma_f32_16x16x32_bf16 v[188:191], v[60:63], v[204:207], v[188:191]
    ds_read_b64_tr_b16 v[200:201], v9 offset:28800
    ds_read_b64_tr_b16 v[202:203], v9 offset:29696
    s_waitcnt lgkmcnt(12)
    v_mfma_f32_16x16x32_bf16 v[164:167], v[28:31], v[208:211], v[164:167]
    v_mfma_f32_16x16x32_bf16 v[192:195], v[60:63], v[208:211], v[192:195]
    ds_read_b64_tr_b16 v[204:205], v9 offset:28832
    ds_read_b64_tr_b16 v[206:207], v9 offset:29728
    s_waitcnt lgkmcnt(12)
    v_mfma_f32_16x16x32_bf16 v[168:171], v[28:31], v[212:215], v[168:171]
    v_mfma_f32_16x16x32_bf16 v[196:199], v[60:63], v[212:215], v[196:199]
    ds_read_b64_tr_b16 v[208:209], v9 offset:28864
    ds_read_b64_tr_b16 v[210:211], v9 offset:29760
    s_waitcnt lgkmcnt(12)
    v_mfma_f32_16x16x32_bf16 v[144:147], v[32:35], v[216:219], v[144:147]
    v_mfma_f32_16x16x32_bf16 v[172:175], v[64:67], v[216:219], v[172:175]
    ds_read_b64_tr_b16 v[212:213], v9 offset:35840
    ds_read_b64_tr_b16 v[214:215], v9 offset:36736
    s_waitcnt lgkmcnt(12)
    v_mfma_f32_16x16x32_bf16 v[148:151], v[32:35], v[220:223], v[148:151]
    v_mfma_f32_16x16x32_bf16 v[176:179], v[64:67], v[220:223], v[176:179]
    ds_read_b64_tr_b16 v[216:217], v9 offset:35872
    ds_read_b64_tr_b16 v[218:219], v9 offset:36768
    s_waitcnt lgkmcnt(12)
    v_mfma_f32_16x16x32_bf16 v[152:155], v[32:35], v[224:227], v[152:155]
    v_mfma_f32_16x16x32_bf16 v[180:183], v[64:67], v[224:227], v[180:183]
    ds_read_b64_tr_b16 v[220:221], v9 offset:35904
    ds_read_b64_tr_b16 v[222:223], v9 offset:36800
    s_waitcnt lgkmcnt(12)
    v_mfma_f32_16x16x32_bf16 v[156:159], v[32:35], v[228:231], v[156:159]
    v_mfma_f32_16x16x32_bf16 v[184:187], v[64:67], v[228:231], v[184:187]
    ds_read_b64_tr_b16 v[224:225], v9 offset:35936
    ds_read_b64_tr_b16 v[226:227], v9 offset:36832
    s_waitcnt lgkmcnt(12)
    v_mfma_f32_16x16x32_bf16 v[160:163], v[32:35], v[200:203], v[160:163]
    v_mfma_f32_16x16x32_bf16 v[188:191], v[64:67], v[200:203], v[188:191]
    ds_read_b64_tr_b16 v[228:229], v9 offset:35968
    ds_read_b64_tr_b16 v[230:231], v9 offset:36864
    s_waitcnt lgkmcnt(12)
    v_mfma_f32_16x16x32_bf16 v[164:167], v[32:35], v[204:207], v[164:167]
    v_mfma_f32_16x16x32_bf16 v[192:195], v[64:67], v[204:207], v[192:195]
    ds_read_b64_tr_b16 v[200:201], v9 offset:36000
    ds_read_b64_tr_b16 v[202:203], v9 offset:36896
    s_waitcnt lgkmcnt(12)
    v_mfma_f32_16x16x32_bf16 v[168:171], v[32:35], v[208:211], v[168:171]
    v_mfma_f32_16x16x32_bf16 v[196:199], v[64:67], v[208:211], v[196:199]
    ds_read_b64_tr_b16 v[204:205], v9 offset:36032
    ds_read_b64_tr_b16 v[206:207], v9 offset:36928
    s_waitcnt lgkmcnt(12)
    v_mfma_f32_16x16x32_bf16 v[144:147], v[36:39], v[212:215], v[144:147]
    v_mfma_f32_16x16x32_bf16 v[172:175], v[68:71], v[212:215], v[172:175]
    ds_read_b64_tr_b16 v[208:209], v9 offset:43008
    ds_read_b64_tr_b16 v[210:211], v9 offset:43904
    s_waitcnt lgkmcnt(12)
    v_mfma_f32_16x16x32_bf16 v[148:151], v[36:39], v[216:219], v[148:151]
    v_mfma_f32_16x16x32_bf16 v[176:179], v[68:71], v[216:219], v[176:179]
    ds_read_b64_tr_b16 v[212:213], v9 offset:43040
    ds_read_b64_tr_b16 v[214:215], v9 offset:43936
    s_waitcnt lgkmcnt(12)
    v_mfma_f32_16x16x32_bf16 v[152:155], v[36:39], v[220:223], v[152:155]
    v_mfma_f32_16x16x32_bf16 v[180:183], v[68:71], v[220:223], v[180:183]
    ds_read_b64_tr_b16 v[216:217], v9 offset:43072
    ds_read_b64_tr_b16 v[218:219], v9 offset:43968
    s_waitcnt lgkmcnt(12)
    v_mfma_f32_16x16x32_bf16 v[156:159], v[36:39], v[224:227], v[156:159]
    v_mfma_f32_16x16x32_bf16 v[184:187], v[68:71], v[224:227], v[184:187]
    ds_read_b64_tr_b16 v[220:221], v9 offset:43104
    ds_read_b64_tr_b16 v[222:223], v9 offset:44000
    s_waitcnt lgkmcnt(12)
    v_mfma_f32_16x16x32_bf16 v[160:163], v[36:39], v[228:231], v[160:163]
    v_mfma_f32_16x16x32_bf16 v[188:191], v[68:71], v[228:231], v[188:191]
    ds_read_b64_tr_b16 v[224:225], v9 offset:43136
    ds_read_b64_tr_b16 v[226:227], v9 offset:44032
    s_waitcnt lgkmcnt(12)
    v_mfma_f32_16x16x32_bf16 v[164:167], v[36:39], v[200:203], v[164:167]
    v_mfma_f32_16x16x32_bf16 v[192:195], v[68:71], v[200:203], v[192:195]
    ds_read_b64_tr_b16 v[228:229], v9 offset:43168
    ds_read_b64_tr_b16 v[230:231], v9 offset:44064
    s_waitcnt lgkmcnt(12)
    v_mfma_f32_16x16x32_bf16 v[168:171], v[36:39], v[204:207], v[168:171]
    v_mfma_f32_16x16x32_bf16 v[196:199], v[68:71], v[204:207], v[196:199]
    ds_read_b64_tr_b16 v[200:201], v9 offset:43200
    ds_read_b64_tr_b16 v[202:203], v9 offset:44096
    s_waitcnt lgkmcnt(12)
    v_mfma_f32_16x16x32_bf16 v[144:147], v[40:43], v[208:211], v[144:147]
    v_mfma_f32_16x16x32_bf16 v[172:175], v[72:75], v[208:211], v[172:175]
    ds_read_b64_tr_b16 v[204:205], v9 offset:50176
    ds_read_b64_tr_b16 v[206:207], v9 offset:51072
    s_waitcnt lgkmcnt(12)
    v_mfma_f32_16x16x32_bf16 v[148:151], v[40:43], v[212:215], v[148:151]
    v_mfma_f32_16x16x32_bf16 v[176:179], v[72:75], v[212:215], v[176:179]
    ds_read_b64_tr_b16 v[208:209], v9 offset:50208
    ds_read_b64_tr_b16 v[210:211], v9 offset:51104
    s_waitcnt lgkmcnt(12)
    v_mfma_f32_16x16x32_bf16 v[152:155], v[40:43], v[216:219], v[152:155]
    v_mfma_f32_16x16x32_bf16 v[180:183], v[72:75], v[216:219], v[180:183]
    ds_read_b64_tr_b16 v[212:213], v9 offset:50240
    ds_read_b64_tr_b16 v[214:215], v9 offset:51136
    s_waitcnt lgkmcnt(12)
    v_mfma_f32_16x16x32_bf16 v[156:159], v[40:43], v[220:223], v[156:159]
    v_mfma_f32_16x16x32_bf16 v[184:187], v[72:75], v[220:223], v[184:187]
    ds_read_b64_tr_b16 v[216:217], v9 offset:50272
    ds_read_b64_tr_b16 v[218:219], v9 offset:51168
    s_waitcnt lgkmcnt(12)
    v_mfma_f32_16x16x32_bf16 v[160:163], v[40:43], v[224:227], v[160:163]
    v_mfma_f32_16x16x32_bf16 v[188:191], v[72:75], v[224:227], v[188:191]
    ds_read_b64_tr_b16 v[220:221], v9 offset:50304
    ds_read_b64_tr_b16 v[222:223], v9 offset:51200
    s_waitcnt lgkmcnt(12)
    v_mfma_f32_16x16x32_bf16 v[164:167], v[40:43], v[228:231], v[164:167]
    v_mfma_f32_16x16x32_bf16 v[192:195], v[72:75], v[228:231], v[192:195]
    ds_read_b64_tr_b16 v[224:225], v9 offset:50336
    ds_read_b64_tr_b16 v[226:227], v9 offset:51232
    s_waitcnt lgkmcnt(12)
    v_mfma_f32_16x16x32_bf16 v[168:171], v[40:43], v[200:203], v[168:171]
    v_mfma_f32_16x16x32_bf16 v[196:199], v[72:75], v[200:203], v[196:199]
    ds_read_b64_tr_b16 v[228:229], v9 offset:50368
    ds_read_b64_tr_b16 v[230:231], v9 offset:51264
    s_waitcnt lgkmcnt(12)
    v_mfma_f32_16x16x32_bf16 v[144:147], v[44:47], v[204:207], v[144:147]
    v_mfma_f32_16x16x32_bf16 v[172:175], v[76:79], v[204:207], v[172:175]
    s_waitcnt lgkmcnt(10)
    v_mfma_f32_16x16x32_bf16 v[148:151], v[44:47], v[208:211], v[148:151]
    v_mfma_f32_16x16x32_bf16 v[176:179], v[76:79], v[208:211], v[176:179]
    s_waitcnt lgkmcnt(8)
    v_mfma_f32_16x16x32_bf16 v[152:155], v[44:47], v[212:215], v[152:155]
    v_mfma_f32_16x16x32_bf16 v[180:183], v[76:79], v[212:215], v[180:183]
    s_waitcnt lgkmcnt(6)
    v_mfma_f32_16x16x32_bf16 v[156:159], v[44:47], v[216:219], v[156:159]
    v_mfma_f32_16x16x32_bf16 v[184:187], v[76:79], v[216:219], v[184:187]
    s_waitcnt lgkmcnt(4)
    v_mfma_f32_16x16x32_bf16 v[160:163], v[44:47], v[220:223], v[160:163]
    v_mfma_f32_16x16x32_bf16 v[188:191], v[76:79], v[220:223], v[188:191]
    s_waitcnt lgkmcnt(2)
    v_mfma_f32_16x16x32_bf16 v[164:167], v[44:47], v[224:227], v[164:167]
    v_mfma_f32_16x16x32_bf16 v[192:195], v[76:79], v[224:227], v[192:195]
    s_waitcnt lgkmcnt(0)
    v_mfma_f32_16x16x32_bf16 v[168:171], v[44:47], v[228:231], v[168:171]
    v_mfma_f32_16x16x32_bf16 v[196:199], v[76:79], v[228:231], v[196:199]
    s_mul_i32 s26, s23, 7
    s_add_u32 s26, s26, 0
    s_lshr_b32 s35, s26, 1
    s_lshl_b32 s35, s35, 2
    s_lshr_b32 s40, s22, 2
    s_add_u32 s35, s35, s40
    s_lshl_b32 s35, s35, 3
    s_and_b32 s40, s22, 3
    s_lshl_b32 s40, s40, 1
    s_add_u32 s35, s35, s40
    s_and_b32 s40, s26, 1
    s_add_u32 s35, s35, s40
    s_mul_i32 s26, s35, 14336
    s_lshl_b32 s35, s25, 10
    s_add_u32 s26, s26, s35
    s_add_u32 s26, s26, 6815744
    v_cvt_pk_bf16_f32 v232, v144, v145
    v_cvt_pk_bf16_f32 v233, v146, v147
    v_cvt_pk_bf16_f32 v234, v172, v173
    v_cvt_pk_bf16_f32 v235, v174, v175
    buffer_store_dwordx4 v[232:235], v2, s[8:11], s26 offen
    s_mul_i32 s26, s23, 7
    s_add_u32 s26, s26, 1
    s_lshr_b32 s35, s26, 1
    s_lshl_b32 s35, s35, 2
    s_lshr_b32 s40, s22, 2
    s_add_u32 s35, s35, s40
    s_lshl_b32 s35, s35, 3
    s_and_b32 s40, s22, 3
    s_lshl_b32 s40, s40, 1
    s_add_u32 s35, s35, s40
    s_and_b32 s40, s26, 1
    s_add_u32 s35, s35, s40
    s_mul_i32 s26, s35, 14336
    s_lshl_b32 s35, s25, 10
    s_add_u32 s26, s26, s35
    s_add_u32 s26, s26, 6815744
    v_cvt_pk_bf16_f32 v236, v148, v149
    v_cvt_pk_bf16_f32 v237, v150, v151
    v_cvt_pk_bf16_f32 v238, v176, v177
    v_cvt_pk_bf16_f32 v239, v178, v179
    buffer_store_dwordx4 v[236:239], v2, s[8:11], s26 offen
    s_mul_i32 s26, s23, 7
    s_add_u32 s26, s26, 2
    s_lshr_b32 s35, s26, 1
    s_lshl_b32 s35, s35, 2
    s_lshr_b32 s40, s22, 2
    s_add_u32 s35, s35, s40
    s_lshl_b32 s35, s35, 3
    s_and_b32 s40, s22, 3
    s_lshl_b32 s40, s40, 1
    s_add_u32 s35, s35, s40
    s_and_b32 s40, s26, 1
    s_add_u32 s35, s35, s40
    s_mul_i32 s26, s35, 14336
    s_lshl_b32 s35, s25, 10
    s_add_u32 s26, s26, s35
    s_add_u32 s26, s26, 6815744
    v_cvt_pk_bf16_f32 v240, v152, v153
    v_cvt_pk_bf16_f32 v241, v154, v155
    v_cvt_pk_bf16_f32 v242, v180, v181
    v_cvt_pk_bf16_f32 v243, v182, v183
    buffer_store_dwordx4 v[240:243], v2, s[8:11], s26 offen
    s_mul_i32 s26, s23, 7
    s_add_u32 s26, s26, 3
    s_lshr_b32 s35, s26, 1
    s_lshl_b32 s35, s35, 2
    s_lshr_b32 s40, s22, 2
    s_add_u32 s35, s35, s40
    s_lshl_b32 s35, s35, 3
    s_and_b32 s40, s22, 3
    s_lshl_b32 s40, s40, 1
    s_add_u32 s35, s35, s40
    s_and_b32 s40, s26, 1
    s_add_u32 s35, s35, s40
    s_mul_i32 s26, s35, 14336
    s_lshl_b32 s35, s25, 10
    s_add_u32 s26, s26, s35
    s_add_u32 s26, s26, 6815744
    v_cvt_pk_bf16_f32 v244, v156, v157
    v_cvt_pk_bf16_f32 v245, v158, v159
    v_cvt_pk_bf16_f32 v246, v184, v185
    v_cvt_pk_bf16_f32 v247, v186, v187
    buffer_store_dwordx4 v[244:247], v2, s[8:11], s26 offen
    s_mul_i32 s26, s23, 7
    s_add_u32 s26, s26, 4
    s_lshr_b32 s35, s26, 1
    s_lshl_b32 s35, s35, 2
    s_lshr_b32 s40, s22, 2
    s_add_u32 s35, s35, s40
    s_lshl_b32 s35, s35, 3
    s_and_b32 s40, s22, 3
    s_lshl_b32 s40, s40, 1
    s_add_u32 s35, s35, s40
    s_and_b32 s40, s26, 1
    s_add_u32 s35, s35, s40
    s_mul_i32 s26, s35, 14336
    s_lshl_b32 s35, s25, 10
    s_add_u32 s26, s26, s35
    s_add_u32 s26, s26, 6815744
    v_cvt_pk_bf16_f32 v232, v160, v161
    v_cvt_pk_bf16_f32 v233, v162, v163
    v_cvt_pk_bf16_f32 v234, v188, v189
    v_cvt_pk_bf16_f32 v235, v190, v191
    buffer_store_dwordx4 v[232:235], v2, s[8:11], s26 offen
    s_mul_i32 s26, s23, 7
    s_add_u32 s26, s26, 5
    s_lshr_b32 s35, s26, 1
    s_lshl_b32 s35, s35, 2
    s_lshr_b32 s40, s22, 2
    s_add_u32 s35, s35, s40
    s_lshl_b32 s35, s35, 3
    s_and_b32 s40, s22, 3
    s_lshl_b32 s40, s40, 1
    s_add_u32 s35, s35, s40
    s_and_b32 s40, s26, 1
    s_add_u32 s35, s35, s40
    s_mul_i32 s26, s35, 14336
    s_lshl_b32 s35, s25, 10
    s_add_u32 s26, s26, s35
    s_add_u32 s26, s26, 6815744
    v_cvt_pk_bf16_f32 v236, v164, v165
    v_cvt_pk_bf16_f32 v237, v166, v167
    v_cvt_pk_bf16_f32 v238, v192, v193
    v_cvt_pk_bf16_f32 v239, v194, v195
    buffer_store_dwordx4 v[236:239], v2, s[8:11], s26 offen
    s_mul_i32 s26, s23, 7
    s_add_u32 s26, s26, 6
    s_lshr_b32 s35, s26, 1
    s_lshl_b32 s35, s35, 2
    s_lshr_b32 s40, s22, 2
    s_add_u32 s35, s35, s40
    s_lshl_b32 s35, s35, 3
    s_and_b32 s40, s22, 3
    s_lshl_b32 s40, s40, 1
    s_add_u32 s35, s35, s40
    s_and_b32 s40, s26, 1
    s_add_u32 s35, s35, s40
    s_mul_i32 s26, s35, 14336
    s_lshl_b32 s35, s25, 10
    s_add_u32 s26, s26, s35
    s_add_u32 s26, s26, 6815744
    v_cvt_pk_bf16_f32 v240, v168, v169
    v_cvt_pk_bf16_f32 v241, v170, v171
    v_cvt_pk_bf16_f32 v242, v196, v197
    v_cvt_pk_bf16_f32 v243, v198, v199
    buffer_store_dwordx4 v[240:243], v2, s[8:11], s26 offen
    s_cmp_ge_u32 s18, 3
    s_nop 0
    s_cbranch_scc1 PWC_END
    v_mov_b32 v144, 0
    v_mov_b32 v145, 0
    v_mov_b32 v146, 0
    v_mov_b32 v147, 0
    v_mov_b32 v148, 0
    v_mov_b32 v149, 0
    v_mov_b32 v150, 0
    v_mov_b32 v151, 0
    v_mov_b32 v152, 0
    v_mov_b32 v153, 0
    v_mov_b32 v154, 0
    v_mov_b32 v155, 0
    v_mov_b32 v156, 0
    v_mov_b32 v157, 0
    v_mov_b32 v158, 0
    v_mov_b32 v159, 0
    v_mov_b32 v160, 0
    v_mov_b32 v161, 0
    v_mov_b32 v162, 0
    v_mov_b32 v163, 0
    v_mov_b32 v164, 0
    v_mov_b32 v165, 0
    v_mov_b32 v166, 0
    v_mov_b32 v167, 0
    v_mov_b32 v168, 0
    v_mov_b32 v169, 0
    v_mov_b32 v170, 0
    v_mov_b32 v171, 0
    v_mov_b32 v172, 0
    v_mov_b32 v173, 0
    v_mov_b32 v174, 0
    v_mov_b32 v175, 0
    v_mov_b32 v176, 0
    v_mov_b32 v177, 0
    v_mov_b32 v178, 0
    v_mov_b32 v179, 0
    v_mov_b32 v180, 0
    v_mov_b32 v181, 0
    v_mov_b32 v182, 0
    v_mov_b32 v183, 0
    v_mov_b32 v184, 0
    v_mov_b32 v185, 0
    v_mov_b32 v186, 0
    v_mov_b32 v187, 0
    v_mov_b32 v188, 0
    v_mov_b32 v189, 0
    v_mov_b32 v190, 0
    v_mov_b32 v191, 0
    v_mov_b32 v192, 0
    v_mov_b32 v193, 0
    v_mov_b32 v194, 0
    v_mov_b32 v195, 0
    v_mov_b32 v196, 0
    v_mov_b32 v197, 0
    v_mov_b32 v198, 0
    v_mov_b32 v199, 0
    ds_read_b64_tr_b16 v[200:201], v9 offset:0
    ds_read_b64_tr_b16 v[202:203], v9 offset:896
    ds_read_b64_tr_b16 v[204:205], v9 offset:32
    ds_read_b64_tr_b16 v[206:207], v9 offset:928
    ds_read_b64_tr_b16 v[208:209], v9 offset:64
    ds_read_b64_tr_b16 v[210:211], v9 offset:960
    ds_read_b64_tr_b16 v[212:213], v9 offset:96
    ds_read_b64_tr_b16 v[214:215], v9 offset:992
    ds_read_b64_tr_b16 v[216:217], v9 offset:128
    ds_read_b64_tr_b16 v[218:219], v9 offset:1024
    ds_read_b64_tr_b16 v[220:221], v9 offset:160
    ds_read_b64_tr_b16 v[222:223], v9 offset:1056
    ds_read_b64_tr_b16 v[224:225], v9 offset:192
    ds_read_b64_tr_b16 v[226:227], v9 offset:1088
    s_waitcnt lgkmcnt(12)
    v_mfma_f32_16x16x32_bf16 v[144:147], v[80:83], v[200:203], v[144:147]
    v_mfma_f32_16x16x32_bf16 v[172:175], v[112:115], v[200:203], v[172:175]
    ds_read_b64_tr_b16 v[228:229], v9 offset:7168
    ds_read_b64_tr_b16 v[230:231], v9 offset:8064
    s_waitcnt lgkmcnt(12)
    v_mfma_f32_16x16x32_bf16 v[148:151], v[80:83], v[204:207], v[148:151]
    v_mfma_f32_16x16x32_bf16 v[176:179], v[112:115], v[204:207], v[176:179]
    ds_read_b64_tr_b16 v[200:201], v9 offset:7200
    ds_read_b64_tr_b16 v[202:203], v9 offset:8096
    s_waitcnt lgkmcnt(12)
    v_mfma_f32_16x16x32_bf16 v[152:155], v[80:83], v[208:211], v[152:155]
    v_mfma_f32_16x16x32_bf16 v[180:183], v[112:115], v[208:211], v[180:183]
    ds_read_b64_tr_b16 v[204:205], v9 offset:7232
    ds_read_b64_tr_b16 v[206:207], v9 offset:8128
    s_waitcnt lgkmcnt(12)
    v_mfma_f32_16x16x32_bf16 v[156:159], v[80:83], v[212:215], v[156:159]
    v_mfma_f32_16x16x32_bf16 v[184:187], v[112:115], v[212:215], v[184:187]
    ds_read_b64_tr_b16 v[208:209], v9 offset:7264
    ds_read_b64_tr_b16 v[210:211], v9 offset:8160
    s_waitcnt lgkmcnt(12)
    v_mfma_f32_16x16x32_bf16 v[160:163], v[80:83], v[216:219], v[160:163]
    v_mfma_f32_16x16x32_bf16 v[188:191], v[112:115], v[216:219], v[188:191]
    ds_read_b64_tr_b16 v[212:213], v9 offset:7296
    ds_read_b64_tr_b16 v[214:215], v9 offset:8192
    s_waitcnt lgkmcnt(12)
    v_mfma_f32_16x16x32_bf16 v[164:167], v[80:83], v[220:223], v[164:167]
    v_mfma_f32_16x16x32_bf16 v[192:195], v[112:115], v[220:223], v[192:195]
    ds_read_b64_tr_b16 v[216:217], v9 offset:7328
    ds_read_b64_tr_b16 v[218:219], v9 offset:8224
    s_waitcnt lgkmcnt(12)
    v_mfma_f32_16x16x32_bf16 v[168:171], v[80:83], v[224:227], v[168:171]
    v_mfma_f32_16x16x32_bf16 v[196:199], v[112:115], v[224:227], v[196:199]
    ds_read_b64_tr_b16 v[220:221], v9 offset:7360
    ds_read_b64_tr_b16 v[222:223], v9 offset:8256
    s_waitcnt lgkmcnt(12)
    v_mfma_f32_16x16x32_bf16 v[144:147], v[84:87], v[228:231], v[144:147]
    v_mfma_f32_16x16x32_bf16 v[172:175], v[116:119], v[228:231], v[172:175]
    ds_read_b64_tr_b16 v[224:225], v9 offset:14336
    ds_read_b64_tr_b16 v[226:227], v9 offset:15232
    s_waitcnt lgkmcnt(12)
    v_mfma_f32_16x16x32_bf16 v[148:151], v[84:87], v[200:203], v[148:151]
    v_mfma_f32_16x16x32_bf16 v[176:179], v[116:119], v[200:203], v[176:179]
    ds_read_b64_tr_b16 v[228:229], v9 offset:14368
    ds_read_b64_tr_b16 v[230:231], v9 offset:15264
    s_waitcnt lgkmcnt(12)
    v_mfma_f32_16x16x32_bf16 v[152:155], v[84:87], v[204:207], v[152:155]
    v_mfma_f32_16x16x32_bf16 v[180:183], v[116:119], v[204:207], v[180:183]
    ds_read_b64_tr_b16 v[200:201], v9 offset:14400
    ds_read_b64_tr_b16 v[202:203], v9 offset:15296
    s_waitcnt lgkmcnt(12)
    v_mfma_f32_16x16x32_bf16 v[156:159], v[84:87], v[208:211], v[156:159]
    v_mfma_f32_16x16x32_bf16 v[184:187], v[116:119], v[208:211], v[184:187]
    ds_read_b64_tr_b16 v[204:205], v9 offset:14432
    ds_read_b64_tr_b16 v[206:207], v9 offset:15328
    s_waitcnt lgkmcnt(12)
    v_mfma_f32_16x16x32_bf16 v[160:163], v[84:87], v[212:215], v[160:163]
    v_mfma_f32_16x16x32_bf16 v[188:191], v[116:119], v[212:215], v[188:191]
    ds_read_b64_tr_b16 v[208:209], v9 offset:14464
    ds_read_b64_tr_b16 v[210:211], v9 offset:15360
    s_waitcnt lgkmcnt(12)
    v_mfma_f32_16x16x32_bf16 v[164:167], v[84:87], v[216:219], v[164:167]
    v_mfma_f32_16x16x32_bf16 v[192:195], v[116:119], v[216:219], v[192:195]
    ds_read_b64_tr_b16 v[212:213], v9 offset:14496
    ds_read_b64_tr_b16 v[214:215], v9 offset:15392
    s_waitcnt lgkmcnt(12)
    v_mfma_f32_16x16x32_bf16 v[168:171], v[84:87], v[220:223], v[168:171]
    v_mfma_f32_16x16x32_bf16 v[196:199], v[116:119], v[220:223], v[196:199]
    ds_read_b64_tr_b16 v[216:217], v9 offset:14528
    ds_read_b64_tr_b16 v[218:219], v9 offset:15424
    s_waitcnt lgkmcnt(12)
    v_mfma_f32_16x16x32_bf16 v[144:147], v[88:91], v[224:227], v[144:147]
    v_mfma_f32_16x16x32_bf16 v[172:175], v[120:123], v[224:227], v[172:175]
    ds_read_b64_tr_b16 v[220:221], v9 offset:21504
    ds_read_b64_tr_b16 v[222:223], v9 offset:22400
    s_waitcnt lgkmcnt(12)
    v_mfma_f32_16x16x32_bf16 v[148:151], v[88:91], v[228:231], v[148:151]
    v_mfma_f32_16x16x32_bf16 v[176:179], v[120:123], v[228:231], v[176:179]
    ds_read_b64_tr_b16 v[224:225], v9 offset:21536
    ds_read_b64_tr_b16 v[226:227], v9 offset:22432
    s_waitcnt lgkmcnt(12)
    v_mfma_f32_16x16x32_bf16 v[152:155], v[88:91], v[200:203], v[152:155]
    v_mfma_f32_16x16x32_bf16 v[180:183], v[120:123], v[200:203], v[180:183]
    ds_read_b64_tr_b16 v[228:229], v9 offset:21568
    ds_read_b64_tr_b16 v[230:231], v9 offset:22464
    s_waitcnt lgkmcnt(12)
    v_mfma_f32_16x16x32_bf16 v[156:159], v[88:91], v[204:207], v[156:159]
    v_mfma_f32_16x16x32_bf16 v[184:187], v[120:123], v[204:207], v[184:187]
    ds_read_b64_tr_b16 v[200:201], v9 offset:21600
    ds_read_b64_tr_b16 v[202:203], v9 offset:22496
    s_waitcnt lgkmcnt(12)
    v_mfma_f32_16x16x32_bf16 v[160:163], v[88:91], v[208:211], v[160:163]
    v_mfma_f32_16x16x32_bf16 v[188:191], v[120:123], v[208:211], v[188:191]
    ds_read_b64_tr_b16 v[204:205], v9 offset:21632
    ds_read_b64_tr_b16 v[206:207], v9 offset:22528
    s_waitcnt lgkmcnt(12)
    v_mfma_f32_16x16x32_bf16 v[164:167], v[88:91], v[212:215], v[164:167]
    v_mfma_f32_16x16x32_bf16 v[192:195], v[120:123], v[212:215], v[192:195]
    ds_read_b64_tr_b16 v[208:209], v9 offset:21664
    ds_read_b64_tr_b16 v[210:211], v9 offset:22560
    s_waitcnt lgkmcnt(12)
    v_mfma_f32_16x16x32_bf16 v[168:171], v[88:91], v[216:219], v[168:171]
    v_mfma_f32_16x16x32_bf16 v[196:199], v[120:123], v[216:219], v[196:199]
    ds_read_b64_tr_b16 v[212:213], v9 offset:21696
    ds_read_b64_tr_b16 v[214:215], v9 offset:22592
    s_waitcnt lgkmcnt(12)
    v_mfma_f32_16x16x32_bf16 v[144:147], v[92:95], v[220:223], v[144:147]
    v_mfma_f32_16x16x32_bf16 v[172:175], v[124:127], v[220:223], v[172:175]
    ds_read_b64_tr_b16 v[216:217], v9 offset:28672
    ds_read_b64_tr_b16 v[218:219], v9 offset:29568
    s_waitcnt lgkmcnt(12)
    v_mfma_f32_16x16x32_bf16 v[148:151], v[92:95], v[224:227], v[148:151]
    v_mfma_f32_16x16x32_bf16 v[176:179], v[124:127], v[224:227], v[176:179]
    ds_read_b64_tr_b16 v[220:221], v9 offset:28704
    ds_read_b64_tr_b16 v[222:223], v9 offset:29600
    s_waitcnt lgkmcnt(12)
    v_mfma_f32_16x16x32_bf16 v[152:155], v[92:95], v[228:231], v[152:155]
    v_mfma_f32_16x16x32_bf16 v[180:183], v[124:127], v[228:231], v[180:183]
    ds_read_b64_tr_b16 v[224:225], v9 offset:28736
    ds_read_b64_tr_b16 v[226:227], v9 offset:29632
    s_waitcnt lgkmcnt(12)
    v_mfma_f32_16x16x32_bf16 v[156:159], v[92:95], v[200:203], v[156:159]
    v_mfma_f32_16x16x32_bf16 v[184:187], v[124:127], v[200:203], v[184:187]
    ds_read_b64_tr_b16 v[228:229], v9 offset:28768
    ds_read_b64_tr_b16 v[230:231], v9 offset:29664
    s_waitcnt lgkmcnt(12)
    v_mfma_f32_16x16x32_bf16 v[160:163], v[92:95], v[204:207], v[160:163]
    v_mfma_f32_16x16x32_bf16 v[188:191], v[124:127], v[204:207], v[188:191]
    ds_read_b64_tr_b16 v[200:201], v9 offset:28800
    ds_read_b64_tr_b16 v[202:203], v9 offset:29696
    s_waitcnt lgkmcnt(12)
    v_mfma_f32_16x16x32_bf16 v[164:167], v[92:95], v[208:211], v[164:167]
    v_mfma_f32_16x16x32_bf16 v[192:195], v[124:127], v[208:211], v[192:195]
    ds_read_b64_tr_b16 v[204:205], v9 offset:28832
    ds_read_b64_tr_b16 v[206:207], v9 offset:29728
    s_waitcnt lgkmcnt(12)
    v_mfma_f32_16x16x32_bf16 v[168:171], v[92:95], v[212:215], v[168:171]
    v_mfma_f32_16x16x32_bf16 v[196:199], v[124:127], v[212:215], v[196:199]
    ds_read_b64_tr_b16 v[208:209], v9 offset:28864
    ds_read_b64_tr_b16 v[210:211], v9 offset:29760
    s_waitcnt lgkmcnt(12)
    v_mfma_f32_16x16x32_bf16 v[144:147], v[96:99], v[216:219], v[144:147]
    v_mfma_f32_16x16x32_bf16 v[172:175], v[128:131], v[216:219], v[172:175]
    ds_read_b64_tr_b16 v[212:213], v9 offset:35840
    ds_read_b64_tr_b16 v[214:215], v9 offset:36736
    s_waitcnt lgkmcnt(12)
    v_mfma_f32_16x16x32_bf16 v[148:151], v[96:99], v[220:223], v[148:151]
    v_mfma_f32_16x16x32_bf16 v[176:179], v[128:131], v[220:223], v[176:179]
    ds_read_b64_tr_b16 v[216:217], v9 offset:35872
    ds_read_b64_tr_b16 v[218:219], v9 offset:36768
    s_waitcnt lgkmcnt(12)
    v_mfma_f32_16x16x32_bf16 v[152:155], v[96:99], v[224:227], v[152:155]
    v_mfma_f32_16x16x32_bf16 v[180:183], v[128:131], v[224:227], v[180:183]
    ds_read_b64_tr_b16 v[220:221], v9 offset:35904
    ds_read_b64_tr_b16 v[222:223], v9 offset:36800
    s_waitcnt lgkmcnt(12)
    v_mfma_f32_16x16x32_bf16 v[156:159], v[96:99], v[228:231], v[156:159]
    v_mfma_f32_16x16x32_bf16 v[184:187], v[128:131], v[228:231], v[184:187]
    ds_read_b64_tr_b16 v[224:225], v9 offset:35936
    ds_read_b64_tr_b16 v[226:227], v9 offset:36832
    s_waitcnt lgkmcnt(12)
    v_mfma_f32_16x16x32_bf16 v[160:163], v[96:99], v[200:203], v[160:163]
    v_mfma_f32_16x16x32_bf16 v[188:191], v[128:131], v[200:203], v[188:191]
    ds_read_b64_tr_b16 v[228:229], v9 offset:35968
    ds_read_b64_tr_b16 v[230:231], v9 offset:36864
    s_waitcnt lgkmcnt(12)
    v_mfma_f32_16x16x32_bf16 v[164:167], v[96:99], v[204:207], v[164:167]
    v_mfma_f32_16x16x32_bf16 v[192:195], v[128:131], v[204:207], v[192:195]
    ds_read_b64_tr_b16 v[200:201], v9 offset:36000
    ds_read_b64_tr_b16 v[202:203], v9 offset:36896
    s_waitcnt lgkmcnt(12)
    v_mfma_f32_16x16x32_bf16 v[168:171], v[96:99], v[208:211], v[168:171]
    v_mfma_f32_16x16x32_bf16 v[196:199], v[128:131], v[208:211], v[196:199]
    ds_read_b64_tr_b16 v[204:205], v9 offset:36032
    ds_read_b64_tr_b16 v[206:207], v9 offset:36928
    s_waitcnt lgkmcnt(12)
    v_mfma_f32_16x16x32_bf16 v[144:147], v[100:103], v[212:215], v[144:147]
    v_mfma_f32_16x16x32_bf16 v[172:175], v[132:135], v[212:215], v[172:175]
    ds_read_b64_tr_b16 v[208:209], v9 offset:43008
    ds_read_b64_tr_b16 v[210:211], v9 offset:43904
    s_waitcnt lgkmcnt(12)
    v_mfma_f32_16x16x32_bf16 v[148:151], v[100:103], v[216:219], v[148:151]
    v_mfma_f32_16x16x32_bf16 v[176:179], v[132:135], v[216:219], v[176:179]
    ds_read_b64_tr_b16 v[212:213], v9 offset:43040
    ds_read_b64_tr_b16 v[214:215], v9 offset:43936
    s_waitcnt lgkmcnt(12)
    v_mfma_f32_16x16x32_bf16 v[152:155], v[100:103], v[220:223], v[152:155]
    v_mfma_f32_16x16x32_bf16 v[180:183], v[132:135], v[220:223], v[180:183]
    ds_read_b64_tr_b16 v[216:217], v9 offset:43072
    ds_read_b64_tr_b16 v[218:219], v9 offset:43968
    s_waitcnt lgkmcnt(12)
    v_mfma_f32_16x16x32_bf16 v[156:159], v[100:103], v[224:227], v[156:159]
    v_mfma_f32_16x16x32_bf16 v[184:187], v[132:135], v[224:227], v[184:187]
    ds_read_b64_tr_b16 v[220:221], v9 offset:43104
    ds_read_b64_tr_b16 v[222:223], v9 offset:44000
    s_waitcnt lgkmcnt(12)
    v_mfma_f32_16x16x32_bf16 v[160:163], v[100:103], v[228:231], v[160:163]
    v_mfma_f32_16x16x32_bf16 v[188:191], v[132:135], v[228:231], v[188:191]
    ds_read_b64_tr_b16 v[224:225], v9 offset:43136
    ds_read_b64_tr_b16 v[226:227], v9 offset:44032
    s_waitcnt lgkmcnt(12)
    v_mfma_f32_16x16x32_bf16 v[164:167], v[100:103], v[200:203], v[164:167]
    v_mfma_f32_16x16x32_bf16 v[192:195], v[132:135], v[200:203], v[192:195]
    ds_read_b64_tr_b16 v[228:229], v9 offset:43168
    ds_read_b64_tr_b16 v[230:231], v9 offset:44064
    s_waitcnt lgkmcnt(12)
    v_mfma_f32_16x16x32_bf16 v[168:171], v[100:103], v[204:207], v[168:171]
    v_mfma_f32_16x16x32_bf16 v[196:199], v[132:135], v[204:207], v[196:199]
    ds_read_b64_tr_b16 v[200:201], v9 offset:43200
    ds_read_b64_tr_b16 v[202:203], v9 offset:44096
    s_waitcnt lgkmcnt(12)
    v_mfma_f32_16x16x32_bf16 v[144:147], v[104:107], v[208:211], v[144:147]
    v_mfma_f32_16x16x32_bf16 v[172:175], v[136:139], v[208:211], v[172:175]
    ds_read_b64_tr_b16 v[204:205], v9 offset:50176
    ds_read_b64_tr_b16 v[206:207], v9 offset:51072
    s_waitcnt lgkmcnt(12)
    v_mfma_f32_16x16x32_bf16 v[148:151], v[104:107], v[212:215], v[148:151]
    v_mfma_f32_16x16x32_bf16 v[176:179], v[136:139], v[212:215], v[176:179]
    ds_read_b64_tr_b16 v[208:209], v9 offset:50208
    ds_read_b64_tr_b16 v[210:211], v9 offset:51104
    s_waitcnt lgkmcnt(12)
    v_mfma_f32_16x16x32_bf16 v[152:155], v[104:107], v[216:219], v[152:155]
    v_mfma_f32_16x16x32_bf16 v[180:183], v[136:139], v[216:219], v[180:183]
    ds_read_b64_tr_b16 v[212:213], v9 offset:50240
    ds_read_b64_tr_b16 v[214:215], v9 offset:51136
    s_waitcnt lgkmcnt(12)
    v_mfma_f32_16x16x32_bf16 v[156:159], v[104:107], v[220:223], v[156:159]
    v_mfma_f32_16x16x32_bf16 v[184:187], v[136:139], v[220:223], v[184:187]
    ds_read_b64_tr_b16 v[216:217], v9 offset:50272
    ds_read_b64_tr_b16 v[218:219], v9 offset:51168
    s_waitcnt lgkmcnt(12)
    v_mfma_f32_16x16x32_bf16 v[160:163], v[104:107], v[224:227], v[160:163]
    v_mfma_f32_16x16x32_bf16 v[188:191], v[136:139], v[224:227], v[188:191]
    ds_read_b64_tr_b16 v[220:221], v9 offset:50304
    ds_read_b64_tr_b16 v[222:223], v9 offset:51200
    s_waitcnt lgkmcnt(12)
    v_mfma_f32_16x16x32_bf16 v[164:167], v[104:107], v[228:231], v[164:167]
    v_mfma_f32_16x16x32_bf16 v[192:195], v[136:139], v[228:231], v[192:195]
    ds_read_b64_tr_b16 v[224:225], v9 offset:50336
    ds_read_b64_tr_b16 v[226:227], v9 offset:51232
    s_waitcnt lgkmcnt(12)
    v_mfma_f32_16x16x32_bf16 v[168:171], v[104:107], v[200:203], v[168:171]
    v_mfma_f32_16x16x32_bf16 v[196:199], v[136:139], v[200:203], v[196:199]
    ds_read_b64_tr_b16 v[228:229], v9 offset:50368
    ds_read_b64_tr_b16 v[230:231], v9 offset:51264
    s_waitcnt lgkmcnt(12)
    v_mfma_f32_16x16x32_bf16 v[144:147], v[108:111], v[204:207], v[144:147]
    v_mfma_f32_16x16x32_bf16 v[172:175], v[140:143], v[204:207], v[172:175]
    s_waitcnt lgkmcnt(10)
    v_mfma_f32_16x16x32_bf16 v[148:151], v[108:111], v[208:211], v[148:151]
    v_mfma_f32_16x16x32_bf16 v[176:179], v[140:143], v[208:211], v[176:179]
    s_waitcnt lgkmcnt(8)
    v_mfma_f32_16x16x32_bf16 v[152:155], v[108:111], v[212:215], v[152:155]
    v_mfma_f32_16x16x32_bf16 v[180:183], v[140:143], v[212:215], v[180:183]
    s_waitcnt lgkmcnt(6)
    v_mfma_f32_16x16x32_bf16 v[156:159], v[108:111], v[216:219], v[156:159]
    v_mfma_f32_16x16x32_bf16 v[184:187], v[140:143], v[216:219], v[184:187]
    s_waitcnt lgkmcnt(4)
    v_mfma_f32_16x16x32_bf16 v[160:163], v[108:111], v[220:223], v[160:163]
    v_mfma_f32_16x16x32_bf16 v[188:191], v[140:143], v[220:223], v[188:191]
    s_waitcnt lgkmcnt(2)
    v_mfma_f32_16x16x32_bf16 v[164:167], v[108:111], v[224:227], v[164:167]
    v_mfma_f32_16x16x32_bf16 v[192:195], v[140:143], v[224:227], v[192:195]
    s_waitcnt lgkmcnt(0)
    v_mfma_f32_16x16x32_bf16 v[168:171], v[108:111], v[228:231], v[168:171]
    v_mfma_f32_16x16x32_bf16 v[196:199], v[140:143], v[228:231], v[196:199]
    s_mul_i32 s26, s23, 7
    s_add_u32 s26, s26, 0
    s_lshr_b32 s35, s26, 1
    s_lshl_b32 s35, s35, 2
    s_lshr_b32 s40, s22, 2
    s_add_u32 s35, s35, s40
    s_lshl_b32 s35, s35, 3
    s_and_b32 s40, s22, 3
    s_lshl_b32 s40, s40, 1
    s_add_u32 s35, s35, s40
    s_and_b32 s40, s26, 1
    s_add_u32 s35, s35, s40
    s_mul_i32 s26, s35, 14336
    s_lshl_b32 s35, s34, 10
    s_add_u32 s26, s26, s35
    s_add_u32 s26, s26, 6815744
    v_cvt_pk_bf16_f32 v232, v144, v145
    v_cvt_pk_bf16_f32 v233, v146, v147
    v_cvt_pk_bf16_f32 v234, v172, v173
    v_cvt_pk_bf16_f32 v235, v174, v175
    buffer_store_dwordx4 v[232:235], v2, s[8:11], s26 offen
    s_mul_i32 s26, s23, 7
    s_add_u32 s26, s26, 1
    s_lshr_b32 s35, s26, 1
    s_lshl_b32 s35, s35, 2
    s_lshr_b32 s40, s22, 2
    s_add_u32 s35, s35, s40
    s_lshl_b32 s35, s35, 3
    s_and_b32 s40, s22, 3
    s_lshl_b32 s40, s40, 1
    s_add_u32 s35, s35, s40
    s_and_b32 s40, s26, 1
    s_add_u32 s35, s35, s40
    s_mul_i32 s26, s35, 14336
    s_lshl_b32 s35, s34, 10
    s_add_u32 s26, s26, s35
    s_add_u32 s26, s26, 6815744
    v_cvt_pk_bf16_f32 v236, v148, v149
    v_cvt_pk_bf16_f32 v237, v150, v151
    v_cvt_pk_bf16_f32 v238, v176, v177
    v_cvt_pk_bf16_f32 v239, v178, v179
    buffer_store_dwordx4 v[236:239], v2, s[8:11], s26 offen
    s_mul_i32 s26, s23, 7
    s_add_u32 s26, s26, 2
    s_lshr_b32 s35, s26, 1
    s_lshl_b32 s35, s35, 2
    s_lshr_b32 s40, s22, 2
    s_add_u32 s35, s35, s40
    s_lshl_b32 s35, s35, 3
    s_and_b32 s40, s22, 3
    s_lshl_b32 s40, s40, 1
    s_add_u32 s35, s35, s40
    s_and_b32 s40, s26, 1
    s_add_u32 s35, s35, s40
    s_mul_i32 s26, s35, 14336
    s_lshl_b32 s35, s34, 10
    s_add_u32 s26, s26, s35
    s_add_u32 s26, s26, 6815744
    v_cvt_pk_bf16_f32 v240, v152, v153
    v_cvt_pk_bf16_f32 v241, v154, v155
    v_cvt_pk_bf16_f32 v242, v180, v181
    v_cvt_pk_bf16_f32 v243, v182, v183
    buffer_store_dwordx4 v[240:243], v2, s[8:11], s26 offen
    s_mul_i32 s26, s23, 7
    s_add_u32 s26, s26, 3
    s_lshr_b32 s35, s26, 1
    s_lshl_b32 s35, s35, 2
    s_lshr_b32 s40, s22, 2
    s_add_u32 s35, s35, s40
    s_lshl_b32 s35, s35, 3
    s_and_b32 s40, s22, 3
    s_lshl_b32 s40, s40, 1
    s_add_u32 s35, s35, s40
    s_and_b32 s40, s26, 1
    s_add_u32 s35, s35, s40
    s_mul_i32 s26, s35, 14336
    s_lshl_b32 s35, s34, 10
    s_add_u32 s26, s26, s35
    s_add_u32 s26, s26, 6815744
    v_cvt_pk_bf16_f32 v244, v156, v157
    v_cvt_pk_bf16_f32 v245, v158, v159
    v_cvt_pk_bf16_f32 v246, v184, v185
    v_cvt_pk_bf16_f32 v247, v186, v187
    buffer_store_dwordx4 v[244:247], v2, s[8:11], s26 offen
    s_mul_i32 s26, s23, 7
    s_add_u32 s26, s26, 4
    s_lshr_b32 s35, s26, 1
    s_lshl_b32 s35, s35, 2
    s_lshr_b32 s40, s22, 2
    s_add_u32 s35, s35, s40
    s_lshl_b32 s35, s35, 3
    s_and_b32 s40, s22, 3
    s_lshl_b32 s40, s40, 1
    s_add_u32 s35, s35, s40
    s_and_b32 s40, s26, 1
    s_add_u32 s35, s35, s40
    s_mul_i32 s26, s35, 14336
    s_lshl_b32 s35, s34, 10
    s_add_u32 s26, s26, s35
    s_add_u32 s26, s26, 6815744
    v_cvt_pk_bf16_f32 v232, v160, v161
    v_cvt_pk_bf16_f32 v233, v162, v163
    v_cvt_pk_bf16_f32 v234, v188, v189
    v_cvt_pk_bf16_f32 v235, v190, v191
    buffer_store_dwordx4 v[232:235], v2, s[8:11], s26 offen
    s_mul_i32 s26, s23, 7
    s_add_u32 s26, s26, 5
    s_lshr_b32 s35, s26, 1
    s_lshl_b32 s35, s35, 2
    s_lshr_b32 s40, s22, 2
    s_add_u32 s35, s35, s40
    s_lshl_b32 s35, s35, 3
    s_and_b32 s40, s22, 3
    s_lshl_b32 s40, s40, 1
    s_add_u32 s35, s35, s40
    s_and_b32 s40, s26, 1
    s_add_u32 s35, s35, s40
    s_mul_i32 s26, s35, 14336
    s_lshl_b32 s35, s34, 10
    s_add_u32 s26, s26, s35
    s_add_u32 s26, s26, 6815744
    v_cvt_pk_bf16_f32 v236, v164, v165
    v_cvt_pk_bf16_f32 v237, v166, v167
    v_cvt_pk_bf16_f32 v238, v192, v193
    v_cvt_pk_bf16_f32 v239, v194, v195
    buffer_store_dwordx4 v[236:239], v2, s[8:11], s26 offen
    s_mul_i32 s26, s23, 7
    s_add_u32 s26, s26, 6
    s_lshr_b32 s35, s26, 1
    s_lshl_b32 s35, s35, 2
    s_lshr_b32 s40, s22, 2
    s_add_u32 s35, s35, s40
    s_lshl_b32 s35, s35, 3
    s_and_b32 s40, s22, 3
    s_lshl_b32 s40, s40, 1
    s_add_u32 s35, s35, s40
    s_and_b32 s40, s26, 1
    s_add_u32 s35, s35, s40
    s_mul_i32 s26, s35, 14336
    s_lshl_b32 s35, s34, 10
    s_add_u32 s26, s26, s35
    s_add_u32 s26, s26, 6815744
    v_cvt_pk_bf16_f32 v240, v168, v169
    v_cvt_pk_bf16_f32 v241, v170, v171
    v_cvt_pk_bf16_f32 v242, v196, v197
    v_cvt_pk_bf16_f32 v243, v198, v199
    buffer_store_dwordx4 v[240:243], v2, s[8:11], s26 offen
    s_nop 1
PWC_END:
    s_endpgm
PW_GA:
    v_mov_b32 v144, 0
    v_mov_b32 v145, 0
    v_mov_b32 v146, 0
    v_mov_b32 v147, 0
    v_mov_b32 v148, 0
    v_mov_b32 v149, 0
    v_mov_b32 v150, 0
    v_mov_b32 v151, 0
    v_mov_b32 v152, 0
    v_mov_b32 v153, 0
    v_mov_b32 v154, 0
    v_mov_b32 v155, 0
    v_mov_b32 v156, 0
    v_mov_b32 v157, 0
    v_mov_b32 v158, 0
    v_mov_b32 v159, 0
    v_mov_b32 v160, 0
    v_mov_b32 v161, 0
    v_mov_b32 v162, 0
    v_mov_b32 v163, 0
    v_mov_b32 v164, 0
    v_mov_b32 v165, 0
    v_mov_b32 v166, 0
    v_mov_b32 v167, 0
    v_mov_b32 v168, 0
    v_mov_b32 v169, 0
    v_mov_b32 v170, 0
    v_mov_b32 v171, 0
    v_mov_b32 v172, 0
    v_mov_b32 v173, 0
    v_mov_b32 v174, 0
    v_mov_b32 v175, 0
    v_mov_b32 v176, 0
    v_mov_b32 v177, 0
    v_mov_b32 v178, 0
    v_mov_b32 v179, 0
    v_mov_b32 v180, 0
    v_mov_b32 v181, 0
    v_mov_b32 v182, 0
    v_mov_b32 v183, 0
    v_mov_b32 v184, 0
    v_mov_b32 v185, 0
    v_mov_b32 v186, 0
    v_mov_b32 v187, 0
    v_mov_b32 v188, 0
    v_mov_b32 v189, 0
    v_mov_b32 v190, 0
    v_mov_b32 v191, 0
    v_mov_b32 v192, 0
    v_mov_b32 v193, 0
    v_mov_b32 v194, 0
    v_mov_b32 v195, 0
    v_mov_b32 v196, 0
    v_mov_b32 v197, 0
    v_mov_b32 v198, 0
    v_mov_b32 v199, 0
    ds_read_b128 v[200:203], v2 offset:0
    ds_read_b128 v[204:207], v2 offset:8192
    ds_read_b128 v[208:211], v2 offset:16384
    ds_read_b128 v[212:215], v2 offset:24576
    ds_read_b128 v[216:219], v2 offset:32768
    ds_read_b128 v[220:223], v2 offset:40960
    ds_read_b128 v[224:227], v2 offset:49152
    s_waitcnt lgkmcnt(6)
    v_mfma_f32_16x16x32_bf16 v[144:147], v[16:19], v[200:203], v[144:147]
    v_mfma_f32_16x16x32_bf16 v[172:175], v[48:51], v[200:203], v[172:175]
    ds_read_b128 v[228:231], v2 offset:1024
    s_waitcnt lgkmcnt(6)
    v_mfma_f32_16x16x32_bf16 v[148:151], v[16:19], v[204:207], v[148:151]
    v_mfma_f32_16x16x32_bf16 v[176:179], v[48:51], v[204:207], v[176:179]
    ds_read_b128 v[200:203], v2 offset:9216
    s_waitcnt lgkmcnt(6)
    v_mfma_f32_16x16x32_bf16 v[152:155], v[16:19], v[208:211], v[152:155]
    v_mfma_f32_16x16x32_bf16 v[180:183], v[48:51], v[208:211], v[180:183]
    ds_read_b128 v[204:207], v2 offset:17408
    s_waitcnt lgkmcnt(6)
    v_mfma_f32_16x16x32_bf16 v[156:159], v[16:19], v[212:215], v[156:159]
    v_mfma_f32_16x16x32_bf16 v[184:187], v[48:51], v[212:215], v[184:187]
    ds_read_b128 v[208:211], v2 offset:25600
    s_waitcnt lgkmcnt(6)
    v_mfma_f32_16x16x32_bf16 v[160:163], v[16:19], v[216:219], v[160:163]
    v_mfma_f32_16x16x32_bf16 v[188:191], v[48:51], v[216:219], v[188:191]
    ds_read_b128 v[212:215], v2 offset:33792
    s_waitcnt lgkmcnt(6)
    v_mfma_f32_16x16x32_bf16 v[164:167], v[16:19], v[220:223], v[164:167]
    v_mfma_f32_16x16x32_bf16 v[192:195], v[48:51], v[220:223], v[192:195]
    ds_read_b128 v[216:219], v2 offset:41984
    s_waitcnt lgkmcnt(6)
    v_mfma_f32_16x16x32_bf16 v[168:171], v[16:19], v[224:227], v[168:171]
    v_mfma_f32_16x16x32_bf16 v[196:199], v[48:51], v[224:227], v[196:199]
    ds_read_b128 v[220:223], v2 offset:50176
    s_waitcnt lgkmcnt(6)
    v_mfma_f32_16x16x32_bf16 v[144:147], v[20:23], v[228:231], v[144:147]
    v_mfma_f32_16x16x32_bf16 v[172:175], v[52:55], v[228:231], v[172:175]
    ds_read_b128 v[224:227], v2 offset:2048
    s_waitcnt lgkmcnt(6)
    v_mfma_f32_16x16x32_bf16 v[148:151], v[20:23], v[200:203], v[148:151]
    v_mfma_f32_16x16x32_bf16 v[176:179], v[52:55], v[200:203], v[176:179]
    ds_read_b128 v[228:231], v2 offset:10240
    s_waitcnt lgkmcnt(6)
    v_mfma_f32_16x16x32_bf16 v[152:155], v[20:23], v[204:207], v[152:155]
    v_mfma_f32_16x16x32_bf16 v[180:183], v[52:55], v[204:207], v[180:183]
    ds_read_b128 v[200:203], v2 offset:18432
    s_waitcnt lgkmcnt(6)
    v_mfma_f32_16x16x32_bf16 v[156:159], v[20:23], v[208:211], v[156:159]
    v_mfma_f32_16x16x32_bf16 v[184:187], v[52:55], v[208:211], v[184:187]
    ds_read_b128 v[204:207], v2 offset:26624
    s_waitcnt lgkmcnt(6)
    v_mfma_f32_16x16x32_bf16 v[160:163], v[20:23], v[212:215], v[160:163]
    v_mfma_f32_16x16x32_bf16 v[188:191], v[52:55], v[212:215], v[188:191]
    ds_read_b128 v[208:211], v2 offset:34816
    s_waitcnt lgkmcnt(6)
    v_mfma_f32_16x16x32_bf16 v[164:167], v[20:23], v[216:219], v[164:167]
    v_mfma_f32_16x16x32_bf16 v[192:195], v[52:55], v[216:219], v[192:195]
    ds_read_b128 v[212:215], v2 offset:43008
    s_waitcnt lgkmcnt(6)
    v_mfma_f32_16x16x32_bf16 v[168:171], v[20:23], v[220:223], v[168:171]
    v_mfma_f32_16x16x32_bf16 v[196:199], v[52:55], v[220:223], v[196:199]
    ds_read_b128 v[216:219], v2 offset:51200
    s_waitcnt lgkmcnt(6)
    v_mfma_f32_16x16x32_bf16 v[144:147], v[24:27], v[224:227], v[144:147]
    v_mfma_f32_16x16x32_bf16 v[172:175], v[56:59], v[224:227], v[172:175]
    ds_read_b128 v[220:223], v2 offset:3072
    s_waitcnt lgkmcnt(6)
    v_mfma_f32_16x16x32_bf16 v[148:151], v[24:27], v[228:231], v[148:151]
    v_mfma_f32_16x16x32_bf16 v[176:179], v[56:59], v[228:231], v[176:179]
    ds_read_b128 v[224:227], v2 offset:11264
    s_waitcnt lgkmcnt(6)
    v_mfma_f32_16x16x32_bf16 v[152:155], v[24:27], v[200:203], v[152:155]
    v_mfma_f32_16x16x32_bf16 v[180:183], v[56:59], v[200:203], v[180:183]
    ds_read_b128 v[228:231], v2 offset:19456
    s_waitcnt lgkmcnt(6)
    v_mfma_f32_16x16x32_bf16 v[156:159], v[24:27], v[204:207], v[156:159]
    v_mfma_f32_16x16x32_bf16 v[184:187], v[56:59], v[204:207], v[184:187]
    ds_read_b128 v[200:203], v2 offset:27648
    s_waitcnt lgkmcnt(6)
    v_mfma_f32_16x16x32_bf16 v[160:163], v[24:27], v[208:211], v[160:163]
    v_mfma_f32_16x16x32_bf16 v[188:191], v[56:59], v[208:211], v[188:191]
    ds_read_b128 v[204:207], v2 offset:35840
    s_waitcnt lgkmcnt(6)
    v_mfma_f32_16x16x32_bf16 v[164:167], v[24:27], v[212:215], v[164:167]
    v_mfma_f32_16x16x32_bf16 v[192:195], v[56:59], v[212:215], v[192:195]
    ds_read_b128 v[208:211], v2 offset:44032
    s_waitcnt lgkmcnt(6)
    v_mfma_f32_16x16x32_bf16 v[168:171], v[24:27], v[216:219], v[168:171]
    v_mfma_f32_16x16x32_bf16 v[196:199], v[56:59], v[216:219], v[196:199]
    ds_read_b128 v[212:215], v2 offset:52224
    s_waitcnt lgkmcnt(6)
    v_mfma_f32_16x16x32_bf16 v[144:147], v[28:31], v[220:223], v[144:147]
    v_mfma_f32_16x16x32_bf16 v[172:175], v[60:63], v[220:223], v[172:175]
    ds_read_b128 v[216:219], v2 offset:4096
    s_waitcnt lgkmcnt(6)
    v_mfma_f32_16x16x32_bf16 v[148:151], v[28:31], v[224:227], v[148:151]
    v_mfma_f32_16x16x32_bf16 v[176:179], v[60:63], v[224:227], v[176:179]
    ds_read_b128 v[220:223], v2 offset:12288
    s_waitcnt lgkmcnt(6)
    v_mfma_f32_16x16x32_bf16 v[152:155], v[28:31], v[228:231], v[152:155]
    v_mfma_f32_16x16x32_bf16 v[180:183], v[60:63], v[228:231], v[180:183]
    ds_read_b128 v[224:227], v2 offset:20480
    s_waitcnt lgkmcnt(6)
    v_mfma_f32_16x16x32_bf16 v[156:159], v[28:31], v[200:203], v[156:159]
    v_mfma_f32_16x16x32_bf16 v[184:187], v[60:63], v[200:203], v[184:187]
    ds_read_b128 v[228:231], v2 offset:28672
    s_waitcnt lgkmcnt(6)
    v_mfma_f32_16x16x32_bf16 v[160:163], v[28:31], v[204:207], v[160:163]
    v_mfma_f32_16x16x32_bf16 v[188:191], v[60:63], v[204:207], v[188:191]
    ds_read_b128 v[200:203], v2 offset:36864
    s_waitcnt lgkmcnt(6)
    v_mfma_f32_16x16x32_bf16 v[164:167], v[28:31], v[208:211], v[164:167]
    v_mfma_f32_16x16x32_bf16 v[192:195], v[60:63], v[208:211], v[192:195]
    ds_read_b128 v[204:207], v2 offset:45056
    s_waitcnt lgkmcnt(6)
    v_mfma_f32_16x16x32_bf16 v[168:171], v[28:31], v[212:215], v[168:171]
    v_mfma_f32_16x16x32_bf16 v[196:199], v[60:63], v[212:215], v[196:199]
    ds_read_b128 v[208:211], v2 offset:53248
    s_waitcnt lgkmcnt(6)
    v_mfma_f32_16x16x32_bf16 v[144:147], v[32:35], v[216:219], v[144:147]
    v_mfma_f32_16x16x32_bf16 v[172:175], v[64:67], v[216:219], v[172:175]
    ds_read_b128 v[212:215], v2 offset:5120
    s_waitcnt lgkmcnt(6)
    v_mfma_f32_16x16x32_bf16 v[148:151], v[32:35], v[220:223], v[148:151]
    v_mfma_f32_16x16x32_bf16 v[176:179], v[64:67], v[220:223], v[176:179]
    ds_read_b128 v[216:219], v2 offset:13312
    s_waitcnt lgkmcnt(6)
    v_mfma_f32_16x16x32_bf16 v[152:155], v[32:35], v[224:227], v[152:155]
    v_mfma_f32_16x16x32_bf16 v[180:183], v[64:67], v[224:227], v[180:183]
    ds_read_b128 v[220:223], v2 offset:21504
    s_waitcnt lgkmcnt(6)
    v_mfma_f32_16x16x32_bf16 v[156:159], v[32:35], v[228:231], v[156:159]
    v_mfma_f32_16x16x32_bf16 v[184:187], v[64:67], v[228:231], v[184:187]
    ds_read_b128 v[224:227], v2 offset:29696
    s_waitcnt lgkmcnt(6)
    v_mfma_f32_16x16x32_bf16 v[160:163], v[32:35], v[200:203], v[160:163]
    v_mfma_f32_16x16x32_bf16 v[188:191], v[64:67], v[200:203], v[188:191]
    ds_read_b128 v[228:231], v2 offset:37888
    s_waitcnt lgkmcnt(6)
    v_mfma_f32_16x16x32_bf16 v[164:167], v[32:35], v[204:207], v[164:167]
    v_mfma_f32_16x16x32_bf16 v[192:195], v[64:67], v[204:207], v[192:195]
    ds_read_b128 v[200:203], v2 offset:46080
    s_waitcnt lgkmcnt(6)
    v_mfma_f32_16x16x32_bf16 v[168:171], v[32:35], v[208:211], v[168:171]
    v_mfma_f32_16x16x32_bf16 v[196:199], v[64:67], v[208:211], v[196:199]
    ds_read_b128 v[204:207], v2 offset:54272
    s_waitcnt lgkmcnt(6)
    v_mfma_f32_16x16x32_bf16 v[144:147], v[36:39], v[212:215], v[144:147]
    v_mfma_f32_16x16x32_bf16 v[172:175], v[68:71], v[212:215], v[172:175]
    ds_read_b128 v[208:211], v2 offset:6144
    s_waitcnt lgkmcnt(6)
    v_mfma_f32_16x16x32_bf16 v[148:151], v[36:39], v[216:219], v[148:151]
    v_mfma_f32_16x16x32_bf16 v[176:179], v[68:71], v[216:219], v[176:179]
    ds_read_b128 v[212:215], v2 offset:14336
    s_waitcnt lgkmcnt(6)
    v_mfma_f32_16x16x32_bf16 v[152:155], v[36:39], v[220:223], v[152:155]
    v_mfma_f32_16x16x32_bf16 v[180:183], v[68:71], v[220:223], v[180:183]
    ds_read_b128 v[216:219], v2 offset:22528
    s_waitcnt lgkmcnt(6)
    v_mfma_f32_16x16x32_bf16 v[156:159], v[36:39], v[224:227], v[156:159]
    v_mfma_f32_16x16x32_bf16 v[184:187], v[68:71], v[224:227], v[184:187]
    ds_read_b128 v[220:223], v2 offset:30720
    s_waitcnt lgkmcnt(6)
    v_mfma_f32_16x16x32_bf16 v[160:163], v[36:39], v[228:231], v[160:163]
    v_mfma_f32_16x16x32_bf16 v[188:191], v[68:71], v[228:231], v[188:191]
    ds_read_b128 v[224:227], v2 offset:38912
    s_waitcnt lgkmcnt(6)
    v_mfma_f32_16x16x32_bf16 v[164:167], v[36:39], v[200:203], v[164:167]
    v_mfma_f32_16x16x32_bf16 v[192:195], v[68:71], v[200:203], v[192:195]
    ds_read_b128 v[228:231], v2 offset:47104
    s_waitcnt lgkmcnt(6)
    v_mfma_f32_16x16x32_bf16 v[168:171], v[36:39], v[204:207], v[168:171]
    v_mfma_f32_16x16x32_bf16 v[196:199], v[68:71], v[204:207], v[196:199]
    ds_read_b128 v[200:203], v2 offset:55296
    s_waitcnt lgkmcnt(6)
    v_mfma_f32_16x16x32_bf16 v[144:147], v[40:43], v[208:211], v[144:147]
    v_mfma_f32_16x16x32_bf16 v[172:175], v[72:75], v[208:211], v[172:175]
    ds_read_b128 v[204:207], v2 offset:7168
    s_waitcnt lgkmcnt(6)
    v_mfma_f32_16x16x32_bf16 v[148:151], v[40:43], v[212:215], v[148:151]
    v_mfma_f32_16x16x32_bf16 v[176:179], v[72:75], v[212:215], v[176:179]
    ds_read_b128 v[208:211], v2 offset:15360
    s_waitcnt lgkmcnt(6)
    v_mfma_f32_16x16x32_bf16 v[152:155], v[40:43], v[216:219], v[152:155]
    v_mfma_f32_16x16x32_bf16 v[180:183], v[72:75], v[216:219], v[180:183]
    ds_read_b128 v[212:215], v2 offset:23552
    s_waitcnt lgkmcnt(6)
    v_mfma_f32_16x16x32_bf16 v[156:159], v[40:43], v[220:223], v[156:159]
    v_mfma_f32_16x16x32_bf16 v[184:187], v[72:75], v[220:223], v[184:187]
    ds_read_b128 v[216:219], v2 offset:31744
    s_waitcnt lgkmcnt(6)
    v_mfma_f32_16x16x32_bf16 v[160:163], v[40:43], v[224:227], v[160:163]
    v_mfma_f32_16x16x32_bf16 v[188:191], v[72:75], v[224:227], v[188:191]
    ds_read_b128 v[220:223], v2 offset:39936
    s_waitcnt lgkmcnt(6)
    v_mfma_f32_16x16x32_bf16 v[164:167], v[40:43], v[228:231], v[164:167]
    v_mfma_f32_16x16x32_bf16 v[192:195], v[72:75], v[228:231], v[192:195]
    ds_read_b128 v[224:227], v2 offset:48128
    s_waitcnt lgkmcnt(6)
    v_mfma_f32_16x16x32_bf16 v[168:171], v[40:43], v[200:203], v[168:171]
    v_mfma_f32_16x16x32_bf16 v[196:199], v[72:75], v[200:203], v[196:199]
    ds_read_b128 v[228:231], v2 offset:56320
    s_waitcnt lgkmcnt(6)
    v_mfma_f32_16x16x32_bf16 v[144:147], v[44:47], v[204:207], v[144:147]
    v_mfma_f32_16x16x32_bf16 v[172:175], v[76:79], v[204:207], v[172:175]
    s_waitcnt lgkmcnt(5)
    v_mfma_f32_16x16x32_bf16 v[148:151], v[44:47], v[208:211], v[148:151]
    v_mfma_f32_16x16x32_bf16 v[176:179], v[76:79], v[208:211], v[176:179]
    s_waitcnt lgkmcnt(4)
    v_mfma_f32_16x16x32_bf16 v[152:155], v[44:47], v[212:215], v[152:155]
    v_mfma_f32_16x16x32_bf16 v[180:183], v[76:79], v[212:215], v[180:183]
    s_waitcnt lgkmcnt(3)
    v_mfma_f32_16x16x32_bf16 v[156:159], v[44:47], v[216:219], v[156:159]
    v_mfma_f32_16x16x32_bf16 v[184:187], v[76:79], v[216:219], v[184:187]
    s_waitcnt lgkmcnt(2)
    v_mfma_f32_16x16x32_bf16 v[160:163], v[44:47], v[220:223], v[160:163]
    v_mfma_f32_16x16x32_bf16 v[188:191], v[76:79], v[220:223], v[188:191]
    s_waitcnt lgkmcnt(1)
    v_mfma_f32_16x16x32_bf16 v[164:167], v[44:47], v[224:227], v[164:167]
    v_mfma_f32_16x16x32_bf16 v[192:195], v[76:79], v[224:227], v[192:195]
    s_waitcnt lgkmcnt(0)
    v_mfma_f32_16x16x32_bf16 v[168:171], v[44:47], v[228:231], v[168:171]
    v_mfma_f32_16x16x32_bf16 v[196:199], v[76:79], v[228:231], v[196:199]
    s_mov_b32 s27, 1035512379
    v_mul_f32 v144, s27, v144
    v_mul_f32 v145, s27, v145
    v_mul_f32 v146, s27, v146
    v_mul_f32 v147, s27, v147
    v_mul_f32 v148, s27, v148
    v_mul_f32 v149, s27, v149
    v_mul_f32 v150, s27, v150
    v_mul_f32 v151, s27, v151
    v_mul_f32 v152, s27, v152
    v_mul_f32 v153, s27, v153
    v_mul_f32 v154, s27, v154
    v_mul_f32 v155, s27, v155
    v_mul_f32 v156, s27, v156
    v_mul_f32 v157, s27, v157
    v_mul_f32 v158, s27, v158
    v_mul_f32 v159, s27, v159
    v_mul_f32 v160, s27, v160
    v_mul_f32 v161, s27, v161
    v_mul_f32 v162, s27, v162
    v_mul_f32 v163, s27, v163
    v_mul_f32 v164, s27, v164
    v_mul_f32 v165, s27, v165
    v_mul_f32 v166, s27, v166
    v_mul_f32 v167, s27, v167
    v_mul_f32 v168, s27, v168
    v_mul_f32 v169, s27, v169
    v_mul_f32 v170, s27, v170
    v_mul_f32 v171, s27, v171
    v_mul_f32 v172, s27, v172
    v_mul_f32 v173, s27, v173
    v_mul_f32 v174, s27, v174
    v_mul_f32 v175, s27, v175
    v_mul_f32 v176, s27, v176
    v_mul_f32 v177, s27, v177
    v_mul_f32 v178, s27, v178
    v_mul_f32 v179, s27, v179
    v_mul_f32 v180, s27, v180
    v_mul_f32 v181, s27, v181
    v_mul_f32 v182, s27, v182
    v_mul_f32 v183, s27, v183
    v_mul_f32 v184, s27, v184
    v_mul_f32 v185, s27, v185
    v_mul_f32 v186, s27, v186
    v_mul_f32 v187, s27, v187
    v_mul_f32 v188, s27, v188
    v_mul_f32 v189, s27, v189
    v_mul_f32 v190, s27, v190
    v_mul_f32 v191, s27, v191
    v_mul_f32 v192, s27, v192
    v_mul_f32 v193, s27, v193
    v_mul_f32 v194, s27, v194
    v_mul_f32 v195, s27, v195
    v_mul_f32 v196, s27, v196
    v_mul_f32 v197, s27, v197
    v_mul_f32 v198, s27, v198
    v_mul_f32 v199, s27, v199
    s_lshl_b32 s26, s22, 2
    s_add_u32 s26, s26, s23
    s_mul_i32 s26, s26, 100352
    s_lshl_b32 s35, s25, 10
    s_add_u32 s26, s26, s35
    s_add_u32 s26, s26, 0
    v_cvt_pk_bf16_f32 v232, v144, v145
    v_cvt_pk_bf16_f32 v233, v146, v147
    v_cvt_pk_bf16_f32 v234, v172, v173
    v_cvt_pk_bf16_f32 v235, v174, v175
    buffer_store_dwordx4 v[232:235], v2, s[8:11], s26 offen
    s_add_u32 s26, s26, 14336
    v_cvt_pk_bf16_f32 v236, v148, v149
    v_cvt_pk_bf16_f32 v237, v150, v151
    v_cvt_pk_bf16_f32 v238, v176, v177
    v_cvt_pk_bf16_f32 v239, v178, v179
    buffer_store_dwordx4 v[236:239], v2, s[8:11], s26 offen
    s_add_u32 s26, s26, 14336
    v_cvt_pk_bf16_f32 v240, v152, v153
    v_cvt_pk_bf16_f32 v241, v154, v155
    v_cvt_pk_bf16_f32 v242, v180, v181
    v_cvt_pk_bf16_f32 v243, v182, v183
    buffer_store_dwordx4 v[240:243], v2, s[8:11], s26 offen
    s_add_u32 s26, s26, 14336
    v_cvt_pk_bf16_f32 v244, v156, v157
    v_cvt_pk_bf16_f32 v245, v158, v159
    v_cvt_pk_bf16_f32 v246, v184, v185
    v_cvt_pk_bf16_f32 v247, v186, v187
    buffer_store_dwordx4 v[244:247], v2, s[8:11], s26 offen
    s_add_u32 s26, s26, 14336
    v_cvt_pk_bf16_f32 v232, v160, v161
    v_cvt_pk_bf16_f32 v233, v162, v163
    v_cvt_pk_bf16_f32 v234, v188, v189
    v_cvt_pk_bf16_f32 v235, v190, v191
    buffer_store_dwordx4 v[232:235], v2, s[8:11], s26 offen
    s_add_u32 s26, s26, 14336
    v_cvt_pk_bf16_f32 v236, v164, v165
    v_cvt_pk_bf16_f32 v237, v166, v167
    v_cvt_pk_bf16_f32 v238, v192, v193
    v_cvt_pk_bf16_f32 v239, v194, v195
    buffer_store_dwordx4 v[236:239], v2, s[8:11], s26 offen
    s_add_u32 s26, s26, 14336
    v_cvt_pk_bf16_f32 v240, v168, v169
    v_cvt_pk_bf16_f32 v241, v170, v171
    v_cvt_pk_bf16_f32 v242, v196, v197
    v_cvt_pk_bf16_f32 v243, v198, v199
    buffer_store_dwordx4 v[240:243], v2, s[8:11], s26 offen
    s_add_u32 s26, s26, 14336
    s_cmp_ge_u32 s18, 3
    s_cbranch_scc1 PWA_END
    v_mov_b32 v144, 0
    v_mov_b32 v145, 0
    v_mov_b32 v146, 0
    v_mov_b32 v147, 0
    v_mov_b32 v148, 0
    v_mov_b32 v149, 0
    v_mov_b32 v150, 0
    v_mov_b32 v151, 0
    v_mov_b32 v152, 0
    v_mov_b32 v153, 0
    v_mov_b32 v154, 0
    v_mov_b32 v155, 0
    v_mov_b32 v156, 0
    v_mov_b32 v157, 0
    v_mov_b32 v158, 0
    v_mov_b32 v159, 0
    v_mov_b32 v160, 0
    v_mov_b32 v161, 0
    v_mov_b32 v162, 0
    v_mov_b32 v163, 0
    v_mov_b32 v164, 0
    v_mov_b32 v165, 0
    v_mov_b32 v166, 0
    v_mov_b32 v167, 0
    v_mov_b32 v168, 0
    v_mov_b32 v169, 0
    v_mov_b32 v170, 0
    v_mov_b32 v171, 0
    v_mov_b32 v172, 0
    v_mov_b32 v173, 0
    v_mov_b32 v174, 0
    v_mov_b32 v175, 0
    v_mov_b32 v176, 0
    v_mov_b32 v177, 0
    v_mov_b32 v178, 0
    v_mov_b32 v179, 0
    v_mov_b32 v180, 0
    v_mov_b32 v181, 0
    v_mov_b32 v182, 0
    v_mov_b32 v183, 0
    v_mov_b32 v184, 0
    v_mov_b32 v185, 0
    v_mov_b32 v186, 0
    v_mov_b32 v187, 0
    v_mov_b32 v188, 0
    v_mov_b32 v189, 0
    v_mov_b32 v190, 0
    v_mov_b32 v191, 0
    v_mov_b32 v192, 0
    v_mov_b32 v193, 0
    v_mov_b32 v194, 0
    v_mov_b32 v195, 0
    v_mov_b32 v196, 0
    v_mov_b32 v197, 0
    v_mov_b32 v198, 0
    v_mov_b32 v199, 0
    ds_read_b128 v[200:203], v2 offset:0
    ds_read_b128 v[204:207], v2 offset:8192
    ds_read_b128 v[208:211], v2 offset:16384
    ds_read_b128 v[212:215], v2 offset:24576
    ds_read_b128 v[216:219], v2 offset:32768
    ds_read_b128 v[220:223], v2 offset:40960
    ds_read_b128 v[224:227], v2 offset:49152
    s_waitcnt lgkmcnt(6)
    v_mfma_f32_16x16x32_bf16 v[144:147], v[80:83], v[200:203], v[144:147]
    v_mfma_f32_16x16x32_bf16 v[172:175], v[112:115], v[200:203], v[172:175]
    ds_read_b128 v[228:231], v2 offset:1024
    s_waitcnt lgkmcnt(6)
    v_mfma_f32_16x16x32_bf16 v[148:151], v[80:83], v[204:207], v[148:151]
    v_mfma_f32_16x16x32_bf16 v[176:179], v[112:115], v[204:207], v[176:179]
    ds_read_b128 v[200:203], v2 offset:9216
    s_waitcnt lgkmcnt(6)
    v_mfma_f32_16x16x32_bf16 v[152:155], v[80:83], v[208:211], v[152:155]
    v_mfma_f32_16x16x32_bf16 v[180:183], v[112:115], v[208:211], v[180:183]
    ds_read_b128 v[204:207], v2 offset:17408
    s_waitcnt lgkmcnt(6)
    v_mfma_f32_16x16x32_bf16 v[156:159], v[80:83], v[212:215], v[156:159]
    v_mfma_f32_16x16x32_bf16 v[184:187], v[112:115], v[212:215], v[184:187]
    ds_read_b128 v[208:211], v2 offset:25600
    s_waitcnt lgkmcnt(6)
    v_mfma_f32_16x16x32_bf16 v[160:163], v[80:83], v[216:219], v[160:163]
    v_mfma_f32_16x16x32_bf16 v[188:191], v[112:115], v[216:219], v[188:191]
    ds_read_b128 v[212:215], v2 offset:33792
    s_waitcnt lgkmcnt(6)
    v_mfma_f32_16x16x32_bf16 v[164:167], v[80:83], v[220:223], v[164:167]
    v_mfma_f32_16x16x32_bf16 v[192:195], v[112:115], v[220:223], v[192:195]
    ds_read_b128 v[216:219], v2 offset:41984
    s_waitcnt lgkmcnt(6)
    v_mfma_f32_16x16x32_bf16 v[168:171], v[80:83], v[224:227], v[168:171]
    v_mfma_f32_16x16x32_bf16 v[196:199], v[112:115], v[224:227], v[196:199]
    ds_read_b128 v[220:223], v2 offset:50176
    s_waitcnt lgkmcnt(6)
    v_mfma_f32_16x16x32_bf16 v[144:147], v[84:87], v[228:231], v[144:147]
    v_mfma_f32_16x16x32_bf16 v[172:175], v[116:119], v[228:231], v[172:175]
    ds_read_b128 v[224:227], v2 offset:2048
    s_waitcnt lgkmcnt(6)
    v_mfma_f32_16x16x32_bf16 v[148:151], v[84:87], v[200:203], v[148:151]
    v_mfma_f32_16x16x32_bf16 v[176:179], v[116:119], v[200:203], v[176:179]
    ds_read_b128 v[228:231], v2 offset:10240
    s_waitcnt lgkmcnt(6)
    v_mfma_f32_16x16x32_bf16 v[152:155], v[84:87], v[204:207], v[152:155]
    v_mfma_f32_16x16x32_bf16 v[180:183], v[116:119], v[204:207], v[180:183]
    ds_read_b128 v[200:203], v2 offset:18432
    s_waitcnt lgkmcnt(6)
    v_mfma_f32_16x16x32_bf16 v[156:159], v[84:87], v[208:211], v[156:159]
    v_mfma_f32_16x16x32_bf16 v[184:187], v[116:119], v[208:211], v[184:187]
    ds_read_b128 v[204:207], v2 offset:26624
    s_waitcnt lgkmcnt(6)
    v_mfma_f32_16x16x32_bf16 v[160:163], v[84:87], v[212:215], v[160:163]
    v_mfma_f32_16x16x32_bf16 v[188:191], v[116:119], v[212:215], v[188:191]
    ds_read_b128 v[208:211], v2 offset:34816
    s_waitcnt lgkmcnt(6)
    v_mfma_f32_16x16x32_bf16 v[164:167], v[84:87], v[216:219], v[164:167]
    v_mfma_f32_16x16x32_bf16 v[192:195], v[116:119], v[216:219], v[192:195]
    ds_read_b128 v[212:215], v2 offset:43008
    s_waitcnt lgkmcnt(6)
    v_mfma_f32_16x16x32_bf16 v[168:171], v[84:87], v[220:223], v[168:171]
    v_mfma_f32_16x16x32_bf16 v[196:199], v[116:119], v[220:223], v[196:199]
    ds_read_b128 v[216:219], v2 offset:51200
    s_waitcnt lgkmcnt(6)
    v_mfma_f32_16x16x32_bf16 v[144:147], v[88:91], v[224:227], v[144:147]
    v_mfma_f32_16x16x32_bf16 v[172:175], v[120:123], v[224:227], v[172:175]
    ds_read_b128 v[220:223], v2 offset:3072
    s_waitcnt lgkmcnt(6)
    v_mfma_f32_16x16x32_bf16 v[148:151], v[88:91], v[228:231], v[148:151]
    v_mfma_f32_16x16x32_bf16 v[176:179], v[120:123], v[228:231], v[176:179]
    ds_read_b128 v[224:227], v2 offset:11264
    s_waitcnt lgkmcnt(6)
    v_mfma_f32_16x16x32_bf16 v[152:155], v[88:91], v[200:203], v[152:155]
    v_mfma_f32_16x16x32_bf16 v[180:183], v[120:123], v[200:203], v[180:183]
    ds_read_b128 v[228:231], v2 offset:19456
    s_waitcnt lgkmcnt(6)
    v_mfma_f32_16x16x32_bf16 v[156:159], v[88:91], v[204:207], v[156:159]
    v_mfma_f32_16x16x32_bf16 v[184:187], v[120:123], v[204:207], v[184:187]
    ds_read_b128 v[200:203], v2 offset:27648
    s_waitcnt lgkmcnt(6)
    v_mfma_f32_16x16x32_bf16 v[160:163], v[88:91], v[208:211], v[160:163]
    v_mfma_f32_16x16x32_bf16 v[188:191], v[120:123], v[208:211], v[188:191]
    ds_read_b128 v[204:207], v2 offset:35840
    s_waitcnt lgkmcnt(6)
    v_mfma_f32_16x16x32_bf16 v[164:167], v[88:91], v[212:215], v[164:167]
    v_mfma_f32_16x16x32_bf16 v[192:195], v[120:123], v[212:215], v[192:195]
    ds_read_b128 v[208:211], v2 offset:44032
    s_waitcnt lgkmcnt(6)
    v_mfma_f32_16x16x32_bf16 v[168:171], v[88:91], v[216:219], v[168:171]
    v_mfma_f32_16x16x32_bf16 v[196:199], v[120:123], v[216:219], v[196:199]
    ds_read_b128 v[212:215], v2 offset:52224
    s_waitcnt lgkmcnt(6)
    v_mfma_f32_16x16x32_bf16 v[144:147], v[92:95], v[220:223], v[144:147]
    v_mfma_f32_16x16x32_bf16 v[172:175], v[124:127], v[220:223], v[172:175]
    ds_read_b128 v[216:219], v2 offset:4096
    s_waitcnt lgkmcnt(6)
    v_mfma_f32_16x16x32_bf16 v[148:151], v[92:95], v[224:227], v[148:151]
    v_mfma_f32_16x16x32_bf16 v[176:179], v[124:127], v[224:227], v[176:179]
    ds_read_b128 v[220:223], v2 offset:12288
    s_waitcnt lgkmcnt(6)
    v_mfma_f32_16x16x32_bf16 v[152:155], v[92:95], v[228:231], v[152:155]
    v_mfma_f32_16x16x32_bf16 v[180:183], v[124:127], v[228:231], v[180:183]
    ds_read_b128 v[224:227], v2 offset:20480
    s_waitcnt lgkmcnt(6)
    v_mfma_f32_16x16x32_bf16 v[156:159], v[92:95], v[200:203], v[156:159]
    v_mfma_f32_16x16x32_bf16 v[184:187], v[124:127], v[200:203], v[184:187]
    ds_read_b128 v[228:231], v2 offset:28672
    s_waitcnt lgkmcnt(6)
    v_mfma_f32_16x16x32_bf16 v[160:163], v[92:95], v[204:207], v[160:163]
    v_mfma_f32_16x16x32_bf16 v[188:191], v[124:127], v[204:207], v[188:191]
    ds_read_b128 v[200:203], v2 offset:36864
    s_waitcnt lgkmcnt(6)
    v_mfma_f32_16x16x32_bf16 v[164:167], v[92:95], v[208:211], v[164:167]
    v_mfma_f32_16x16x32_bf16 v[192:195], v[124:127], v[208:211], v[192:195]
    ds_read_b128 v[204:207], v2 offset:45056
    s_waitcnt lgkmcnt(6)
    v_mfma_f32_16x16x32_bf16 v[168:171], v[92:95], v[212:215], v[168:171]
    v_mfma_f32_16x16x32_bf16 v[196:199], v[124:127], v[212:215], v[196:199]
    ds_read_b128 v[208:211], v2 offset:53248
    s_waitcnt lgkmcnt(6)
    v_mfma_f32_16x16x32_bf16 v[144:147], v[96:99], v[216:219], v[144:147]
    v_mfma_f32_16x16x32_bf16 v[172:175], v[128:131], v[216:219], v[172:175]
    ds_read_b128 v[212:215], v2 offset:5120
    s_waitcnt lgkmcnt(6)
    v_mfma_f32_16x16x32_bf16 v[148:151], v[96:99], v[220:223], v[148:151]
    v_mfma_f32_16x16x32_bf16 v[176:179], v[128:131], v[220:223], v[176:179]
    ds_read_b128 v[216:219], v2 offset:13312
    s_waitcnt lgkmcnt(6)
    v_mfma_f32_16x16x32_bf16 v[152:155], v[96:99], v[224:227], v[152:155]
    v_mfma_f32_16x16x32_bf16 v[180:183], v[128:131], v[224:227], v[180:183]
    ds_read_b128 v[220:223], v2 offset:21504
    s_waitcnt lgkmcnt(6)
    v_mfma_f32_16x16x32_bf16 v[156:159], v[96:99], v[228:231], v[156:159]
    v_mfma_f32_16x16x32_bf16 v[184:187], v[128:131], v[228:231], v[184:187]
    ds_read_b128 v[224:227], v2 offset:29696
    s_waitcnt lgkmcnt(6)
    v_mfma_f32_16x16x32_bf16 v[160:163], v[96:99], v[200:203], v[160:163]
    v_mfma_f32_16x16x32_bf16 v[188:191], v[128:131], v[200:203], v[188:191]
    ds_read_b128 v[228:231], v2 offset:37888
    s_waitcnt lgkmcnt(6)
    v_mfma_f32_16x16x32_bf16 v[164:167], v[96:99], v[204:207], v[164:167]
    v_mfma_f32_16x16x32_bf16 v[192:195], v[128:131], v[204:207], v[192:195]
    ds_read_b128 v[200:203], v2 offset:46080
    s_waitcnt lgkmcnt(6)
    v_mfma_f32_16x16x32_bf16 v[168:171], v[96:99], v[208:211], v[168:171]
    v_mfma_f32_16x16x32_bf16 v[196:199], v[128:131], v[208:211], v[196:199]
    ds_read_b128 v[204:207], v2 offset:54272
    s_waitcnt lgkmcnt(6)
    v_mfma_f32_16x16x32_bf16 v[144:147], v[100:103], v[212:215], v[144:147]
    v_mfma_f32_16x16x32_bf16 v[172:175], v[132:135], v[212:215], v[172:175]
    ds_read_b128 v[208:211], v2 offset:6144
    s_waitcnt lgkmcnt(6)
    v_mfma_f32_16x16x32_bf16 v[148:151], v[100:103], v[216:219], v[148:151]
    v_mfma_f32_16x16x32_bf16 v[176:179], v[132:135], v[216:219], v[176:179]
    ds_read_b128 v[212:215], v2 offset:14336
    s_waitcnt lgkmcnt(6)
    v_mfma_f32_16x16x32_bf16 v[152:155], v[100:103], v[220:223], v[152:155]
    v_mfma_f32_16x16x32_bf16 v[180:183], v[132:135], v[220:223], v[180:183]
    ds_read_b128 v[216:219], v2 offset:22528
    s_waitcnt lgkmcnt(6)
    v_mfma_f32_16x16x32_bf16 v[156:159], v[100:103], v[224:227], v[156:159]
    v_mfma_f32_16x16x32_bf16 v[184:187], v[132:135], v[224:227], v[184:187]
    ds_read_b128 v[220:223], v2 offset:30720
    s_waitcnt lgkmcnt(6)
    v_mfma_f32_16x16x32_bf16 v[160:163], v[100:103], v[228:231], v[160:163]
    v_mfma_f32_16x16x32_bf16 v[188:191], v[132:135], v[228:231], v[188:191]
    ds_read_b128 v[224:227], v2 offset:38912
    s_waitcnt lgkmcnt(6)
    v_mfma_f32_16x16x32_bf16 v[164:167], v[100:103], v[200:203], v[164:167]
    v_mfma_f32_16x16x32_bf16 v[192:195], v[132:135], v[200:203], v[192:195]
    ds_read_b128 v[228:231], v2 offset:47104
    s_waitcnt lgkmcnt(6)
    v_mfma_f32_16x16x32_bf16 v[168:171], v[100:103], v[204:207], v[168:171]
    v_mfma_f32_16x16x32_bf16 v[196:199], v[132:135], v[204:207], v[196:199]
    ds_read_b128 v[200:203], v2 offset:55296
    s_waitcnt lgkmcnt(6)
    v_mfma_f32_16x16x32_bf16 v[144:147], v[104:107], v[208:211], v[144:147]
    v_mfma_f32_16x16x32_bf16 v[172:175], v[136:139], v[208:211], v[172:175]
    ds_read_b128 v[204:207], v2 offset:7168
    s_waitcnt lgkmcnt(6)
    v_mfma_f32_16x16x32_bf16 v[148:151], v[104:107], v[212:215], v[148:151]
    v_mfma_f32_16x16x32_bf16 v[176:179], v[136:139], v[212:215], v[176:179]
    ds_read_b128 v[208:211], v2 offset:15360
    s_waitcnt lgkmcnt(6)
    v_mfma_f32_16x16x32_bf16 v[152:155], v[104:107], v[216:219], v[152:155]
    v_mfma_f32_16x16x32_bf16 v[180:183], v[136:139], v[216:219], v[180:183]
    ds_read_b128 v[212:215], v2 offset:23552
    s_waitcnt lgkmcnt(6)
    v_mfma_f32_16x16x32_bf16 v[156:159], v[104:107], v[220:223], v[156:159]
    v_mfma_f32_16x16x32_bf16 v[184:187], v[136:139], v[220:223], v[184:187]
    ds_read_b128 v[216:219], v2 offset:31744
    s_waitcnt lgkmcnt(6)
    v_mfma_f32_16x16x32_bf16 v[160:163], v[104:107], v[224:227], v[160:163]
    v_mfma_f32_16x16x32_bf16 v[188:191], v[136:139], v[224:227], v[188:191]
    ds_read_b128 v[220:223], v2 offset:39936
    s_waitcnt lgkmcnt(6)
    v_mfma_f32_16x16x32_bf16 v[164:167], v[104:107], v[228:231], v[164:167]
    v_mfma_f32_16x16x32_bf16 v[192:195], v[136:139], v[228:231], v[192:195]
    ds_read_b128 v[224:227], v2 offset:48128
    s_waitcnt lgkmcnt(6)
    v_mfma_f32_16x16x32_bf16 v[168:171], v[104:107], v[200:203], v[168:171]
    v_mfma_f32_16x16x32_bf16 v[196:199], v[136:139], v[200:203], v[196:199]
    ds_read_b128 v[228:231], v2 offset:56320
    s_waitcnt lgkmcnt(6)
    v_mfma_f32_16x16x32_bf16 v[144:147], v[108:111], v[204:207], v[144:147]
    v_mfma_f32_16x16x32_bf16 v[172:175], v[140:143], v[204:207], v[172:175]
    s_waitcnt lgkmcnt(5)
    v_mfma_f32_16x16x32_bf16 v[148:151], v[108:111], v[208:211], v[148:151]
    v_mfma_f32_16x16x32_bf16 v[176:179], v[140:143], v[208:211], v[176:179]
    s_waitcnt lgkmcnt(4)
    v_mfma_f32_16x16x32_bf16 v[152:155], v[108:111], v[212:215], v[152:155]
    v_mfma_f32_16x16x32_bf16 v[180:183], v[140:143], v[212:215], v[180:183]
    s_waitcnt lgkmcnt(3)
    v_mfma_f32_16x16x32_bf16 v[156:159], v[108:111], v[216:219], v[156:159]
    v_mfma_f32_16x16x32_bf16 v[184:187], v[140:143], v[216:219], v[184:187]
    s_waitcnt lgkmcnt(2)
    v_mfma_f32_16x16x32_bf16 v[160:163], v[108:111], v[220:223], v[160:163]
    v_mfma_f32_16x16x32_bf16 v[188:191], v[140:143], v[220:223], v[188:191]
    s_waitcnt lgkmcnt(1)
    v_mfma_f32_16x16x32_bf16 v[164:167], v[108:111], v[224:227], v[164:167]
    v_mfma_f32_16x16x32_bf16 v[192:195], v[140:143], v[224:227], v[192:195]
    s_waitcnt lgkmcnt(0)
    v_mfma_f32_16x16x32_bf16 v[168:171], v[108:111], v[228:231], v[168:171]
    v_mfma_f32_16x16x32_bf16 v[196:199], v[140:143], v[228:231], v[196:199]
    s_mov_b32 s27, 1035512379
    v_mul_f32 v144, s27, v144
    v_mul_f32 v145, s27, v145
    v_mul_f32 v146, s27, v146
    v_mul_f32 v147, s27, v147
    v_mul_f32 v148, s27, v148
    v_mul_f32 v149, s27, v149
    v_mul_f32 v150, s27, v150
    v_mul_f32 v151, s27, v151
    v_mul_f32 v152, s27, v152
    v_mul_f32 v153, s27, v153
    v_mul_f32 v154, s27, v154
    v_mul_f32 v155, s27, v155
    v_mul_f32 v156, s27, v156
    v_mul_f32 v157, s27, v157
    v_mul_f32 v158, s27, v158
    v_mul_f32 v159, s27, v159
    v_mul_f32 v160, s27, v160
    v_mul_f32 v161, s27, v161
    v_mul_f32 v162, s27, v162
    v_mul_f32 v163, s27, v163
    v_mul_f32 v164, s27, v164
    v_mul_f32 v165, s27, v165
    v_mul_f32 v166, s27, v166
    v_mul_f32 v167, s27, v167
    v_mul_f32 v168, s27, v168
    v_mul_f32 v169, s27, v169
    v_mul_f32 v170, s27, v170
    v_mul_f32 v171, s27, v171
    v_mul_f32 v172, s27, v172
    v_mul_f32 v173, s27, v173
    v_mul_f32 v174, s27, v174
    v_mul_f32 v175, s27, v175
    v_mul_f32 v176, s27, v176
    v_mul_f32 v177, s27, v177
    v_mul_f32 v178, s27, v178
    v_mul_f32 v179, s27, v179
    v_mul_f32 v180, s27, v180
    v_mul_f32 v181, s27, v181
    v_mul_f32 v182, s27, v182
    v_mul_f32 v183, s27, v183
    v_mul_f32 v184, s27, v184
    v_mul_f32 v185, s27, v185
    v_mul_f32 v186, s27, v186
    v_mul_f32 v187, s27, v187
    v_mul_f32 v188, s27, v188
    v_mul_f32 v189, s27, v189
    v_mul_f32 v190, s27, v190
    v_mul_f32 v191, s27, v191
    v_mul_f32 v192, s27, v192
    v_mul_f32 v193, s27, v193
    v_mul_f32 v194, s27, v194
    v_mul_f32 v195, s27, v195
    v_mul_f32 v196, s27, v196
    v_mul_f32 v197, s27, v197
    v_mul_f32 v198, s27, v198
    v_mul_f32 v199, s27, v199
    s_lshl_b32 s26, s22, 2
    s_add_u32 s26, s26, s23
    s_mul_i32 s26, s26, 100352
    s_lshl_b32 s35, s34, 10
    s_add_u32 s26, s26, s35
    s_add_u32 s26, s26, 0
    v_cvt_pk_bf16_f32 v232, v144, v145
    v_cvt_pk_bf16_f32 v233, v146, v147
    v_cvt_pk_bf16_f32 v234, v172, v173
    v_cvt_pk_bf16_f32 v235, v174, v175
    buffer_store_dwordx4 v[232:235], v2, s[8:11], s26 offen
    s_add_u32 s26, s26, 14336
    v_cvt_pk_bf16_f32 v236, v148, v149
    v_cvt_pk_bf16_f32 v237, v150, v151
    v_cvt_pk_bf16_f32 v238, v176, v177
    v_cvt_pk_bf16_f32 v239, v178, v179
    buffer_store_dwordx4 v[236:239], v2, s[8:11], s26 offen
    s_add_u32 s26, s26, 14336
    v_cvt_pk_bf16_f32 v240, v152, v153
    v_cvt_pk_bf16_f32 v241, v154, v155
    v_cvt_pk_bf16_f32 v242, v180, v181
    v_cvt_pk_bf16_f32 v243, v182, v183
    buffer_store_dwordx4 v[240:243], v2, s[8:11], s26 offen
    s_add_u32 s26, s26, 14336
    v_cvt_pk_bf16_f32 v244, v156, v157
    v_cvt_pk_bf16_f32 v245, v158, v159
    v_cvt_pk_bf16_f32 v246, v184, v185
    v_cvt_pk_bf16_f32 v247, v186, v187
    buffer_store_dwordx4 v[244:247], v2, s[8:11], s26 offen
    s_add_u32 s26, s26, 14336
    v_cvt_pk_bf16_f32 v232, v160, v161
    v_cvt_pk_bf16_f32 v233, v162, v163
    v_cvt_pk_bf16_f32 v234, v188, v189
    v_cvt_pk_bf16_f32 v235, v190, v191
    buffer_store_dwordx4 v[232:235], v2, s[8:11], s26 offen
    s_add_u32 s26, s26, 14336
    v_cvt_pk_bf16_f32 v236, v164, v165
    v_cvt_pk_bf16_f32 v237, v166, v167
    v_cvt_pk_bf16_f32 v238, v192, v193
    v_cvt_pk_bf16_f32 v239, v194, v195
    buffer_store_dwordx4 v[236:239], v2, s[8:11], s26 offen
    s_add_u32 s26, s26, 14336
    v_cvt_pk_bf16_f32 v240, v168, v169
    v_cvt_pk_bf16_f32 v241, v170, v171
    v_cvt_pk_bf16_f32 v242, v196, v197
    v_cvt_pk_bf16_f32 v243, v198, v199
    buffer_store_dwordx4 v[240:243], v2, s[8:11], s26 offen
    s_add_u32 s26, s26, 14336
    s_nop 0
PWA_END:
    s_endpgm
PREP_LN:
    s_sub_u32 s20, s2, 256
    s_load_dwordx2 s[16:17], s[0:1], 0
    s_lshl_b32 s21, s20, 4
    s_lshl_b32 s22, s18, 2
    s_add_u32 s21, s21, s22
    s_mul_i32 s21, s21, 896
    v_lshlrev_b32 v2, 4, v1
    v_mov_b32 v3, 0x7ffffff0
    v_cmp_gt_u32 vcc, 56, v1
    s_nop 1
    v_cndmask_b32 v3, v3, v2, vcc
    s_waitcnt lgkmcnt(0)
    s_mov_b32 s12, s16
    s_and_b32 s13, s17, 0xffff
    s_mov_b32 s14, 1835008
    s_mov_b32 s15, 0x00020000
    buffer_load_dwordx4 v[16:19], v3, s[12:15], s21 offen offset:0
    buffer_load_dwordx4 v[20:23], v3, s[12:15], s21 offen offset:896
    buffer_load_dwordx4 v[24:27], v3, s[12:15], s21 offen offset:1792
    buffer_load_dwordx4 v[28:31], v3, s[12:15], s21 offen offset:2688
    s_waitcnt vmcnt(3)
    v_lshlrev_b32 v64, 16, v16
    v_and_b32 v65, 0xffff0000, v16
    v_lshlrev_b32 v66, 16, v17
    v_and_b32 v67, 0xffff0000, v17
    v_lshlrev_b32 v68, 16, v18
    v_and_b32 v69, 0xffff0000, v18
    v_lshlrev_b32 v70, 16, v19
    v_and_b32 v71, 0xffff0000, v19
    v_pk_add_f32 v[56:57], v[64:65], v[66:67]
    v_pk_add_f32 v[58:59], v[68:69], v[70:71]
    v_pk_add_f32 v[56:57], v[56:57], v[58:59]
    v_add_f32 v40, v56, v57
    s_waitcnt vmcnt(2)
    v_lshlrev_b32 v72, 16, v20
    v_and_b32 v73, 0xffff0000, v20
    v_lshlrev_b32 v74, 16, v21
    v_and_b32 v75, 0xffff0000, v21
    v_lshlrev_b32 v76, 16, v22
    v_and_b32 v77, 0xffff0000, v22
    v_lshlrev_b32 v78, 16, v23
    v_and_b32 v79, 0xffff0000, v23
    v_pk_add_f32 v[56:57], v[72:73], v[74:75]
    v_pk_add_f32 v[58:59], v[76:77], v[78:79]
    v_pk_add_f32 v[56:57], v[56:57], v[58:59]
    v_add_f32 v41, v56, v57
    s_waitcnt vmcnt(1)
    v_lshlrev_b32 v80, 16, v24
    v_and_b32 v81, 0xffff0000, v24
    v_lshlrev_b32 v82, 16, v25
    v_and_b32 v83, 0xffff0000, v25
    v_lshlrev_b32 v84, 16, v26
    v_and_b32 v85, 0xffff0000, v26
    v_lshlrev_b32 v86, 16, v27
    v_and_b32 v87, 0xffff0000, v27
    v_pk_add_f32 v[56:57], v[80:81], v[82:83]
    v_pk_add_f32 v[58:59], v[84:85], v[86:87]
    v_pk_add_f32 v[56:57], v[56:57], v[58:59]
    v_add_f32 v42, v56, v57
    s_waitcnt vmcnt(0)
    v_lshlrev_b32 v88, 16, v28
    v_and_b32 v89, 0xffff0000, v28
    v_lshlrev_b32 v90, 16, v29
    v_and_b32 v91, 0xffff0000, v29
    v_lshlrev_b32 v92, 16, v30
    v_and_b32 v93, 0xffff0000, v30
    v_lshlrev_b32 v94, 16, v31
    v_and_b32 v95, 0xffff0000, v31
    v_pk_add_f32 v[56:57], v[88:89], v[90:91]
    v_pk_add_f32 v[58:59], v[92:93], v[94:95]
    v_pk_add_f32 v[56:57], v[56:57], v[58:59]
    v_add_f32 v43, v56, v57
    v_add_f32_dpp v40, v40, v40 quad_perm:[1,0,3,2] row_mask:0xf bank_mask:0xf
    v_add_f32_dpp v41, v41, v41 quad_perm:[1,0,3,2] row_mask:0xf bank_mask:0xf
    v_add_f32_dpp v42, v42, v42 quad_perm:[1,0,3,2] row_mask:0xf bank_mask:0xf
    v_add_f32_dpp v43, v43, v43 quad_perm:[1,0,3,2] row_mask:0xf bank_mask:0xf
    v_add_f32_dpp v40, v40, v40 quad_perm:[2,3,0,1] row_mask:0xf bank_mask:0xf
    v_add_f32_dpp v41, v41, v41 quad_perm:[2,3,0,1] row_mask:0xf bank_mask:0xf
    v_add_f32_dpp v42, v42, v42 quad_perm:[2,3,0,1] row_mask:0xf bank_mask:0xf
    v_add_f32_dpp v43, v43, v43 quad_perm:[2,3,0,1] row_mask:0xf bank_mask:0xf
    v_add_f32_dpp v40, v40, v40 row_half_mirror row_mask:0xf bank_mask:0xf
    v_add_f32_dpp v41, v41, v41 row_half_mirror row_mask:0xf bank_mask:0xf
    v_add_f32_dpp v42, v42, v42 row_half_mirror row_mask:0xf bank_mask:0xf
    v_add_f32_dpp v43, v43, v43 row_half_mirror row_mask:0xf bank_mask:0xf
    v_add_f32_dpp v40, v40, v40 row_mirror row_mask:0xf bank_mask:0xf
    v_add_f32_dpp v41, v41, v41 row_mirror row_mask:0xf bank_mask:0xf
    v_add_f32_dpp v42, v42, v42 row_mirror row_mask:0xf bank_mask:0xf
    v_add_f32_dpp v43, v43, v43 row_mirror row_mask:0xf bank_mask:0xf
    v_mov_b32 v48, v40
    v_mov_b32 v49, v41
    v_mov_b32 v50, v42
    v_mov_b32 v51, v43
    v_permlane16_swap_b32 v40, v48
    v_permlane16_swap_b32 v41, v49
    v_permlane16_swap_b32 v42, v50
    v_permlane16_swap_b32 v43, v51
    v_add_f32 v40, v40, v48
    v_add_f32 v41, v41, v49
    v_add_f32 v42, v42, v50
    v_add_f32 v43, v43, v51
    v_mov_b32 v48, v40
    v_mov_b32 v49, v41
    v_mov_b32 v50, v42
    v_mov_b32 v51, v43
    v_permlane32_swap_b32 v40, v48
    v_permlane32_swap_b32 v41, v49
    v_permlane32_swap_b32 v42, v50
    v_permlane32_swap_b32 v43, v51
    v_add_f32 v40, v40, v48
    v_add_f32 v41, v41, v49
    v_add_f32 v42, v42, v50
    v_add_f32 v43, v43, v51
    s_mov_b32 s24, 0x3b124925
    v_cmp_gt_u32 vcc, 56, v1
    v_mul_f32 v56, s24, v40
    v_mov_b32 v57, v56
    v_pk_add_f32 v[64:65], v[64:65], v[56:57] neg_lo:[0,1] neg_hi:[0,1]
    v_pk_add_f32 v[66:67], v[66:67], v[56:57] neg_lo:[0,1] neg_hi:[0,1]
    v_pk_add_f32 v[68:69], v[68:69], v[56:57] neg_lo:[0,1] neg_hi:[0,1]
    v_pk_add_f32 v[70:71], v[70:71], v[56:57] neg_lo:[0,1] neg_hi:[0,1]
    v_pk_mul_f32 v[58:59], v[64:65], v[64:65]
    v_pk_fma_f32 v[58:59], v[66:67], v[66:67], v[58:59]
    v_pk_fma_f32 v[58:59], v[68:69], v[68:69], v[58:59]
    v_pk_fma_f32 v[58:59], v[70:71], v[70:71], v[58:59]
    v_add_f32 v58, v58, v59
    v_cndmask_b32 v40, 0, v58, vcc
    v_mul_f32 v56, s24, v41
    v_mov_b32 v57, v56
    v_pk_add_f32 v[72:73], v[72:73], v[56:57] neg_lo:[0,1] neg_hi:[0,1]
    v_pk_add_f32 v[74:75], v[74:75], v[56:57] neg_lo:[0,1] neg_hi:[0,1]
    v_pk_add_f32 v[76:77], v[76:77], v[56:57] neg_lo:[0,1] neg_hi:[0,1]
    v_pk_add_f32 v[78:79], v[78:79], v[56:57] neg_lo:[0,1] neg_hi:[0,1]
    v_pk_mul_f32 v[58:59], v[72:73], v[72:73]
    v_pk_fma_f32 v[58:59], v[74:75], v[74:75], v[58:59]
    v_pk_fma_f32 v[58:59], v[76:77], v[76:77], v[58:59]
    v_pk_fma_f32 v[58:59], v[78:79], v[78:79], v[58:59]
    v_add_f32 v58, v58, v59
    v_cndmask_b32 v41, 0, v58, vcc
    v_mul_f32 v56, s24, v42
    v_mov_b32 v57, v56
    v_pk_add_f32 v[80:81], v[80:81], v[56:57] neg_lo:[0,1] neg_hi:[0,1]
    v_pk_add_f32 v[82:83], v[82:83], v[56:57] neg_lo:[0,1] neg_hi:[0,1]
    v_pk_add_f32 v[84:85], v[84:85], v[56:57] neg_lo:[0,1] neg_hi:[0,1]
    v_pk_add_f32 v[86:87], v[86:87], v[56:57] neg_lo:[0,1] neg_hi:[0,1]
    v_pk_mul_f32 v[58:59], v[80:81], v[80:81]
    v_pk_fma_f32 v[58:59], v[82:83], v[82:83], v[58:59]
    v_pk_fma_f32 v[58:59], v[84:85], v[84:85], v[58:59]
    v_pk_fma_f32 v[58:59], v[86:87], v[86:87], v[58:59]
    v_add_f32 v58, v58, v59
    v_cndmask_b32 v42, 0, v58, vcc
    v_mul_f32 v56, s24, v43
    v_mov_b32 v57, v56
    v_pk_add_f32 v[88:89], v[88:89], v[56:57] neg_lo:[0,1] neg_hi:[0,1]
    v_pk_add_f32 v[90:91], v[90:91], v[56:57] neg_lo:[0,1] neg_hi:[0,1]
    v_pk_add_f32 v[92:93], v[92:93], v[56:57] neg_lo:[0,1] neg_hi:[0,1]
    v_pk_add_f32 v[94:95], v[94:95], v[56:57] neg_lo:[0,1] neg_hi:[0,1]
    v_pk_mul_f32 v[58:59], v[88:89], v[88:89]
    v_pk_fma_f32 v[58:59], v[90:91], v[90:91], v[58:59]
    v_pk_fma_f32 v[58:59], v[92:93], v[92:93], v[58:59]
    v_pk_fma_f32 v[58:59], v[94:95], v[94:95], v[58:59]
    v_add_f32 v58, v58, v59
    v_cndmask_b32 v43, 0, v58, vcc
    v_add_f32_dpp v40, v40, v40 quad_perm:[1,0,3,2] row_mask:0xf bank_mask:0xf
    v_add_f32_dpp v41, v41, v41 quad_perm:[1,0,3,2] row_mask:0xf bank_mask:0xf
    v_add_f32_dpp v42, v42, v42 quad_perm:[1,0,3,2] row_mask:0xf bank_mask:0xf
    v_add_f32_dpp v43, v43, v43 quad_perm:[1,0,3,2] row_mask:0xf bank_mask:0xf
    v_add_f32_dpp v40, v40, v40 quad_perm:[2,3,0,1] row_mask:0xf bank_mask:0xf
    v_add_f32_dpp v41, v41, v41 quad_perm:[2,3,0,1] row_mask:0xf bank_mask:0xf
    v_add_f32_dpp v42, v42, v42 quad_perm:[2,3,0,1] row_mask:0xf bank_mask:0xf
    v_add_f32_dpp v43, v43, v43 quad_perm:[2,3,0,1] row_mask:0xf bank_mask:0xf
    v_add_f32_dpp v40, v40, v40 row_half_mirror row_mask:0xf bank_mask:0xf
    v_add_f32_dpp v41, v41, v41 row_half_mirror row_mask:0xf bank_mask:0xf
    v_add_f32_dpp v42, v42, v42 row_half_mirror row_mask:0xf bank_mask:0xf
    v_add_f32_dpp v43, v43, v43 row_half_mirror row_mask:0xf bank_mask:0xf
    v_add_f32_dpp v40, v40, v40 row_mirror row_mask:0xf bank_mask:0xf
    v_add_f32_dpp v41, v41, v41 row_mirror row_mask:0xf bank_mask:0xf
    v_add_f32_dpp v42, v42, v42 row_mirror row_mask:0xf bank_mask:0xf
    v_add_f32_dpp v43, v43, v43 row_mirror row_mask:0xf bank_mask:0xf
    v_mov_b32 v48, v40
    v_mov_b32 v49, v41
    v_mov_b32 v50, v42
    v_mov_b32 v51, v43
    v_permlane16_swap_b32 v40, v48
    v_permlane16_swap_b32 v41, v49
    v_permlane16_swap_b32 v42, v50
    v_permlane16_swap_b32 v43, v51
    v_add_f32 v40, v40, v48
    v_add_f32 v41, v41, v49
    v_add_f32 v42, v42, v50
    v_add_f32 v43, v43, v51
    v_mov_b32 v48, v40
    v_mov_b32 v49, v41
    v_mov_b32 v50, v42
    v_mov_b32 v51, v43
    v_permlane32_swap_b32 v40, v48
    v_permlane32_swap_b32 v41, v49
    v_permlane32_swap_b32 v42, v50
    v_permlane32_swap_b32 v43, v51
    v_add_f32 v40, v40, v48
    v_add_f32 v41, v41, v49
    v_add_f32 v42, v42, v50
    v_add_f32 v43, v43, v51
    v_mov_b32 v60, 0x3727c5ac
    s_mul_i32 s22, s18, 3648
    v_add_u32 v4, s22, v2
    v_fma_f32 v40, v40, s24, v60
    v_fma_f32 v41, v41, s24, v60
    v_fma_f32 v42, v42, s24, v60
    v_fma_f32 v43, v43, s24, v60
    v_rsq_f32 v40, v40
    v_rsq_f32 v41, v41
    v_rsq_f32 v42, v42
    v_rsq_f32 v43, v43
    s_mov_b64 s[26:27], exec
    v_mov_b32 v56, v40
    v_mov_b32 v57, v40
    v_pk_mul_f32 v[64:65], v[64:65], v[56:57]
    v_pk_mul_f32 v[66:67], v[66:67], v[56:57]
    v_pk_mul_f32 v[68:69], v[68:69], v[56:57]
    v_pk_mul_f32 v[70:71], v[70:71], v[56:57]
    v_cvt_pk_bf16_f32 v16, v64, v65
    v_cvt_pk_bf16_f32 v17, v66, v67
    v_cvt_pk_bf16_f32 v18, v68, v69
    v_cvt_pk_bf16_f32 v19, v70, v71
    v_mov_b32 v56, v41
    v_mov_b32 v57, v41
    v_pk_mul_f32 v[72:73], v[72:73], v[56:57]
    v_pk_mul_f32 v[74:75], v[74:75], v[56:57]
    v_pk_mul_f32 v[76:77], v[76:77], v[56:57]
    v_pk_mul_f32 v[78:79], v[78:79], v[56:57]
    v_cvt_pk_bf16_f32 v20, v72, v73
    v_cvt_pk_bf16_f32 v21, v74, v75
    v_cvt_pk_bf16_f32 v22, v76, v77
    v_cvt_pk_bf16_f32 v23, v78, v79
    v_mov_b32 v56, v42
    v_mov_b32 v57, v42
    v_pk_mul_f32 v[80:81], v[80:81], v[56:57]
    v_pk_mul_f32 v[82:83], v[82:83], v[56:57]
    v_pk_mul_f32 v[84:85], v[84:85], v[56:57]
    v_pk_mul_f32 v[86:87], v[86:87], v[56:57]
    v_cvt_pk_bf16_f32 v24, v80, v81
    v_cvt_pk_bf16_f32 v25, v82, v83
    v_cvt_pk_bf16_f32 v26, v84, v85
    v_cvt_pk_bf16_f32 v27, v86, v87
    v_mov_b32 v56, v43
    v_mov_b32 v57, v43
    v_pk_mul_f32 v[88:89], v[88:89], v[56:57]
    v_pk_mul_f32 v[90:91], v[90:91], v[56:57]
    v_pk_mul_f32 v[92:93], v[92:93], v[56:57]
    v_pk_mul_f32 v[94:95], v[94:95], v[56:57]
    v_cvt_pk_bf16_f32 v28, v88, v89
    v_cvt_pk_bf16_f32 v29, v90, v91
    v_cvt_pk_bf16_f32 v30, v92, v93
    v_cvt_pk_bf16_f32 v31, v94, v95
    s_mov_b32 exec_hi, 0x00ffffff
    ds_write_b128 v4, v[16:19] offset:0
    ds_write_b128 v4, v[20:23] offset:912
    ds_write_b128 v4, v[24:27] offset:1824
    ds_write_b128 v4, v[28:31] offset:2736
    s_mov_b64 exec, s[26:27]
    s_waitcnt lgkmcnt(0)
    s_barrier
    v_and_b32 v5, 15, v1
    v_lshrrev_b32 v6, 4, v1
    v_mul_u32_u24 v7, 912, v5
    v_lshrrev_b32 v8, 1, v6
    v_lshlrev_b32 v8, 5, v8
    v_and_b32 v9, 1, v6
    v_lshl_add_u32 v8, v9, 3, v8
    v_add_u32 v8, v8, v7
    v_lshl_add_u32 v10, v6, 3, v7
    s_lshl_b32 s22, s18, 6
    v_add_u32 v8, s22, v8
    v_add_u32 v11, s22, v10
    s_mul_i32 s23, s20, 14336
    s_lshl_b32 s22, s18, 10
    s_add_u32 s23, s23, s22
    s_add_u32 s24, s23, 56623104
    s_add_u32 s25, s23, 58720256
    s_mul_i32 s22, s18, 224
    v_add_u32 v12, s22, v10
    ds_read_b64 v[80:81], v12 offset:0
    ds_read_b64 v[82:83], v12 offset:32
    ds_read_b64 v[84:85], v12 offset:64
    ds_read_b64 v[86:87], v12 offset:96
    ds_read_b64 v[88:89], v12 offset:128
    ds_read_b64 v[90:91], v12 offset:160
    ds_read_b64 v[92:93], v12 offset:192
    ds_read_b64 v[94:95], v12 offset:224
    ds_read2_b32 v[16:17], v8 offset0:0 offset1:4
    ds_read2_b32 v[18:19], v8 offset0:1 offset1:5
    ds_read_b64 v[20:21], v11 offset:0
    ds_read_b64 v[22:23], v11 offset:32
    ds_read2_b32 v[24:25], v8 offset0:64 offset1:68
    ds_read2_b32 v[26:27], v8 offset0:65 offset1:69
    ds_read_b64 v[28:29], v11 offset:256
    ds_read_b64 v[30:31], v11 offset:288
    ds_read2_b32 v[32:33], v8 offset0:128 offset1:132
    ds_read2_b32 v[34:35], v8 offset0:129 offset1:133
    ds_read_b64 v[36:37], v11 offset:512
    ds_read_b64 v[38:39], v11 offset:544
    ds_read2_b32 v[40:41], v8 offset0:192 offset1:196
    ds_read2_b32 v[42:43], v8 offset0:193 offset1:197
    ds_read_b64 v[44:45], v11 offset:768
    ds_read_b64 v[46:47], v11 offset:800
    s_lshr_b32 s28, s20, 1
    s_lshl_b32 s28, s28, 15
    s_and_b32 s29, s20, 1
    s_lshl_b32 s29, s29, 12
    s_add_u32 s28, s28, s29
    s_lshl_b32 s29, s18, 13
    s_add_u32 s28, s28, s29
    s_add_u32 s28, s28, 13631488
    s_waitcnt lgkmcnt(0)
    buffer_store_dwordx4 v[80:83], v2, s[8:11], s28 offen offset:0
    buffer_store_dwordx4 v[84:87], v2, s[8:11], s28 offen offset:1024
    buffer_store_dwordx4 v[88:91], v2, s[8:11], s28 offen offset:2048
    buffer_store_dwordx4 v[92:95], v2, s[8:11], s28 offen offset:3072
    buffer_store_dwordx4 v[16:19], v2, s[8:11], s24 offen
    buffer_store_dwordx4 v[20:23], v2, s[8:11], s25 offen
    s_add_u32 s24, s24, 4096
    s_add_u32 s25, s25, 4096
    buffer_store_dwordx4 v[24:27], v2, s[8:11], s24 offen
    buffer_store_dwordx4 v[28:31], v2, s[8:11], s25 offen
    s_add_u32 s24, s24, 4096
    s_add_u32 s25, s25, 4096
    buffer_store_dwordx4 v[32:35], v2, s[8:11], s24 offen
    buffer_store_dwordx4 v[36:39], v2, s[8:11], s25 offen
    s_add_u32 s24, s24, 4096
    s_add_u32 s25, s25, 4096
    s_cmp_ge_u32 s18, 2
    s_cbranch_scc1 PLN_END
    buffer_store_dwordx4 v[40:43], v2, s[8:11], s24 offen
    buffer_store_dwordx4 v[44:47], v2, s[8:11], s25 offen
    s_add_u32 s24, s24, 4096
    s_add_u32 s25, s25, 4096
PLN_END:
    s_endpgm
PREP_S:
    s_sub_u32 s20, s2, 384
    v_lshlrev_b32 v2, 4, v0
    v_mov_b32 v16, -1
    v_mov_b32 v17, -1
    v_mov_b32 v18, -1
    v_mov_b32 v19, -1
    s_mul_i32 s21, s20, 73728
    s_add_u32 s21, s21, 16261120
    s_mov_b32 s22, 18
PS_LOOP:
    s_cmp_ge_u32 s21, 17432576
    s_cbranch_scc1 PS_DONE
    buffer_store_dwordx4 v[16:19], v2, s[8:11], s21 offen
    s_add_u32 s21, s21, 4096
    s_sub_u32 s22, s22, 1
    s_cmp_lg_u32 s22, 0
    s_cbranch_scc1 PS_LOOP
PS_DONE:
    s_cmp_lg_u32 s20, 1
    s_cbranch_scc1 PS_NOFLAG
    v_mov_b32 v24, 0
    v_mov_b32 v25, 0
    v_mov_b32 v26, 0
    v_mov_b32 v27, 0
    s_mov_b32 s21, 112197632
    buffer_store_dwordx4 v[24:27], v2, s[8:11], s21 offen
    s_add_u32 s21, s21, 4096
    buffer_store_dwordx4 v[24:27], v2, s[8:11], s21 offen
    s_add_u32 s21, s21, 4096
    buffer_store_dwordx4 v[24:27], v2, s[8:11], s21 offen
    s_add_u32 s21, s21, 4096
    buffer_store_dwordx4 v[24:27], v2, s[8:11], s21 offen
    s_add_u32 s21, s21, 4096
    buffer_store_dwordx4 v[24:27], v2, s[8:11], s21 offen
    s_add_u32 s21, s21, 4096
    buffer_store_dwordx4 v[24:27], v2, s[8:11], s21 offen
    s_add_u32 s21, s21, 4096
    buffer_store_dwordx4 v[24:27], v2, s[8:11], s21 offen
    s_add_u32 s21, s21, 4096
    buffer_store_dwordx4 v[24:27], v2, s[8:11], s21 offen
    s_add_u32 s21, s21, 4096
    buffer_store_dwordx4 v[24:27], v2, s[8:11], s21 offen
    s_add_u32 s21, s21, 4096
    buffer_store_dwordx4 v[24:27], v2, s[8:11], s21 offen
    s_add_u32 s21, s21, 4096
    buffer_store_dwordx4 v[24:27], v2, s[8:11], s21 offen
    s_add_u32 s21, s21, 4096
    buffer_store_dwordx4 v[24:27], v2, s[8:11], s21 offen
    s_add_u32 s21, s21, 4096
    buffer_store_dwordx4 v[24:27], v2, s[8:11], s21 offen
    s_add_u32 s21, s21, 4096
    buffer_store_dwordx4 v[24:27], v2, s[8:11], s21 offen
    s_add_u32 s21, s21, 4096
    buffer_store_dwordx4 v[24:27], v2, s[8:11], s21 offen
    s_add_u32 s21, s21, 4096
    buffer_store_dwordx4 v[24:27], v2, s[8:11], s21 offen
    s_add_u32 s21, s21, 4096
    buffer_store_dwordx4 v[24:27], v2, s[8:11], s21 offen
    s_add_u32 s21, s21, 4096
    s_mov_b32 s21, 16260096
    v_mov_b32 v8, 0x7ffffff0
    v_cmp_gt_u32 vcc, 64, v0
    s_nop 1
    v_cndmask_b32 v9, v8, v2, vcc
    buffer_store_dwordx4 v[16:19], v9, s[8:11], s21 offen
    s_nop 1
PS_NOFLAG:
    s_cmp_lg_u32 s20, 0
    s_cbranch_scc1 PS_END
    s_load_dwordx2 s[16:17], s[0:1], 8
    s_waitcnt lgkmcnt(0)
    s_mov_b32 s12, s16
    s_and_b32 s13, s17, 0xffff
    s_mov_b32 s14, 7168
    s_mov_b32 s15, 0x00020000
    v_add_u32 v5, 0, v0
    v_lshrrev_b32 v6, 3, v5
    v_and_b32 v7, 7, v5
    v_mul_u32_u24 v7, 896, v7
    v_lshl_add_u32 v7, v6, 4, v7
    v_mov_b32 v8, 0x7ffffff0
    v_cmp_gt_u32 vcc, 448, v5
    s_nop 1
    v_cndmask_b32 v7, v8, v7, vcc
    v_lshlrev_b32 v9, 4, v5
    v_cndmask_b32 v9, v8, v9, vcc
    buffer_load_dwordx4 v[20:23], v7, s[12:15], 0 offen
    s_waitcnt vmcnt(0)
    s_mov_b32 s21, 16252928
    buffer_store_dwordx4 v[20:23], v9, s[8:11], s21 offen
    s_mov_b32 s21, 111149056
    buffer_store_dwordx4 v[20:23], v9, s[8:11], s21 offen
    v_add_u32 v5, 256, v0
    v_lshrrev_b32 v6, 3, v5
    v_and_b32 v7, 7, v5
    v_mul_u32_u24 v7, 896, v7
    v_lshl_add_u32 v7, v6, 4, v7
    v_mov_b32 v8, 0x7ffffff0
    v_cmp_gt_u32 vcc, 448, v5
    s_nop 1
    v_cndmask_b32 v7, v8, v7, vcc
    v_lshlrev_b32 v9, 4, v5
    v_cndmask_b32 v9, v8, v9, vcc
    buffer_load_dwordx4 v[20:23], v7, s[12:15], 0 offen
    s_waitcnt vmcnt(0)
    s_mov_b32 s21, 16252928
    buffer_store_dwordx4 v[20:23], v9, s[8:11], s21 offen
    s_mov_b32 s21, 111149056
    buffer_store_dwordx4 v[20:23], v9, s[8:11], s21 offen
    s_nop 1
PS_END:
    s_endpgm
PREP_EXIT:
    s_endpgm
.globl mega_kernel
.p2align 8
.type mega_kernel,@function
mega_kernel:
    s_cmp_ge_u32 s2, 256
    s_cbranch_scc1 CH_EXIT
    s_load_dwordx2 s[4:5], s[0:1], 112
    s_load_dwordx2 s[6:7], s[0:1], 104
    v_lshrrev_b32 v1, 6, v0
    s_nop 0
    v_readfirstlane_b32 s13, v1
    v_and_b32 v1, 63, v0
    s_waitcnt lgkmcnt(0)
    s_mov_b32 s8, s4
    s_and_b32 s9, s5, 0xffff
    s_mov_b32 s10, 0x10000000
    s_mov_b32 s11, 0x00020000
    s_cmp_lg_u32 s13, 0
    s_cbranch_scc1 EL_WAIT
    s_getreg_b32 s18, hwreg(HW_REG_XCC_ID)
    s_and_b32 s18, s18, 7
    s_lshl_b32 s20, s18, 7
    s_add_u32 s20, s20, 112238848
    s_mov_b32 s21, 112239872
    s_add_u32 s22, s18, 1
    v_mov_b32 v2, 0
    v_mov_b32 v3, 1
    v_mov_b32 v4, s22
    v_mov_b32 v5, 0
    s_mov_b64 s[26:27], exec
    s_mov_b64 exec, 1
    buffer_atomic_add v3, v2, s[8:11], s20 offen sc0
    buffer_atomic_cmpswap v[4:5], v2, s[8:11], s21 offen sc0
    s_waitcnt vmcnt(0)
    v_readfirstlane_b32 s12, v3
    v_readfirstlane_b32 s21, v4
    s_nop 0
    s_cmp_eq_u32 s21, 0
    s_cselect_b32 s21, s22, s21
    s_cmp_eq_u32 s21, s22
    s_nop 0
    s_cbranch_scc1 EL_PUB
    s_cmp_gt_u32 s22, s21
    s_cselect_b32 s20, 1, 0
    s_sub_u32 s18, s18, s20
    s_lshl_b32 s18, s18, 5
    s_cmp_ge_u32 s12, 32
    s_cselect_b32 s12, 224, s12
    s_cselect_b32 s18, 0, s18
    s_add_u32 s12, s12, s18
    s_add_u32 s12, s12, 256
EL_PUB:
    v_mov_b32 v4, s12
    v_mov_b32 v5, 0
    ds_write_b32 v5, v4
    s_waitcnt lgkmcnt(0)
    s_mov_b64 exec, s[26:27]
EL_WAIT:
    s_barrier
    v_mov_b32 v5, 0
    ds_read_b32 v4, v5
    s_waitcnt lgkmcnt(0)
    v_readfirstlane_b32 s12, v4
    s_barrier
    s_cmp_ge_u32 s12, 256
    s_nop 2
    s_cbranch_scc1 BULK
    s_cmp_ge_u32 s12, 32
    s_cbranch_scc1 CH_EXIT
    s_cmp_ge_u32 s12, 30
    s_cbranch_scc1 ROLE_PF
    s_cmp_ge_u32 s12, 16
    s_cbranch_scc1 ROLE_C
ROLE_A:
    v_lshlrev_b32 v5, 4, v1
    v_lshlrev_b32 v3, 4, v0
    v_add_u32 v4, 4096, v3
    v_and_b32 v44, 15, v1
    v_lshrrev_b32 v45, 4, v1
    v_mov_b32 v2, 0x44444444
    v_mov_b32 v46, 0xeeeeeeee
    v_cmp_lt_u32 vcc, 7, v44
    s_nop 1
    v_cndmask_b32 v2, v2, v46, vcc
    s_lshl_b32 s18, s13, 11
    s_add_u32 s18, s18, 8192
    v_lshrrev_b32 v46, 1, v45
    v_lshlrev_b32 v46, 8, v46
    v_lshl_add_u32 v46, v44, 4, v46
    v_and_b32 v47, 1, v45
    v_lshl_add_u32 v46, v47, 3, v46
    v_add_u32 v6, s18, v46
    v_lshrrev_b32 v46, 2, v44
    v_lshl_add_u32 v46, v45, 2, v46
    v_lshlrev_b32 v46, 4, v46
    v_and_b32 v48, 1, v1
    v_lshl_add_u32 v46, v48, 3, v46
    v_add_u32 v7, s18, v46
    s_mul_i32 s20, s13, 1792
    v_lshrrev_b32 v46, 1, v45
    v_lshlrev_b32 v46, 7, v46
    v_and_b32 v48, 7, v1
    v_lshl_add_u32 v46, v48, 4, v46
    v_lshl_add_u32 v46, v47, 3, v46
    v_add_u32 v8, s20, v46
    s_lshl_b32 s18, s13, 13
    s_add_u32 s26, s18, 32768
    v_add_u32 v9, s26, v5
    s_add_u32 s17, s18, 13631488
    s_add_u32 s29, s17, 4096
    s_mul_i32 s20, s13, 1728
    s_add_u32 s20, s20, 16384
    v_lshlrev_b32 v46, 4, v48
    v_mul_u32_u24 v49, 144, v45
    v_add_u32 v46, v46, v49
    v_add_u32 v10, s20, v46
    v_and_b32 v49, 31, v1
    v_lshrrev_b32 v46, 5, v1
    v_cmp_gt_u32 vcc, 20, v49
    v_mov_b32 v13, 0
    s_nop 0
    v_cndmask_b32 v13, v13, 1.0, vcc
    v_cndmask_b32 v47, 0, v49, vcc
    s_lshl_b32 s20, s13, 1
    v_add_u32 v46, s20, v46
    v_add_u32 v45, 4, v47
    v_cmp_lt_u32 vcc, 3, v47
    s_nop 1
    v_cndmask_b32 v47, v47, v45, vcc
    v_lshrrev_b32 v44, 1, v47
    v_mul_u32_u24 v44, 144, v44
    v_and_b32 v45, 1, v47
    v_lshl_add_u32 v44, v45, 3, v44
    v_lshl_add_u32 v44, v46, 4, v44
    v_add_u32 v11, 16384, v44
    s_lshr_b32 s18, s12, 2
    s_mul_i32 s18, s18, 2560
    s_and_b32 s20, s12, 3
    s_lshl_b32 s21, s20, 9
    s_add_u32 s21, s21, s18
    s_and_b32 s22, s20, 1
    s_lshl_b32 s22, s22, 8
    s_lshr_b32 s20, s20, 1
    s_lshl_b32 s20, s20, 3
    s_add_u32 s22, s22, s20
    s_add_u32 s22, s22, s18
    s_add_u32 s22, s22, 2048
    v_subrev_u32 v44, 4, v49
    v_and_b32 v45, 7, v44
    v_lshrrev_b32 v45, 1, v45
    v_lshlrev_b32 v45, 4, v45
    v_lshrrev_b32 v47, 3, v44
    v_lshl_add_u32 v45, v47, 3, v45
    v_and_b32 v44, 1, v44
    v_lshl_add_u32 v44, v44, 2, v45
    v_add_u32 v44, s21, v44
    v_lshl_add_u32 v44, v46, 6, v44
    v_lshrrev_b32 v45, 1, v49
    v_lshlrev_b32 v45, 7, v45
    v_and_b32 v47, 1, v49
    v_lshl_add_u32 v45, v47, 2, v45
    v_add_u32 v45, s22, v45
    v_lshl_add_u32 v45, v46, 4, v45
    v_cmp_gt_u32 vcc, 4, v49
    s_nop 1
    v_cndmask_b32 v44, v44, v45, vcc
    v_mov_b32 v45, 0x7ffffff0
    v_cmp_gt_u32 vcc, 20, v49
    s_nop 1
    v_cndmask_b32 v12, v45, v44, vcc
    v_and_b32 v44, 7, v1
    v_lshrrev_b32 v45, 4, v1
    v_and_b32 v45, 1, v45
    v_lshlrev_b32 v45, 2, v45
    v_sub_u32 v44, v44, v45
    v_mov_b32 v46, 0x3f80
    v_mov_b32 v47, 0x3f800000
    v_mov_b32 v14, 0
    v_mov_b32 v15, 0
    v_cmp_eq_u32 vcc, 0, v44
    s_nop 1
    v_cndmask_b32 v14, v14, v46, vcc
    v_cmp_eq_u32 vcc, 1, v44
    s_nop 1
    v_cndmask_b32 v14, v14, v47, vcc
    v_cmp_eq_u32 vcc, 2, v44
    s_nop 1
    v_cndmask_b32 v15, v15, v46, vcc
    v_cmp_eq_u32 vcc, 3, v44
    s_nop 1
    v_cndmask_b32 v15, v15, v47, vcc
    s_lshl_b32 s18, s12, 2
    s_add_u32 s18, s18, s13
    s_mul_i32 s18, s18, 100352
    s_add_u32 s18, s18, 0
    buffer_load_dwordx4 a[0:3], v5, s[8:11], s18 offen offset:0
    buffer_load_dwordx4 a[4:7], v5, s[8:11], s18 offen offset:1024
    buffer_load_dwordx4 a[8:11], v5, s[8:11], s18 offen offset:2048
    buffer_load_dwordx4 a[12:15], v5, s[8:11], s18 offen offset:3072
    s_add_u32 s18, s18, 4096
    buffer_load_dwordx4 a[16:19], v5, s[8:11], s18 offen offset:0
    buffer_load_dwordx4 a[20:23], v5, s[8:11], s18 offen offset:1024
    buffer_load_dwordx4 a[24:27], v5, s[8:11], s18 offen offset:2048
    buffer_load_dwordx4 a[28:31], v5, s[8:11], s18 offen offset:3072
    s_add_u32 s18, s18, 4096
    buffer_load_dwordx4 a[32:35], v5, s[8:11], s18 offen offset:0
    buffer_load_dwordx4 a[36:39], v5, s[8:11], s18 offen offset:1024
    buffer_load_dwordx4 a[40:43], v5, s[8:11], s18 offen offset:2048
    buffer_load_dwordx4 a[44:47], v5, s[8:11], s18 offen offset:3072
    s_add_u32 s18, s18, 4096
    buffer_load_dwordx4 a[48:51], v5, s[8:11], s18 offen offset:0
    buffer_load_dwordx4 a[52:55], v5, s[8:11], s18 offen offset:1024
    buffer_load_dwordx4 a[56:59], v5, s[8:11], s18 offen offset:2048
    buffer_load_dwordx4 a[60:63], v5, s[8:11], s18 offen offset:3072
    s_add_u32 s18, s18, 4096
    buffer_load_dwordx4 a[64:67], v5, s[8:11], s18 offen offset:0
    buffer_load_dwordx4 a[68:71], v5, s[8:11], s18 offen offset:1024
    buffer_load_dwordx4 a[72:75], v5, s[8:11], s18 offen offset:2048
    buffer_load_dwordx4 a[76:79], v5, s[8:11], s18 offen offset:3072
    s_add_u32 s18, s18, 4096
    buffer_load_dwordx4 a[80:83], v5, s[8:11], s18 offen offset:0
    buffer_load_dwordx4 a[84:87], v5, s[8:11], s18 offen offset:1024
    buffer_load_dwordx4 a[88:91], v5, s[8:11], s18 offen offset:2048
    buffer_load_dwordx4 a[92:95], v5, s[8:11], s18 offen offset:3072
    s_add_u32 s18, s18, 4096
    buffer_load_dwordx4 a[96:99], v5, s[8:11], s18 offen offset:0
    buffer_load_dwordx4 a[100:103], v5, s[8:11], s18 offen offset:1024
    buffer_load_dwordx4 a[104:107], v5, s[8:11], s18 offen offset:2048
    buffer_load_dwordx4 a[108:111], v5, s[8:11], s18 offen offset:3072
    s_add_u32 s18, s18, 4096
    buffer_load_dwordx4 a[112:115], v5, s[8:11], s18 offen offset:0
    buffer_load_dwordx4 a[116:119], v5, s[8:11], s18 offen offset:1024
    buffer_load_dwordx4 a[120:123], v5, s[8:11], s18 offen offset:2048
    buffer_load_dwordx4 a[124:127], v5, s[8:11], s18 offen offset:3072
    s_add_u32 s18, s18, 4096
    buffer_load_dwordx4 a[128:131], v5, s[8:11], s18 offen offset:0
    buffer_load_dwordx4 a[132:135], v5, s[8:11], s18 offen offset:1024
    buffer_load_dwordx4 a[136:139], v5, s[8:11], s18 offen offset:2048
    buffer_load_dwordx4 a[140:143], v5, s[8:11], s18 offen offset:3072
    s_add_u32 s18, s18, 4096
    buffer_load_dwordx4 a[144:147], v5, s[8:11], s18 offen offset:0
    buffer_load_dwordx4 a[148:151], v5, s[8:11], s18 offen offset:1024
    buffer_load_dwordx4 a[152:155], v5, s[8:11], s18 offen offset:2048
    buffer_load_dwordx4 a[156:159], v5, s[8:11], s18 offen offset:3072
    s_add_u32 s18, s18, 4096
    buffer_load_dwordx4 a[160:163], v5, s[8:11], s18 offen offset:0
    buffer_load_dwordx4 a[164:167], v5, s[8:11], s18 offen offset:1024
    buffer_load_dwordx4 a[168:171], v5, s[8:11], s18 offen offset:2048
    buffer_load_dwordx4 a[172:175], v5, s[8:11], s18 offen offset:3072
    s_add_u32 s18, s18, 4096
    buffer_load_dwordx4 a[176:179], v5, s[8:11], s18 offen offset:0
    buffer_load_dwordx4 a[180:183], v5, s[8:11], s18 offen offset:1024
    buffer_load_dwordx4 a[184:187], v5, s[8:11], s18 offen offset:2048
    buffer_load_dwordx4 a[188:191], v5, s[8:11], s18 offen offset:3072
    s_add_u32 s18, s18, 4096
    buffer_load_dwordx4 a[192:195], v5, s[8:11], s18 offen offset:0
    buffer_load_dwordx4 a[196:199], v5, s[8:11], s18 offen offset:1024
    buffer_load_dwordx4 a[200:203], v5, s[8:11], s18 offen offset:2048
    buffer_load_dwordx4 a[204:207], v5, s[8:11], s18 offen offset:3072
    s_add_u32 s18, s18, 4096
    buffer_load_dwordx4 a[208:211], v5, s[8:11], s18 offen offset:0
    buffer_load_dwordx4 a[212:215], v5, s[8:11], s18 offen offset:1024
    buffer_load_dwordx4 a[216:219], v5, s[8:11], s18 offen offset:2048
    buffer_load_dwordx4 a[220:223], v5, s[8:11], s18 offen offset:3072
    s_add_u32 s18, s18, 4096
    buffer_load_dwordx4 a[224:227], v5, s[8:11], s18 offen offset:0
    buffer_load_dwordx4 a[228:231], v5, s[8:11], s18 offen offset:1024
    buffer_load_dwordx4 a[232:235], v5, s[8:11], s18 offen offset:2048
    buffer_load_dwordx4 a[236:239], v5, s[8:11], s18 offen offset:3072
    s_add_u32 s18, s18, 4096
    buffer_load_dwordx4 a[240:243], v5, s[8:11], s18 offen offset:0
    buffer_load_dwordx4 a[244:247], v5, s[8:11], s18 offen offset:1024
    buffer_load_dwordx4 a[248:251], v5, s[8:11], s18 offen offset:2048
    buffer_load_dwordx4 a[252:255], v5, s[8:11], s18 offen offset:3072
    s_add_u32 s18, s18, 4096
    buffer_load_dwordx4 v[120:123], v5, s[8:11], s18 offen offset:0
    buffer_load_dwordx4 v[124:127], v5, s[8:11], s18 offen offset:1024
    buffer_load_dwordx4 v[128:131], v5, s[8:11], s18 offen offset:2048
    buffer_load_dwordx4 v[132:135], v5, s[8:11], s18 offen offset:3072
    s_add_u32 s18, s18, 4096
    buffer_load_dwordx4 v[136:139], v5, s[8:11], s18 offen offset:0
    buffer_load_dwordx4 v[140:143], v5, s[8:11], s18 offen offset:1024
    buffer_load_dwordx4 v[144:147], v5, s[8:11], s18 offen offset:2048
    buffer_load_dwordx4 v[148:151], v5, s[8:11], s18 offen offset:3072
    s_add_u32 s18, s18, 4096
    buffer_load_dwordx4 v[152:155], v5, s[8:11], s18 offen offset:0
    buffer_load_dwordx4 v[156:159], v5, s[8:11], s18 offen offset:1024
    buffer_load_dwordx4 v[160:163], v5, s[8:11], s18 offen offset:2048
    buffer_load_dwordx4 v[164:167], v5, s[8:11], s18 offen offset:3072
    s_add_u32 s18, s18, 4096
    buffer_load_dwordx4 v[168:171], v5, s[8:11], s18 offen offset:0
    buffer_load_dwordx4 v[172:175], v5, s[8:11], s18 offen offset:1024
    buffer_load_dwordx4 v[176:179], v5, s[8:11], s18 offen offset:2048
    buffer_load_dwordx4 v[180:183], v5, s[8:11], s18 offen offset:3072
    s_add_u32 s18, s18, 4096
    buffer_load_dwordx4 v[184:187], v5, s[8:11], s18 offen offset:0
    buffer_load_dwordx4 v[188:191], v5, s[8:11], s18 offen offset:1024
    buffer_load_dwordx4 v[192:195], v5, s[8:11], s18 offen offset:2048
    buffer_load_dwordx4 v[196:199], v5, s[8:11], s18 offen offset:3072
    s_add_u32 s18, s18, 4096
    buffer_load_dwordx4 v[200:203], v5, s[8:11], s18 offen offset:0
    buffer_load_dwordx4 v[204:207], v5, s[8:11], s18 offen offset:1024
    buffer_load_dwordx4 v[208:211], v5, s[8:11], s18 offen offset:2048
    buffer_load_dwordx4 v[212:215], v5, s[8:11], s18 offen offset:3072
    s_add_u32 s18, s18, 4096
    buffer_load_dwordx4 v[216:219], v5, s[8:11], s18 offen offset:0
    buffer_load_dwordx4 v[220:223], v5, s[8:11], s18 offen offset:1024
    buffer_load_dwordx4 v[224:227], v5, s[8:11], s18 offen offset:2048
    buffer_load_dwordx4 v[228:231], v5, s[8:11], s18 offen offset:3072
    s_add_u32 s18, s18, 4096
    buffer_load_dwordx4 v[232:235], v5, s[8:11], s18 offen offset:0
    buffer_load_dwordx4 v[236:239], v5, s[8:11], s18 offen offset:1024
    buffer_load_dwordx4 v[240:243], v5, s[8:11], s18 offen offset:2048
    buffer_load_dwordx4 v[244:247], v5, s[8:11], s18 offen offset:3072
    s_add_u32 s18, s18, 4096
    buffer_load_dwordx4 v[248:251], v5, s[8:11], s18 offen offset:0
    buffer_load_dwordx4 v[252:255], v5, s[8:11], s18 offen offset:1024
    s_mov_b32 s14, 0
    s_mov_b32 s15, 16252928
    s_mov_b32 s16, 16777216
    s_mov_b32 s19, 0x40000
    s_lshl_b32 s25, s13, 12
    s_add_u32 s25, s25, 139264
    s_mov_b32 s52, 0
    s_lshl_b32 s18, s12, 2
    s_add_u32 s18, s18, s13
    s_mul_i32 s18, s18, 7168
    s_add_u32 s24, s18, 18743296
    s_mov_b32 s34, 112248320
    s_lshl_b32 s33, s12, 2
    s_add_u32 s33, s33, 112248320
    v_min_u32 v0, 55, v1
    v_lshlrev_b32 v0, 7, v0
    s_waitcnt vmcnt(0)
    s_cmp_eq_u32 s13, 1
    s_cbranch_scc1 A1_LOOP
    s_cmp_eq_u32 s13, 2
    s_cbranch_scc1 A2_LOOP
    s_cmp_eq_u32 s13, 3
    s_cbranch_scc1 A3_LOOP
A0_LOOP:
    s_mov_b32 m0, s26
    s_nop 0
    buffer_load_dwordx4 v5, s[8:11], s17 offen offset:0 lds
    buffer_load_dwordx4 v5, s[8:11], s17 offen offset:1024 lds
    buffer_load_dwordx4 v5, s[8:11], s17 offen offset:2048 lds
    buffer_load_dwordx4 v5, s[8:11], s17 offen offset:3072 lds
    s_add_u32 m0, s26, 4096
    s_nop 0
    buffer_load_dwordx4 v5, s[8:11], s29 offen offset:0 lds
    buffer_load_dwordx4 v5, s[8:11], s29 offen offset:1024 lds
    buffer_load_dwordx4 v5, s[8:11], s29 offen offset:2048 lds
    buffer_load_dwordx4 v5, s[8:11], s29 offen offset:3072 lds
    s_add_u32 s17, s17, 32768
    s_add_u32 s29, s29, 32768
    v_mov_b32 v44, 0
    v_mov_b32 v45, 0
    v_mov_b32 v46, 0
    v_mov_b32 v47, 0
    v_mov_b32 v48, 0
    v_mov_b32 v49, 0
    v_mov_b32 v50, 0
    v_mov_b32 v51, 0
    v_mov_b32 v52, 0
    v_mov_b32 v53, 0
    v_mov_b32 v54, 0
    v_mov_b32 v55, 0
    v_mov_b32 v56, 0
    v_mov_b32 v57, 0
    v_mov_b32 v58, 0
    v_mov_b32 v59, 0
    v_mov_b32 v60, 0
    v_mov_b32 v61, 0
    v_mov_b32 v62, 0
    v_mov_b32 v63, 0
    v_mov_b32 v64, 0
    v_mov_b32 v65, 0
    v_mov_b32 v66, 0
    v_mov_b32 v67, 0
    v_mov_b32 v68, 0
    v_mov_b32 v69, 0
    v_mov_b32 v70, 0
    v_mov_b32 v71, 0
    v_mov_b32 v106, 0
    v_mov_b32 v107, 0
    v_mov_b32 v108, 0
    v_mov_b32 v109, 0
    v_mov_b32 v110, 0
    v_mov_b32 v111, 0
    v_mov_b32 v112, 0
    v_mov_b32 v113, 0
    v_mov_b32 v114, 0
    v_mov_b32 v115, 0
    v_mov_b32 v116, 0
    v_mov_b32 v117, 0
    buffer_load_dwordx4 v[94:97], v3, s[8:11], s15 offen sc1
    buffer_load_dwordx4 v[98:101], v4, s[8:11], s15 offen sc1
    s_sleep 3
A0_PL:
    buffer_load_dwordx4 v[74:77], v3, s[8:11], s15 offen sc1
    buffer_load_dwordx4 v[78:81], v4, s[8:11], s15 offen sc1
    s_waitcnt vmcnt(2)
    v_max3_u32 v118, v94, v95, v96
    v_max3_u32 v119, v97, v98, v99
    v_max3_u32 v119, v119, v100, v101
    v_max_u32 v118, v118, v119
    v_cmp_eq_u32 vcc, -1, v118
    s_nop 0
    s_cbranch_vccz A0_GOTA
    buffer_load_dwordx4 v[94:97], v3, s[8:11], s15 offen sc1
    buffer_load_dwordx4 v[98:101], v4, s[8:11], s15 offen sc1
    s_waitcnt vmcnt(2)
    v_max3_u32 v118, v74, v75, v76
    v_max3_u32 v119, v77, v78, v79
    v_max3_u32 v119, v119, v80, v81
    v_max_u32 v118, v118, v119
    v_cmp_eq_u32 vcc, -1, v118
    s_nop 0
    s_cbranch_vccz A0_GOTB
    s_sub_u32 s19, s19, 1
    s_cbranch_scc0 A0_PL
    s_mov_b32 s19, 0
    s_branch A0_GOTB
A0_GOTA:
    ds_write_b128 v3, v[94:97]
    ds_write_b128 v4, v[98:101]
    v_smfmac_f32_16x16x64_bf16 v[44:47], v[94:97], a[0:7], v2
    v_smfmac_f32_16x16x64_bf16 v[48:51], v[94:97], a[56:63], v2
    v_smfmac_f32_16x16x64_bf16 v[52:55], v[94:97], a[112:119], v2
    v_smfmac_f32_16x16x64_bf16 v[56:59], v[94:97], a[168:175], v2
    v_smfmac_f32_16x16x64_bf16 v[60:63], v[94:97], a[224:231], v2
    v_smfmac_f32_16x16x64_bf16 v[64:67], v[94:97], v[144:151], v2
    s_waitcnt lgkmcnt(0)
    s_barrier
    ds_read_b128 v[20:23], v5 offset:1024
    ds_read_b128 v[24:27], v5 offset:2048
    ds_read_b128 v[28:31], v5 offset:3072
    ds_read_b128 v[36:39], v5 offset:5120
    ds_read_b128 v[40:43], v5 offset:6144
    ds_read_b128 v[16:19], v5 offset:0
    ds_read_b128 v[32:35], v5 offset:4096
    buffer_load_dword v1, v0, s[8:11], s24 offen
    s_add_u32 s24, s24, 458752
    v_smfmac_f32_16x16x64_bf16 v[44:47], v[98:101], a[32:39], v2
    v_smfmac_f32_16x16x64_bf16 v[48:51], v[98:101], a[88:95], v2
    v_smfmac_f32_16x16x64_bf16 v[52:55], v[98:101], a[144:151], v2
    v_smfmac_f32_16x16x64_bf16 v[56:59], v[98:101], a[200:207], v2
    v_smfmac_f32_16x16x64_bf16 v[60:63], v[98:101], v[120:127], v2
    v_smfmac_f32_16x16x64_bf16 v[64:67], v[98:101], v[176:183], v2
    s_branch A0_PRE
A0_GOTB:
    ds_write_b128 v3, v[74:77]
    ds_write_b128 v4, v[78:81]
    v_smfmac_f32_16x16x64_bf16 v[44:47], v[74:77], a[0:7], v2
    v_smfmac_f32_16x16x64_bf16 v[48:51], v[74:77], a[56:63], v2
    v_smfmac_f32_16x16x64_bf16 v[52:55], v[74:77], a[112:119], v2
    v_smfmac_f32_16x16x64_bf16 v[56:59], v[74:77], a[168:175], v2
    v_smfmac_f32_16x16x64_bf16 v[60:63], v[74:77], a[224:231], v2
    v_smfmac_f32_16x16x64_bf16 v[64:67], v[74:77], v[144:151], v2
    s_waitcnt lgkmcnt(0)
    s_barrier
    ds_read_b128 v[20:23], v5 offset:1024
    ds_read_b128 v[24:27], v5 offset:2048
    ds_read_b128 v[28:31], v5 offset:3072
    ds_read_b128 v[36:39], v5 offset:5120
    ds_read_b128 v[40:43], v5 offset:6144
    ds_read_b128 v[16:19], v5 offset:0
    ds_read_b128 v[32:35], v5 offset:4096
    buffer_load_dword v1, v0, s[8:11], s24 offen
    s_add_u32 s24, s24, 458752
    v_smfmac_f32_16x16x64_bf16 v[44:47], v[78:81], a[32:39], v2
    v_smfmac_f32_16x16x64_bf16 v[48:51], v[78:81], a[88:95], v2
    v_smfmac_f32_16x16x64_bf16 v[52:55], v[78:81], a[144:151], v2
    v_smfmac_f32_16x16x64_bf16 v[56:59], v[78:81], a[200:207], v2
    v_smfmac_f32_16x16x64_bf16 v[60:63], v[78:81], v[120:127], v2
    v_smfmac_f32_16x16x64_bf16 v[64:67], v[78:81], v[176:183], v2
A0_PRE:
    s_waitcnt lgkmcnt(6)
    v_smfmac_f32_16x16x64_bf16 v[44:47], v[20:23], a[8:15], v2
    s_waitcnt lgkmcnt(5)
    v_smfmac_f32_16x16x64_bf16 v[44:47], v[24:27], a[16:23], v2
    ds_read2_b64 v[82:85], v8 offset0:0 offset1:32
    ds_read_b128 v[86:89], v9 offset:0
    ds_read_b128 v[90:93], v9 offset:4096
    s_waitcnt lgkmcnt(7)
    v_smfmac_f32_16x16x64_bf16 v[44:47], v[28:31], a[24:31], v2
    s_waitcnt lgkmcnt(6)
    v_smfmac_f32_16x16x64_bf16 v[44:47], v[36:39], a[40:47], v2
    s_waitcnt lgkmcnt(5)
    v_smfmac_f32_16x16x64_bf16 v[44:47], v[40:43], a[48:55], v2
    v_smfmac_f32_16x16x64_bf16 v[48:51], v[20:23], a[64:71], v2
    v_smfmac_f32_16x16x64_bf16 v[48:51], v[24:27], a[72:79], v2
    s_waitcnt vmcnt(1)
    v_smfmac_f32_16x16x64_bf16 v[48:51], v[28:31], a[80:87], v2
    v_smfmac_f32_16x16x64_bf16 v[48:51], v[36:39], a[96:103], v2
    v_smfmac_f32_16x16x64_bf16 v[48:51], v[40:43], a[104:111], v2
    v_smfmac_f32_16x16x64_bf16 v[52:55], v[20:23], a[120:127], v2
    v_smfmac_f32_16x16x64_bf16 v[52:55], v[24:27], a[128:135], v2
    s_nop 5
    v_permlane32_swap_b32 v44, v48
    v_permlane32_swap_b32 v45, v49
    v_permlane32_swap_b32 v46, v50
    v_permlane32_swap_b32 v47, v51
    v_add_f32 v44, v44, v48
    v_add_f32 v45, v45, v49
    v_add_f32 v46, v46, v50
    v_add_f32 v47, v47, v51
    v_cvt_pk_bf16_f32 v72, v44, v45
    v_cvt_pk_bf16_f32 v73, v46, v47
    ds_write_b64 v6, v[72:73] offset:0
    ds_read_b64_tr_b16 v[74:75], v7 offset:0
    ds_read_b64_tr_b16 v[76:77], v7 offset:256
    v_smfmac_f32_16x16x64_bf16 v[52:55], v[28:31], a[136:143], v2
    v_smfmac_f32_16x16x64_bf16 v[52:55], v[36:39], a[152:159], v2
    v_smfmac_f32_16x16x64_bf16 v[52:55], v[40:43], a[160:167], v2
    ds_read2_b64 v[94:97], v8 offset0:64 offset1:96
    ds_read_b128 v[98:101], v9 offset:1024
    ds_read_b128 v[102:105], v9 offset:5120
    v_smfmac_f32_16x16x64_bf16 v[56:59], v[20:23], a[176:183], v2
    v_smfmac_f32_16x16x64_bf16 v[56:59], v[24:27], a[184:191], v2
    v_smfmac_f32_16x16x64_bf16 v[56:59], v[28:31], a[192:199], v2
    v_smfmac_f32_16x16x64_bf16 v[56:59], v[36:39], a[208:215], v2
    v_smfmac_f32_16x16x64_bf16 v[56:59], v[40:43], a[216:223], v2
    v_smfmac_f32_16x16x64_bf16 v[60:63], v[20:23], a[232:239], v2
    v_smfmac_f32_16x16x64_bf16 v[60:63], v[24:27], a[240:247], v2
    s_waitcnt lgkmcnt(0)
    v_mfma_f32_16x16x32_bf16 v[106:109], v[82:85], v[74:77], v[106:109]
    s_nop 3
    v_permlane32_swap_b32 v52, v56
    v_permlane32_swap_b32 v53, v57
    v_mfma_f32_16x16x32_bf16 v[110:113], v[86:89], v[74:77], v[110:113]
    v_permlane32_swap_b32 v54, v58
    v_permlane32_swap_b32 v55, v59
    v_mfma_f32_16x16x32_bf16 v[114:117], v[90:93], v[74:77], v[114:117]
    v_add_f32 v52, v52, v56
    v_add_f32 v53, v53, v57
    v_add_f32 v54, v54, v58
    v_add_f32 v55, v55, v59
    v_cvt_pk_bf16_f32 v72, v52, v53
    v_cvt_pk_bf16_f32 v73, v54, v55
    ds_write_b64 v6, v[72:73] offset:512
    ds_read_b64_tr_b16 v[78:79], v7 offset:512
    ds_read_b64_tr_b16 v[80:81], v7 offset:768
    v_smfmac_f32_16x16x64_bf16 v[60:63], v[28:31], a[248:255], v2
    v_smfmac_f32_16x16x64_bf16 v[60:63], v[36:39], v[128:135], v2
    v_mov_b32 v44, 0
    v_mov_b32 v45, 0
    v_mov_b32 v46, 0
    v_mov_b32 v47, 0
    v_smfmac_f32_16x16x64_bf16 v[60:63], v[40:43], v[136:143], v2
    ds_read2_b64 v[82:85], v8 offset0:128 offset1:160
    ds_read_b128 v[86:89], v9 offset:2048
    ds_read_b128 v[90:93], v9 offset:6144
    v_smfmac_f32_16x16x64_bf16 v[64:67], v[20:23], v[152:159], v2
    v_smfmac_f32_16x16x64_bf16 v[64:67], v[24:27], v[160:167], v2
    v_smfmac_f32_16x16x64_bf16 v[64:67], v[28:31], v[168:175], v2
    v_smfmac_f32_16x16x64_bf16 v[64:67], v[36:39], v[184:191], v2
    v_smfmac_f32_16x16x64_bf16 v[64:67], v[40:43], v[192:199], v2
    v_smfmac_f32_16x16x64_bf16 v[68:71], v[20:23], v[208:215], v2
    v_smfmac_f32_16x16x64_bf16 v[68:71], v[24:27], v[216:223], v2
    s_waitcnt lgkmcnt(0)
    v_mfma_f32_16x16x32_bf16 v[106:109], v[94:97], v[78:81], v[106:109]
    s_nop 3
    v_permlane32_swap_b32 v60, v64
    v_permlane32_swap_b32 v61, v65
    v_mfma_f32_16x16x32_bf16 v[110:113], v[98:101], v[78:81], v[110:113]
    v_permlane32_swap_b32 v62, v66
    v_permlane32_swap_b32 v63, v67
    v_mfma_f32_16x16x32_bf16 v[114:117], v[102:105], v[78:81], v[114:117]
    v_add_f32 v60, v60, v64
    v_add_f32 v61, v61, v65
    v_add_f32 v62, v62, v66
    v_add_f32 v63, v63, v67
    v_cvt_pk_bf16_f32 v72, v60, v61
    v_cvt_pk_bf16_f32 v73, v62, v63
    ds_write_b64 v6, v[72:73] offset:1024
    ds_read_b64_tr_b16 v[74:75], v7 offset:1024
    ds_read_b64_tr_b16 v[76:77], v7 offset:1280
    v_smfmac_f32_16x16x64_bf16 v[68:71], v[28:31], v[224:231], v2
    v_smfmac_f32_16x16x64_bf16 v[68:71], v[36:39], v[240:247], v2
    ds_read_b64 v[94:95], v8 offset:1536
    ds_read_b64 v[98:99], v9 offset:3072
    ds_read_b64 v[102:103], v9 offset:7168
    v_smfmac_f32_16x16x64_bf16 v[68:71], v[40:43], v[248:255], v2
    v_smfmac_f32_16x16x64_bf16 v[68:71], v[16:19], v[200:207], v2
    v_smfmac_f32_16x16x64_bf16 v[68:71], v[32:35], v[232:239], v2
    s_waitcnt lgkmcnt(0)
    v_mfma_f32_16x16x32_bf16 v[106:109], v[82:85], v[74:77], v[106:109]
    v_mfma_f32_16x16x32_bf16 v[110:113], v[86:89], v[74:77], v[110:113]
    s_nop 4
    v_cvt_pk_bf16_f32 v72, v68, v69
    v_cvt_pk_bf16_f32 v73, v70, v71
    v_mfma_f32_16x16x32_bf16 v[114:117], v[90:93], v[74:77], v[114:117]
    s_nop 0
    v_mfma_f32_16x16x16_bf16 v[44:47], v[72:73], v[14:15], v[44:47]
    s_nop 7
    v_cvt_pk_bf16_f32 v78, v44, v45
    v_cvt_pk_bf16_f32 v79, v46, v47
    s_nop 1
    v_mfma_f32_16x16x16_bf16 v[106:109], v[94:95], v[78:79], v[106:109]
    v_mfma_f32_16x16x16_bf16 v[110:113], v[98:99], v[78:79], v[110:113]
    v_mfma_f32_16x16x16_bf16 v[114:117], v[102:103], v[78:79], v[114:117]
    s_mov_b32 exec_lo, 0x00ff00ff
    s_mov_b32 exec_hi, 0x00ff00ff
    s_nop 3
    ds_write_b128 v10, v[106:109] offset:0
    ds_write_b128 v10, v[110:113] offset:576
    ds_write_b128 v10, v[114:117] offset:1152
    s_mov_b64 exec, -1
    s_waitcnt lgkmcnt(0)
    s_barrier
    ds_read_b64 v[16:17], v11 offset:0
    ds_read_b64 v[18:19], v11 offset:1728
    ds_read_b64 v[20:21], v11 offset:3456
    ds_read_b64 v[22:23], v11 offset:5184
    s_waitcnt lgkmcnt(2)
    v_pk_add_f32 v[16:17], v[16:17], v[18:19]
    s_waitcnt lgkmcnt(0)
    v_pk_add_f32 v[20:21], v[20:21], v[22:23]
    v_pk_add_f32 v[16:17], v[16:17], v[20:21]
    v_max_f32 v24, v16, v17
    s_nop 1
    v_max_f32_dpp v24, v24, v24 quad_perm:[1,0,3,2] row_mask:0xf bank_mask:0xf
    s_nop 1
    v_max_f32_dpp v24, v24, v24 quad_perm:[2,3,0,1] row_mask:0xf bank_mask:0xf
    s_nop 1
    v_max_f32_dpp v24, v24, v24 row_half_mirror row_mask:0xf bank_mask:0xf
    s_nop 1
    v_max_f32_dpp v24, v24, v24 row_mirror row_mask:0xf bank_mask:0xf
    v_mov_b32 v25, v24
    s_nop 1
    v_permlane16_swap_b32 v24, v25
    v_max_f32 v24, v24, v25
    v_sub_f32 v16, v16, v24
    v_sub_f32 v17, v17, v24
    v_exp_f32 v16, v16
    v_exp_f32 v17, v17
    s_nop 0
    v_add_f32 v26, v16, v17
    v_mul_f32 v26, v26, v13
    s_nop 1
    v_add_f32_dpp v26, v26, v26 quad_perm:[1,0,3,2] row_mask:0xf bank_mask:0xf
    s_nop 1
    v_add_f32_dpp v26, v26, v26 quad_perm:[2,3,0,1] row_mask:0xf bank_mask:0xf
    s_nop 1
    v_add_f32_dpp v26, v26, v26 row_half_mirror row_mask:0xf bank_mask:0xf
    s_nop 1
    v_add_f32_dpp v26, v26, v26 row_mirror row_mask:0xf bank_mask:0xf
    v_mov_b32 v25, v26
    s_nop 1
    v_permlane16_swap_b32 v26, v25
    v_add_f32 v26, v26, v25
    v_rcp_f32 v26, v26
    s_nop 0
    v_mul_f32 v16, v16, v26
    v_mul_f32 v17, v17, v26
    v_cvt_pk_bf16_f32 v16, v16, v17
    buffer_store_dword v16, v12, s[8:11], s16 offen
    s_add_u32 s15, s15, 8192
    s_add_u32 s16, s16, 10240
    s_add_u32 s34, s34, 128
    s_add_u32 s33, s33, 128
    s_add_u32 s14, s14, 1
    s_cmp_lt_u32 s14, 63
    s_cbranch_scc1 A0_LOOP
    s_waitcnt vmcnt(0)
    s_endpgm
A1_LOOP:
    s_mov_b32 m0, s26
    s_nop 0
    buffer_load_dwordx4 v5, s[8:11], s17 offen offset:0 lds
    buffer_load_dwordx4 v5, s[8:11], s17 offen offset:1024 lds
    buffer_load_dwordx4 v5, s[8:11], s17 offen offset:2048 lds
    buffer_load_dwordx4 v5, s[8:11], s17 offen offset:3072 lds
    s_add_u32 m0, s26, 4096
    s_nop 0
    buffer_load_dwordx4 v5, s[8:11], s29 offen offset:0 lds
    buffer_load_dwordx4 v5, s[8:11], s29 offen offset:1024 lds
    buffer_load_dwordx4 v5, s[8:11], s29 offen offset:2048 lds
    buffer_load_dwordx4 v5, s[8:11], s29 offen offset:3072 lds
    s_add_u32 s17, s17, 32768
    s_add_u32 s29, s29, 32768
    v_mov_b32 v44, 0
    v_mov_b32 v45, 0
    v_mov_b32 v46, 0
    v_mov_b32 v47, 0
    v_mov_b32 v48, 0
    v_mov_b32 v49, 0
    v_mov_b32 v50, 0
    v_mov_b32 v51, 0
    v_mov_b32 v52, 0
    v_mov_b32 v53, 0
    v_mov_b32 v54, 0
    v_mov_b32 v55, 0
    v_mov_b32 v56, 0
    v_mov_b32 v57, 0
    v_mov_b32 v58, 0
    v_mov_b32 v59, 0
    v_mov_b32 v60, 0
    v_mov_b32 v61, 0
    v_mov_b32 v62, 0
    v_mov_b32 v63, 0
    v_mov_b32 v64, 0
    v_mov_b32 v65, 0
    v_mov_b32 v66, 0
    v_mov_b32 v67, 0
    v_mov_b32 v68, 0
    v_mov_b32 v69, 0
    v_mov_b32 v70, 0
    v_mov_b32 v71, 0
    v_mov_b32 v106, 0
    v_mov_b32 v107, 0
    v_mov_b32 v108, 0
    v_mov_b32 v109, 0
    v_mov_b32 v110, 0
    v_mov_b32 v111, 0
    v_mov_b32 v112, 0
    v_mov_b32 v113, 0
    v_mov_b32 v114, 0
    v_mov_b32 v115, 0
    v_mov_b32 v116, 0
    v_mov_b32 v117, 0
    buffer_load_dwordx4 v[94:97], v3, s[8:11], s15 offen sc1
    buffer_load_dwordx4 v[98:101], v4, s[8:11], s15 offen sc1
    s_sleep 3
A1_PL:
    buffer_load_dwordx4 v[74:77], v3, s[8:11], s15 offen sc1
    buffer_load_dwordx4 v[78:81], v4, s[8:11], s15 offen sc1
    s_waitcnt vmcnt(2)
    v_max3_u32 v118, v94, v95, v96
    v_max3_u32 v119, v97, v98, v99
    v_max3_u32 v119, v119, v100, v101
    v_max_u32 v118, v118, v119
    v_cmp_eq_u32 vcc, -1, v118
    s_nop 0
    s_cbranch_vccz A1_GOTA
    buffer_load_dwordx4 v[94:97], v3, s[8:11], s15 offen sc1
    buffer_load_dwordx4 v[98:101], v4, s[8:11], s15 offen sc1
    s_waitcnt vmcnt(2)
    v_max3_u32 v118, v74, v75, v76
    v_max3_u32 v119, v77, v78, v79
    v_max3_u32 v119, v119, v80, v81
    v_max_u32 v118, v118, v119
    v_cmp_eq_u32 vcc, -1, v118
    s_nop 0
    s_cbranch_vccz A1_GOTB
    s_sub_u32 s19, s19, 1
    s_cbranch_scc0 A1_PL
    s_mov_b32 s19, 0
    s_branch A1_GOTB
A1_GOTA:
    ds_write_b128 v3, v[94:97]
    ds_write_b128 v4, v[98:101]
    v_smfmac_f32_16x16x64_bf16 v[44:47], v[94:97], a[8:15], v2
    v_smfmac_f32_16x16x64_bf16 v[48:51], v[94:97], a[64:71], v2
    v_smfmac_f32_16x16x64_bf16 v[52:55], v[94:97], a[120:127], v2
    v_smfmac_f32_16x16x64_bf16 v[56:59], v[94:97], a[176:183], v2
    v_smfmac_f32_16x16x64_bf16 v[60:63], v[94:97], a[232:239], v2
    v_smfmac_f32_16x16x64_bf16 v[64:67], v[94:97], v[152:159], v2
    s_waitcnt lgkmcnt(0)
    s_barrier
    ds_read_b128 v[16:19], v5 offset:0
    ds_read_b128 v[24:27], v5 offset:2048
    ds_read_b128 v[28:31], v5 offset:3072
    ds_read_b128 v[32:35], v5 offset:4096
    ds_read_b128 v[40:43], v5 offset:6144
    ds_read_b128 v[20:23], v5 offset:1024
    ds_read_b128 v[36:39], v5 offset:5120
    buffer_load_dword v1, v0, s[8:11], s24 offen
    s_add_u32 s24, s24, 458752
    v_smfmac_f32_16x16x64_bf16 v[44:47], v[98:101], a[40:47], v2
    v_smfmac_f32_16x16x64_bf16 v[48:51], v[98:101], a[96:103], v2
    v_smfmac_f32_16x16x64_bf16 v[52:55], v[98:101], a[152:159], v2
    v_smfmac_f32_16x16x64_bf16 v[56:59], v[98:101], a[208:215], v2
    v_smfmac_f32_16x16x64_bf16 v[60:63], v[98:101], v[128:135], v2
    v_smfmac_f32_16x16x64_bf16 v[64:67], v[98:101], v[184:191], v2
    s_branch A1_PRE
A1_GOTB:
    ds_write_b128 v3, v[74:77]
    ds_write_b128 v4, v[78:81]
    v_smfmac_f32_16x16x64_bf16 v[44:47], v[74:77], a[8:15], v2
    v_smfmac_f32_16x16x64_bf16 v[48:51], v[74:77], a[64:71], v2
    v_smfmac_f32_16x16x64_bf16 v[52:55], v[74:77], a[120:127], v2
    v_smfmac_f32_16x16x64_bf16 v[56:59], v[74:77], a[176:183], v2
    v_smfmac_f32_16x16x64_bf16 v[60:63], v[74:77], a[232:239], v2
    v_smfmac_f32_16x16x64_bf16 v[64:67], v[74:77], v[152:159], v2
    s_waitcnt lgkmcnt(0)
    s_barrier
    ds_read_b128 v[16:19], v5 offset:0
    ds_read_b128 v[24:27], v5 offset:2048
    ds_read_b128 v[28:31], v5 offset:3072
    ds_read_b128 v[32:35], v5 offset:4096
    ds_read_b128 v[40:43], v5 offset:6144
    ds_read_b128 v[20:23], v5 offset:1024
    ds_read_b128 v[36:39], v5 offset:5120
    buffer_load_dword v1, v0, s[8:11], s24 offen
    s_add_u32 s24, s24, 458752
    v_smfmac_f32_16x16x64_bf16 v[44:47], v[78:81], a[40:47], v2
    v_smfmac_f32_16x16x64_bf16 v[48:51], v[78:81], a[96:103], v2
    v_smfmac_f32_16x16x64_bf16 v[52:55], v[78:81], a[152:159], v2
    v_smfmac_f32_16x16x64_bf16 v[56:59], v[78:81], a[208:215], v2
    v_smfmac_f32_16x16x64_bf16 v[60:63], v[78:81], v[128:135], v2
    v_smfmac_f32_16x16x64_bf16 v[64:67], v[78:81], v[184:191], v2
A1_PRE:
    s_waitcnt lgkmcnt(6)
    v_smfmac_f32_16x16x64_bf16 v[44:47], v[16:19], a[0:7], v2
    s_waitcnt lgkmcnt(5)
    v_smfmac_f32_16x16x64_bf16 v[44:47], v[24:27], a[16:23], v2
    ds_read2_b64 v[82:85], v8 offset0:0 offset1:32
    ds_read_b128 v[86:89], v9 offset:0
    ds_read_b128 v[90:93], v9 offset:4096
    s_waitcnt lgkmcnt(7)
    v_smfmac_f32_16x16x64_bf16 v[44:47], v[28:31], a[24:31], v2
    s_waitcnt lgkmcnt(6)
    v_smfmac_f32_16x16x64_bf16 v[44:47], v[32:35], a[32:39], v2
    s_waitcnt lgkmcnt(5)
    v_smfmac_f32_16x16x64_bf16 v[44:47], v[40:43], a[48:55], v2
    v_smfmac_f32_16x16x64_bf16 v[48:51], v[16:19], a[56:63], v2
    v_smfmac_f32_16x16x64_bf16 v[48:51], v[24:27], a[72:79], v2
    s_waitcnt vmcnt(1)
    v_smfmac_f32_16x16x64_bf16 v[48:51], v[28:31], a[80:87], v2
    v_smfmac_f32_16x16x64_bf16 v[48:51], v[32:35], a[88:95], v2
    v_smfmac_f32_16x16x64_bf16 v[48:51], v[40:43], a[104:111], v2
    v_smfmac_f32_16x16x64_bf16 v[52:55], v[16:19], a[112:119], v2
    v_smfmac_f32_16x16x64_bf16 v[52:55], v[24:27], a[128:135], v2
    s_nop 5
    v_permlane32_swap_b32 v44, v48
    v_permlane32_swap_b32 v45, v49
    v_permlane32_swap_b32 v46, v50
    v_permlane32_swap_b32 v47, v51
    v_add_f32 v44, v44, v48
    v_add_f32 v45, v45, v49
    v_add_f32 v46, v46, v50
    v_add_f32 v47, v47, v51
    v_cvt_pk_bf16_f32 v72, v44, v45
    v_cvt_pk_bf16_f32 v73, v46, v47
    ds_write_b64 v6, v[72:73] offset:0
    ds_read_b64_tr_b16 v[74:75], v7 offset:0
    ds_read_b64_tr_b16 v[76:77], v7 offset:256
    v_smfmac_f32_16x16x64_bf16 v[52:55], v[28:31], a[136:143], v2
    v_smfmac_f32_16x16x64_bf16 v[52:55], v[32:35], a[144:151], v2
    v_smfmac_f32_16x16x64_bf16 v[52:55], v[40:43], a[160:167], v2
    ds_read2_b64 v[94:97], v8 offset0:64 offset1:96
    ds_read_b128 v[98:101], v9 offset:1024
    ds_read_b128 v[102:105], v9 offset:5120
    v_smfmac_f32_16x16x64_bf16 v[56:59], v[16:19], a[168:175], v2
    v_smfmac_f32_16x16x64_bf16 v[56:59], v[24:27], a[184:191], v2
    v_smfmac_f32_16x16x64_bf16 v[56:59], v[28:31], a[192:199], v2
    v_smfmac_f32_16x16x64_bf16 v[56:59], v[32:35], a[200:207], v2
    v_smfmac_f32_16x16x64_bf16 v[56:59], v[40:43], a[216:223], v2
    v_smfmac_f32_16x16x64_bf16 v[60:63], v[16:19], a[224:231], v2
    v_smfmac_f32_16x16x64_bf16 v[60:63], v[24:27], a[240:247], v2
    s_waitcnt lgkmcnt(0)
    v_mfma_f32_16x16x32_bf16 v[106:109], v[82:85], v[74:77], v[106:109]
    s_nop 3
    v_permlane32_swap_b32 v52, v56
    v_permlane32_swap_b32 v53, v57
    v_mfma_f32_16x16x32_bf16 v[110:113], v[86:89], v[74:77], v[110:113]
    v_permlane32_swap_b32 v54, v58
    v_permlane32_swap_b32 v55, v59
    v_mfma_f32_16x16x32_bf16 v[114:117], v[90:93], v[74:77], v[114:117]
    v_add_f32 v52, v52, v56
    v_add_f32 v53, v53, v57
    v_add_f32 v54, v54, v58
    v_add_f32 v55, v55, v59
    v_cvt_pk_bf16_f32 v72, v52, v53
    v_cvt_pk_bf16_f32 v73, v54, v55
    ds_write_b64 v6, v[72:73] offset:512
    ds_read_b64_tr_b16 v[78:79], v7 offset:512
    ds_read_b64_tr_b16 v[80:81], v7 offset:768
    v_smfmac_f32_16x16x64_bf16 v[60:63], v[28:31], a[248:255], v2
    v_smfmac_f32_16x16x64_bf16 v[60:63], v[32:35], v[120:127], v2
    v_mov_b32 v44, 0
    v_mov_b32 v45, 0
    v_mov_b32 v46, 0
    v_mov_b32 v47, 0
    v_smfmac_f32_16x16x64_bf16 v[60:63], v[40:43], v[136:143], v2
    ds_read2_b64 v[82:85], v8 offset0:128 offset1:160
    ds_read_b128 v[86:89], v9 offset:2048
    ds_read_b128 v[90:93], v9 offset:6144
    v_smfmac_f32_16x16x64_bf16 v[64:67], v[16:19], v[144:151], v2
    v_smfmac_f32_16x16x64_bf16 v[64:67], v[24:27], v[160:167], v2
    v_smfmac_f32_16x16x64_bf16 v[64:67], v[28:31], v[168:175], v2
    v_smfmac_f32_16x16x64_bf16 v[64:67], v[32:35], v[176:183], v2
    v_smfmac_f32_16x16x64_bf16 v[64:67], v[40:43], v[192:199], v2
    v_smfmac_f32_16x16x64_bf16 v[68:71], v[16:19], v[200:207], v2
    v_smfmac_f32_16x16x64_bf16 v[68:71], v[24:27], v[216:223], v2
    s_waitcnt lgkmcnt(0)
    v_mfma_f32_16x16x32_bf16 v[106:109], v[94:97], v[78:81], v[106:109]
    s_nop 3
    v_permlane32_swap_b32 v60, v64
    v_permlane32_swap_b32 v61, v65
    v_mfma_f32_16x16x32_bf16 v[110:113], v[98:101], v[78:81], v[110:113]
    v_permlane32_swap_b32 v62, v66
    v_permlane32_swap_b32 v63, v67
    v_mfma_f32_16x16x32_bf16 v[114:117], v[102:105], v[78:81], v[114:117]
    v_add_f32 v60, v60, v64
    v_add_f32 v61, v61, v65
    v_add_f32 v62, v62, v66
    v_add_f32 v63, v63, v67
    v_cvt_pk_bf16_f32 v72, v60, v61
    v_cvt_pk_bf16_f32 v73, v62, v63
    ds_write_b64 v6, v[72:73] offset:1024
    ds_read_b64_tr_b16 v[74:75], v7 offset:1024
    ds_read_b64_tr_b16 v[76:77], v7 offset:1280
    v_smfmac_f32_16x16x64_bf16 v[68:71], v[28:31], v[224:231], v2
    v_smfmac_f32_16x16x64_bf16 v[68:71], v[32:35], v[232:239], v2
    ds_read_b64 v[94:95], v8 offset:1536
    ds_read_b64 v[98:99], v9 offset:3072
    ds_read_b64 v[102:103], v9 offset:7168
    v_smfmac_f32_16x16x64_bf16 v[68:71], v[40:43], v[248:255], v2
    v_smfmac_f32_16x16x64_bf16 v[68:71], v[20:23], v[208:215], v2
    v_smfmac_f32_16x16x64_bf16 v[68:71], v[36:39], v[240:247], v2
    s_waitcnt lgkmcnt(0)
    v_mfma_f32_16x16x32_bf16 v[106:109], v[82:85], v[74:77], v[106:109]
    v_mfma_f32_16x16x32_bf16 v[110:113], v[86:89], v[74:77], v[110:113]
    s_nop 4
    v_cvt_pk_bf16_f32 v72, v68, v69
    v_cvt_pk_bf16_f32 v73, v70, v71
    v_mfma_f32_16x16x32_bf16 v[114:117], v[90:93], v[74:77], v[114:117]
    s_nop 0
    v_mfma_f32_16x16x16_bf16 v[44:47], v[72:73], v[14:15], v[44:47]
    s_nop 7
    v_cvt_pk_bf16_f32 v78, v44, v45
    v_cvt_pk_bf16_f32 v79, v46, v47
    s_nop 1
    v_mfma_f32_16x16x16_bf16 v[106:109], v[94:95], v[78:79], v[106:109]
    v_mfma_f32_16x16x16_bf16 v[110:113], v[98:99], v[78:79], v[110:113]
    v_mfma_f32_16x16x16_bf16 v[114:117], v[102:103], v[78:79], v[114:117]
    s_mov_b32 exec_lo, 0x00ff00ff
    s_mov_b32 exec_hi, 0x00ff00ff
    s_nop 3
    ds_write_b128 v10, v[106:109] offset:0
    ds_write_b128 v10, v[110:113] offset:576
    ds_write_b128 v10, v[114:117] offset:1152
    s_mov_b64 exec, -1
    s_waitcnt lgkmcnt(0)
    s_barrier
    ds_read_b64 v[16:17], v11 offset:0
    ds_read_b64 v[18:19], v11 offset:1728
    ds_read_b64 v[20:21], v11 offset:3456
    ds_read_b64 v[22:23], v11 offset:5184
    s_waitcnt lgkmcnt(2)
    v_pk_add_f32 v[16:17], v[16:17], v[18:19]
    s_waitcnt lgkmcnt(0)
    v_pk_add_f32 v[20:21], v[20:21], v[22:23]
    v_pk_add_f32 v[16:17], v[16:17], v[20:21]
    v_max_f32 v24, v16, v17
    s_nop 1
    v_max_f32_dpp v24, v24, v24 quad_perm:[1,0,3,2] row_mask:0xf bank_mask:0xf
    s_nop 1
    v_max_f32_dpp v24, v24, v24 quad_perm:[2,3,0,1] row_mask:0xf bank_mask:0xf
    s_nop 1
    v_max_f32_dpp v24, v24, v24 row_half_mirror row_mask:0xf bank_mask:0xf
    s_nop 1
    v_max_f32_dpp v24, v24, v24 row_mirror row_mask:0xf bank_mask:0xf
    v_mov_b32 v25, v24
    s_nop 1
    v_permlane16_swap_b32 v24, v25
    v_max_f32 v24, v24, v25
    v_sub_f32 v16, v16, v24
    v_sub_f32 v17, v17, v24
    v_exp_f32 v16, v16
    v_exp_f32 v17, v17
    s_nop 0
    v_add_f32 v26, v16, v17
    v_mul_f32 v26, v26, v13
    s_nop 1
    v_add_f32_dpp v26, v26, v26 quad_perm:[1,0,3,2] row_mask:0xf bank_mask:0xf
    s_nop 1
    v_add_f32_dpp v26, v26, v26 quad_perm:[2,3,0,1] row_mask:0xf bank_mask:0xf
    s_nop 1
    v_add_f32_dpp v26, v26, v26 row_half_mirror row_mask:0xf bank_mask:0xf
    s_nop 1
    v_add_f32_dpp v26, v26, v26 row_mirror row_mask:0xf bank_mask:0xf
    v_mov_b32 v25, v26
    s_nop 1
    v_permlane16_swap_b32 v26, v25
    v_add_f32 v26, v26, v25
    v_rcp_f32 v26, v26
    s_nop 0
    v_mul_f32 v16, v16, v26
    v_mul_f32 v17, v17, v26
    v_cvt_pk_bf16_f32 v16, v16, v17
    buffer_store_dword v16, v12, s[8:11], s16 offen
    s_add_u32 s15, s15, 8192
    s_add_u32 s16, s16, 10240
    s_add_u32 s34, s34, 128
    s_add_u32 s33, s33, 128
    s_add_u32 s14, s14, 1
    s_cmp_lt_u32 s14, 63
    s_cbranch_scc1 A1_LOOP
    s_waitcnt vmcnt(0)
    s_endpgm
A2_LOOP:
    s_mov_b32 m0, s26
    s_nop 0
    buffer_load_dwordx4 v5, s[8:11], s17 offen offset:0 lds
    buffer_load_dwordx4 v5, s[8:11], s17 offen offset:1024 lds
    buffer_load_dwordx4 v5, s[8:11], s17 offen offset:2048 lds
    buffer_load_dwordx4 v5, s[8:11], s17 offen offset:3072 lds
    s_add_u32 m0, s26, 4096
    s_nop 0
    buffer_load_dwordx4 v5, s[8:11], s29 offen offset:0 lds
    buffer_load_dwordx4 v5, s[8:11], s29 offen offset:1024 lds
    buffer_load_dwordx4 v5, s[8:11], s29 offen offset:2048 lds
    buffer_load_dwordx4 v5, s[8:11], s29 offen offset:3072 lds
    s_add_u32 s17, s17, 32768
    s_add_u32 s29, s29, 32768
    v_mov_b32 v44, 0
    v_mov_b32 v45, 0
    v_mov_b32 v46, 0
    v_mov_b32 v47, 0
    v_mov_b32 v48, 0
    v_mov_b32 v49, 0
    v_mov_b32 v50, 0
    v_mov_b32 v51, 0
    v_mov_b32 v52, 0
    v_mov_b32 v53, 0
    v_mov_b32 v54, 0
    v_mov_b32 v55, 0
    v_mov_b32 v56, 0
    v_mov_b32 v57, 0
    v_mov_b32 v58, 0
    v_mov_b32 v59, 0
    v_mov_b32 v60, 0
    v_mov_b32 v61, 0
    v_mov_b32 v62, 0
    v_mov_b32 v63, 0
    v_mov_b32 v64, 0
    v_mov_b32 v65, 0
    v_mov_b32 v66, 0
    v_mov_b32 v67, 0
    v_mov_b32 v68, 0
    v_mov_b32 v69, 0
    v_mov_b32 v70, 0
    v_mov_b32 v71, 0
    v_mov_b32 v106, 0
    v_mov_b32 v107, 0
    v_mov_b32 v108, 0
    v_mov_b32 v109, 0
    v_mov_b32 v110, 0
    v_mov_b32 v111, 0
    v_mov_b32 v112, 0
    v_mov_b32 v113, 0
    v_mov_b32 v114, 0
    v_mov_b32 v115, 0
    v_mov_b32 v116, 0
    v_mov_b32 v117, 0
    buffer_load_dwordx4 v[94:97], v3, s[8:11], s15 offen sc1
    buffer_load_dwordx4 v[98:101], v4, s[8:11], s15 offen sc1
    s_sleep 3
A2_PL:
    buffer_load_dwordx4 v[74:77], v3, s[8:11], s15 offen sc1
    buffer_load_dwordx4 v[78:81], v4, s[8:11], s15 offen sc1
    s_waitcnt vmcnt(2)
    v_max3_u32 v118, v94, v95, v96
    v_max3_u32 v119, v97, v98, v99
    v_max3_u32 v119, v119, v100, v101
    v_max_u32 v118, v118, v119
    v_cmp_eq_u32 vcc, -1, v118
    s_nop 0
    s_cbranch_vccz A2_GOTA
    buffer_load_dwordx4 v[94:97], v3, s[8:11], s15 offen sc1
    buffer_load_dwordx4 v[98:101], v4, s[8:11], s15 offen sc1
    s_waitcnt vmcnt(2)
    v_max3_u32 v118, v74, v75, v76
    v_max3_u32 v119, v77, v78, v79
    v_max3_u32 v119, v119, v80, v81
    v_max_u32 v118, v118, v119
    v_cmp_eq_u32 vcc, -1, v118
    s_nop 0
    s_cbranch_vccz A2_GOTB
    s_sub_u32 s19, s19, 1
    s_cbranch_scc0 A2_PL
    s_mov_b32 s19, 0
    s_branch A2_GOTB
A2_GOTA:
    ds_write_b128 v3, v[94:97]
    ds_write_b128 v4, v[98:101]
    v_smfmac_f32_16x16x64_bf16 v[44:47], v[94:97], a[16:23], v2
    v_smfmac_f32_16x16x64_bf16 v[48:51], v[94:97], a[72:79], v2
    v_smfmac_f32_16x16x64_bf16 v[52:55], v[94:97], a[128:135], v2
    v_smfmac_f32_16x16x64_bf16 v[56:59], v[94:97], a[184:191], v2
    v_smfmac_f32_16x16x64_bf16 v[60:63], v[94:97], a[240:247], v2
    v_smfmac_f32_16x16x64_bf16 v[64:67], v[94:97], v[160:167], v2
    s_waitcnt lgkmcnt(0)
    s_barrier
    ds_read_b128 v[16:19], v5 offset:0
    ds_read_b128 v[20:23], v5 offset:1024
    ds_read_b128 v[28:31], v5 offset:3072
    ds_read_b128 v[32:35], v5 offset:4096
    ds_read_b128 v[36:39], v5 offset:5120
    ds_read_b128 v[24:27], v5 offset:2048
    ds_read_b128 v[40:43], v5 offset:6144
    buffer_load_dword v1, v0, s[8:11], s24 offen
    s_add_u32 s24, s24, 458752
    v_smfmac_f32_16x16x64_bf16 v[44:47], v[98:101], a[48:55], v2
    v_smfmac_f32_16x16x64_bf16 v[48:51], v[98:101], a[104:111], v2
    v_smfmac_f32_16x16x64_bf16 v[52:55], v[98:101], a[160:167], v2
    v_smfmac_f32_16x16x64_bf16 v[56:59], v[98:101], a[216:223], v2
    v_smfmac_f32_16x16x64_bf16 v[60:63], v[98:101], v[136:143], v2
    v_smfmac_f32_16x16x64_bf16 v[64:67], v[98:101], v[192:199], v2
    s_branch A2_PRE
A2_GOTB:
    ds_write_b128 v3, v[74:77]
    ds_write_b128 v4, v[78:81]
    v_smfmac_f32_16x16x64_bf16 v[44:47], v[74:77], a[16:23], v2
    v_smfmac_f32_16x16x64_bf16 v[48:51], v[74:77], a[72:79], v2
    v_smfmac_f32_16x16x64_bf16 v[52:55], v[74:77], a[128:135], v2
    v_smfmac_f32_16x16x64_bf16 v[56:59], v[74:77], a[184:191], v2
    v_smfmac_f32_16x16x64_bf16 v[60:63], v[74:77], a[240:247], v2
    v_smfmac_f32_16x16x64_bf16 v[64:67], v[74:77], v[160:167], v2
    s_waitcnt lgkmcnt(0)
    s_barrier
    ds_read_b128 v[16:19], v5 offset:0
    ds_read_b128 v[20:23], v5 offset:1024
    ds_read_b128 v[28:31], v5 offset:3072
    ds_read_b128 v[32:35], v5 offset:4096
    ds_read_b128 v[36:39], v5 offset:5120
    ds_read_b128 v[24:27], v5 offset:2048
    ds_read_b128 v[40:43], v5 offset:6144
    buffer_load_dword v1, v0, s[8:11], s24 offen
    s_add_u32 s24, s24, 458752
    v_smfmac_f32_16x16x64_bf16 v[44:47], v[78:81], a[48:55], v2
    v_smfmac_f32_16x16x64_bf16 v[48:51], v[78:81], a[104:111], v2
    v_smfmac_f32_16x16x64_bf16 v[52:55], v[78:81], a[160:167], v2
    v_smfmac_f32_16x16x64_bf16 v[56:59], v[78:81], a[216:223], v2
    v_smfmac_f32_16x16x64_bf16 v[60:63], v[78:81], v[136:143], v2
    v_smfmac_f32_16x16x64_bf16 v[64:67], v[78:81], v[192:199], v2
A2_PRE:
    s_waitcnt lgkmcnt(6)
    v_smfmac_f32_16x16x64_bf16 v[44:47], v[16:19], a[0:7], v2
    s_waitcnt lgkmcnt(5)
    v_smfmac_f32_16x16x64_bf16 v[44:47], v[20:23], a[8:15], v2
    ds_read2_b64 v[82:85], v8 offset0:0 offset1:32
    ds_read_b128 v[86:89], v9 offset:0
    ds_read_b128 v[90:93], v9 offset:4096
    s_waitcnt lgkmcnt(7)
    v_smfmac_f32_16x16x64_bf16 v[44:47], v[28:31], a[24:31], v2
    s_waitcnt lgkmcnt(6)
    v_smfmac_f32_16x16x64_bf16 v[44:47], v[32:35], a[32:39], v2
    s_waitcnt lgkmcnt(5)
    v_smfmac_f32_16x16x64_bf16 v[44:47], v[36:39], a[40:47], v2
    v_smfmac_f32_16x16x64_bf16 v[48:51], v[16:19], a[56:63], v2
    v_smfmac_f32_16x16x64_bf16 v[48:51], v[20:23], a[64:71], v2
    s_waitcnt vmcnt(1)
    v_smfmac_f32_16x16x64_bf16 v[48:51], v[28:31], a[80:87], v2
    v_smfmac_f32_16x16x64_bf16 v[48:51], v[32:35], a[88:95], v2
    v_smfmac_f32_16x16x64_bf16 v[48:51], v[36:39], a[96:103], v2
    v_smfmac_f32_16x16x64_bf16 v[52:55], v[16:19], a[112:119], v2
    v_smfmac_f32_16x16x64_bf16 v[52:55], v[20:23], a[120:127], v2
    s_nop 5
    v_permlane32_swap_b32 v44, v48
    v_permlane32_swap_b32 v45, v49
    v_permlane32_swap_b32 v46, v50
    v_permlane32_swap_b32 v47, v51
    v_add_f32 v44, v44, v48
    v_add_f32 v45, v45, v49
    v_add_f32 v46, v46, v50
    v_add_f32 v47, v47, v51
    v_cvt_pk_bf16_f32 v72, v44, v45
    v_cvt_pk_bf16_f32 v73, v46, v47
    ds_write_b64 v6, v[72:73] offset:0
    ds_read_b64_tr_b16 v[74:75], v7 offset:0
    ds_read_b64_tr_b16 v[76:77], v7 offset:256
    v_smfmac_f32_16x16x64_bf16 v[52:55], v[28:31], a[136:143], v2
    v_smfmac_f32_16x16x64_bf16 v[52:55], v[32:35], a[144:151], v2
    v_smfmac_f32_16x16x64_bf16 v[52:55], v[36:39], a[152:159], v2
    ds_read2_b64 v[94:97], v8 offset0:64 offset1:96
    ds_read_b128 v[98:101], v9 offset:1024
    ds_read_b128 v[102:105], v9 offset:5120
    v_smfmac_f32_16x16x64_bf16 v[56:59], v[16:19], a[168:175], v2
    v_smfmac_f32_16x16x64_bf16 v[56:59], v[20:23], a[176:183], v2
    v_smfmac_f32_16x16x64_bf16 v[56:59], v[28:31], a[192:199], v2
    v_smfmac_f32_16x16x64_bf16 v[56:59], v[32:35], a[200:207], v2
    v_smfmac_f32_16x16x64_bf16 v[56:59], v[36:39], a[208:215], v2
    v_smfmac_f32_16x16x64_bf16 v[60:63], v[16:19], a[224:231], v2
    v_smfmac_f32_16x16x64_bf16 v[60:63], v[20:23], a[232:239], v2
    s_waitcnt lgkmcnt(0)
    v_mfma_f32_16x16x32_bf16 v[106:109], v[82:85], v[74:77], v[106:109]
    s_nop 3
    v_permlane32_swap_b32 v52, v56
    v_permlane32_swap_b32 v53, v57
    v_mfma_f32_16x16x32_bf16 v[110:113], v[86:89], v[74:77], v[110:113]
    v_permlane32_swap_b32 v54, v58
    v_permlane32_swap_b32 v55, v59
    v_mfma_f32_16x16x32_bf16 v[114:117], v[90:93], v[74:77], v[114:117]
    v_add_f32 v52, v52, v56
    v_add_f32 v53, v53, v57
    v_add_f32 v54, v54, v58
    v_add_f32 v55, v55, v59
    v_cvt_pk_bf16_f32 v72, v52, v53
    v_cvt_pk_bf16_f32 v73, v54, v55
    ds_write_b64 v6, v[72:73] offset:512
    ds_read_b64_tr_b16 v[78:79], v7 offset:512
    ds_read_b64_tr_b16 v[80:81], v7 offset:768
    v_smfmac_f32_16x16x64_bf16 v[60:63], v[28:31], a[248:255], v2
    v_smfmac_f32_16x16x64_bf16 v[60:63], v[32:35], v[120:127], v2
    v_mov_b32 v44, 0
    v_mov_b32 v45, 0
    v_mov_b32 v46, 0
    v_mov_b32 v47, 0
    v_smfmac_f32_16x16x64_bf16 v[60:63], v[36:39], v[128:135], v2
    ds_read2_b64 v[82:85], v8 offset0:128 offset1:160
    ds_read_b128 v[86:89], v9 offset:2048
    ds_read_b128 v[90:93], v9 offset:6144
    v_smfmac_f32_16x16x64_bf16 v[64:67], v[16:19], v[144:151], v2
    v_smfmac_f32_16x16x64_bf16 v[64:67], v[20:23], v[152:159], v2
    v_smfmac_f32_16x16x64_bf16 v[64:67], v[28:31], v[168:175], v2
    v_smfmac_f32_16x16x64_bf16 v[64:67], v[32:35], v[176:183], v2
    v_smfmac_f32_16x16x64_bf16 v[64:67], v[36:39], v[184:191], v2
    v_smfmac_f32_16x16x64_bf16 v[68:71], v[16:19], v[200:207], v2
    v_smfmac_f32_16x16x64_bf16 v[68:71], v[20:23], v[208:215], v2
    s_waitcnt lgkmcnt(0)
    v_mfma_f32_16x16x32_bf16 v[106:109], v[94:97], v[78:81], v[106:109]
    s_nop 3
    v_permlane32_swap_b32 v60, v64
    v_permlane32_swap_b32 v61, v65
    v_mfma_f32_16x16x32_bf16 v[110:113], v[98:101], v[78:81], v[110:113]
    v_permlane32_swap_b32 v62, v66
    v_permlane32_swap_b32 v63, v67
    v_mfma_f32_16x16x32_bf16 v[114:117], v[102:105], v[78:81], v[114:117]
    v_add_f32 v60, v60, v64
    v_add_f32 v61, v61, v65
    v_add_f32 v62, v62, v66
    v_add_f32 v63, v63, v67
    v_cvt_pk_bf16_f32 v72, v60, v61
    v_cvt_pk_bf16_f32 v73, v62, v63
    ds_write_b64 v6, v[72:73] offset:1024
    ds_read_b64_tr_b16 v[74:75], v7 offset:1024
    ds_read_b64_tr_b16 v[76:77], v7 offset:1280
    v_smfmac_f32_16x16x64_bf16 v[68:71], v[28:31], v[224:231], v2
    v_smfmac_f32_16x16x64_bf16 v[68:71], v[32:35], v[232:239], v2
    ds_read_b64 v[94:95], v8 offset:1536
    ds_read_b64 v[98:99], v9 offset:3072
    ds_read_b64 v[102:103], v9 offset:7168
    v_smfmac_f32_16x16x64_bf16 v[68:71], v[36:39], v[240:247], v2
    v_smfmac_f32_16x16x64_bf16 v[68:71], v[24:27], v[216:223], v2
    v_smfmac_f32_16x16x64_bf16 v[68:71], v[40:43], v[248:255], v2
    s_waitcnt lgkmcnt(0)
    v_mfma_f32_16x16x32_bf16 v[106:109], v[82:85], v[74:77], v[106:109]
    v_mfma_f32_16x16x32_bf16 v[110:113], v[86:89], v[74:77], v[110:113]
    s_nop 4
    v_cvt_pk_bf16_f32 v72, v68, v69
    v_cvt_pk_bf16_f32 v73, v70, v71
    v_mfma_f32_16x16x32_bf16 v[114:117], v[90:93], v[74:77], v[114:117]
    s_nop 0
    v_mfma_f32_16x16x16_bf16 v[44:47], v[72:73], v[14:15], v[44:47]
    s_nop 7
    v_cvt_pk_bf16_f32 v78, v44, v45
    v_cvt_pk_bf16_f32 v79, v46, v47
    s_nop 1
    v_mfma_f32_16x16x16_bf16 v[106:109], v[94:95], v[78:79], v[106:109]
    v_mfma_f32_16x16x16_bf16 v[110:113], v[98:99], v[78:79], v[110:113]
    v_mfma_f32_16x16x16_bf16 v[114:117], v[102:103], v[78:79], v[114:117]
    s_mov_b32 exec_lo, 0x00ff00ff
    s_mov_b32 exec_hi, 0x00ff00ff
    s_nop 3
    ds_write_b128 v10, v[106:109] offset:0
    ds_write_b128 v10, v[110:113] offset:576
    ds_write_b128 v10, v[114:117] offset:1152
    s_mov_b64 exec, -1
    s_waitcnt lgkmcnt(0)
    s_barrier
    ds_read_b64 v[16:17], v11 offset:0
    ds_read_b64 v[18:19], v11 offset:1728
    ds_read_b64 v[20:21], v11 offset:3456
    ds_read_b64 v[22:23], v11 offset:5184
    s_waitcnt lgkmcnt(2)
    v_pk_add_f32 v[16:17], v[16:17], v[18:19]
    s_waitcnt lgkmcnt(0)
    v_pk_add_f32 v[20:21], v[20:21], v[22:23]
    v_pk_add_f32 v[16:17], v[16:17], v[20:21]
    v_max_f32 v24, v16, v17
    s_nop 1
    v_max_f32_dpp v24, v24, v24 quad_perm:[1,0,3,2] row_mask:0xf bank_mask:0xf
    s_nop 1
    v_max_f32_dpp v24, v24, v24 quad_perm:[2,3,0,1] row_mask:0xf bank_mask:0xf
    s_nop 1
    v_max_f32_dpp v24, v24, v24 row_half_mirror row_mask:0xf bank_mask:0xf
    s_nop 1
    v_max_f32_dpp v24, v24, v24 row_mirror row_mask:0xf bank_mask:0xf
    v_mov_b32 v25, v24
    s_nop 1
    v_permlane16_swap_b32 v24, v25
    v_max_f32 v24, v24, v25
    v_sub_f32 v16, v16, v24
    v_sub_f32 v17, v17, v24
    v_exp_f32 v16, v16
    v_exp_f32 v17, v17
    s_nop 0
    v_add_f32 v26, v16, v17
    v_mul_f32 v26, v26, v13
    s_nop 1
    v_add_f32_dpp v26, v26, v26 quad_perm:[1,0,3,2] row_mask:0xf bank_mask:0xf
    s_nop 1
    v_add_f32_dpp v26, v26, v26 quad_perm:[2,3,0,1] row_mask:0xf bank_mask:0xf
    s_nop 1
    v_add_f32_dpp v26, v26, v26 row_half_mirror row_mask:0xf bank_mask:0xf
    s_nop 1
    v_add_f32_dpp v26, v26, v26 row_mirror row_mask:0xf bank_mask:0xf
    v_mov_b32 v25, v26
    s_nop 1
    v_permlane16_swap_b32 v26, v25
    v_add_f32 v26, v26, v25
    v_rcp_f32 v26, v26
    s_nop 0
    v_mul_f32 v16, v16, v26
    v_mul_f32 v17, v17, v26
    v_cvt_pk_bf16_f32 v16, v16, v17
    buffer_store_dword v16, v12, s[8:11], s16 offen
    s_add_u32 s15, s15, 8192
    s_add_u32 s16, s16, 10240
    s_add_u32 s34, s34, 128
    s_add_u32 s33, s33, 128
    s_add_u32 s14, s14, 1
    s_cmp_lt_u32 s14, 63
    s_cbranch_scc1 A2_LOOP
    s_waitcnt vmcnt(0)
    s_endpgm
A3_LOOP:
    s_mov_b32 m0, s26
    s_nop 0
    buffer_load_dwordx4 v5, s[8:11], s17 offen offset:0 lds
    buffer_load_dwordx4 v5, s[8:11], s17 offen offset:1024 lds
    buffer_load_dwordx4 v5, s[8:11], s17 offen offset:2048 lds
    buffer_load_dwordx4 v5, s[8:11], s17 offen offset:3072 lds
    s_add_u32 m0, s26, 4096
    s_nop 0
    buffer_load_dwordx4 v5, s[8:11], s29 offen offset:0 lds
    buffer_load_dwordx4 v5, s[8:11], s29 offen offset:1024 lds
    buffer_load_dwordx4 v5, s[8:11], s29 offen offset:2048 lds
    buffer_load_dwordx4 v5, s[8:11], s29 offen offset:3072 lds
    s_add_u32 s17, s17, 32768
    s_add_u32 s29, s29, 32768
    v_mov_b32 v44, 0
    v_mov_b32 v45, 0
    v_mov_b32 v46, 0
    v_mov_b32 v47, 0
    v_mov_b32 v48, 0
    v_mov_b32 v49, 0
    v_mov_b32 v50, 0
    v_mov_b32 v51, 0
    v_mov_b32 v52, 0
    v_mov_b32 v53, 0
    v_mov_b32 v54, 0
    v_mov_b32 v55, 0
    v_mov_b32 v56, 0
    v_mov_b32 v57, 0
    v_mov_b32 v58, 0
    v_mov_b32 v59, 0
    v_mov_b32 v60, 0
    v_mov_b32 v61, 0
    v_mov_b32 v62, 0
    v_mov_b32 v63, 0
    v_mov_b32 v64, 0
    v_mov_b32 v65, 0
    v_mov_b32 v66, 0
    v_mov_b32 v67, 0
    v_mov_b32 v68, 0
    v_mov_b32 v69, 0
    v_mov_b32 v70, 0
    v_mov_b32 v71, 0
    v_mov_b32 v106, 0
    v_mov_b32 v107, 0
    v_mov_b32 v108, 0
    v_mov_b32 v109, 0
    v_mov_b32 v110, 0
    v_mov_b32 v111, 0
    v_mov_b32 v112, 0
    v_mov_b32 v113, 0
    v_mov_b32 v114, 0
    v_mov_b32 v115, 0
    v_mov_b32 v116, 0
    v_mov_b32 v117, 0
    buffer_load_dwordx4 v[94:97], v3, s[8:11], s15 offen sc1
    buffer_load_dwordx4 v[98:101], v4, s[8:11], s15 offen sc1
    s_sleep 3
A3_PL:
    buffer_load_dwordx4 v[74:77], v3, s[8:11], s15 offen sc1
    buffer_load_dwordx4 v[78:81], v4, s[8:11], s15 offen sc1
    s_waitcnt vmcnt(2)
    v_max3_u32 v118, v94, v95, v96
    v_max3_u32 v119, v97, v98, v99
    v_max3_u32 v119, v119, v100, v101
    v_max_u32 v118, v118, v119
    v_cmp_eq_u32 vcc, -1, v118
    s_nop 0
    s_cbranch_vccz A3_GOTA
    buffer_load_dwordx4 v[94:97], v3, s[8:11], s15 offen sc1
    buffer_load_dwordx4 v[98:101], v4, s[8:11], s15 offen sc1
    s_waitcnt vmcnt(2)
    v_max3_u32 v118, v74, v75, v76
    v_max3_u32 v119, v77, v78, v79
    v_max3_u32 v119, v119, v80, v81
    v_max_u32 v118, v118, v119
    v_cmp_eq_u32 vcc, -1, v118
    s_nop 0
    s_cbranch_vccz A3_GOTB
    s_sub_u32 s19, s19, 1
    s_cbranch_scc0 A3_PL
    s_mov_b32 s19, 0
    s_branch A3_GOTB
A3_GOTA:
    ds_write_b128 v3, v[94:97]
    ds_write_b128 v4, v[98:101]
    v_smfmac_f32_16x16x64_bf16 v[44:47], v[94:97], a[24:31], v2
    v_smfmac_f32_16x16x64_bf16 v[48:51], v[94:97], a[80:87], v2
    v_smfmac_f32_16x16x64_bf16 v[52:55], v[94:97], a[136:143], v2
    v_smfmac_f32_16x16x64_bf16 v[56:59], v[94:97], a[192:199], v2
    v_smfmac_f32_16x16x64_bf16 v[60:63], v[94:97], a[248:255], v2
    v_smfmac_f32_16x16x64_bf16 v[64:67], v[94:97], v[168:175], v2
    s_waitcnt lgkmcnt(0)
    s_barrier
    ds_read_b128 v[16:19], v5 offset:0
    ds_read_b128 v[20:23], v5 offset:1024
    ds_read_b128 v[24:27], v5 offset:2048
    ds_read_b128 v[32:35], v5 offset:4096
    ds_read_b128 v[36:39], v5 offset:5120
    ds_read_b128 v[40:43], v5 offset:6144
    ds_read_b128 v[28:31], v5 offset:3072
    buffer_load_dword v1, v0, s[8:11], s24 offen
    s_add_u32 s24, s24, 458752
    s_branch A3_PRE
A3_GOTB:
    ds_write_b128 v3, v[74:77]
    ds_write_b128 v4, v[78:81]
    v_smfmac_f32_16x16x64_bf16 v[44:47], v[74:77], a[24:31], v2
    v_smfmac_f32_16x16x64_bf16 v[48:51], v[74:77], a[80:87], v2
    v_smfmac_f32_16x16x64_bf16 v[52:55], v[74:77], a[136:143], v2
    v_smfmac_f32_16x16x64_bf16 v[56:59], v[74:77], a[192:199], v2
    v_smfmac_f32_16x16x64_bf16 v[60:63], v[74:77], a[248:255], v2
    v_smfmac_f32_16x16x64_bf16 v[64:67], v[74:77], v[168:175], v2
    s_waitcnt lgkmcnt(0)
    s_barrier
    ds_read_b128 v[16:19], v5 offset:0
    ds_read_b128 v[20:23], v5 offset:1024
    ds_read_b128 v[24:27], v5 offset:2048
    ds_read_b128 v[32:35], v5 offset:4096
    ds_read_b128 v[36:39], v5 offset:5120
    ds_read_b128 v[40:43], v5 offset:6144
    ds_read_b128 v[28:31], v5 offset:3072
    buffer_load_dword v1, v0, s[8:11], s24 offen
    s_add_u32 s24, s24, 458752
A3_PRE:
    s_waitcnt lgkmcnt(6)
    v_smfmac_f32_16x16x64_bf16 v[44:47], v[16:19], a[0:7], v2
    s_waitcnt lgkmcnt(5)
    v_smfmac_f32_16x16x64_bf16 v[44:47], v[20:23], a[8:15], v2
    ds_read2_b64 v[82:85], v8 offset0:0 offset1:32
    ds_read_b128 v[86:89], v9 offset:0
    ds_read_b128 v[90:93], v9 offset:4096
    s_waitcnt lgkmcnt(7)
    v_smfmac_f32_16x16x64_bf16 v[44:47], v[24:27], a[16:23], v2
    s_waitcnt lgkmcnt(6)
    v_smfmac_f32_16x16x64_bf16 v[44:47], v[32:35], a[32:39], v2
    s_waitcnt lgkmcnt(5)
    v_smfmac_f32_16x16x64_bf16 v[44:47], v[36:39], a[40:47], v2
    s_waitcnt lgkmcnt(4)
    v_smfmac_f32_16x16x64_bf16 v[44:47], v[40:43], a[48:55], v2
    v_smfmac_f32_16x16x64_bf16 v[48:51], v[16:19], a[56:63], v2
    s_waitcnt vmcnt(1)
    v_smfmac_f32_16x16x64_bf16 v[48:51], v[20:23], a[64:71], v2
    v_smfmac_f32_16x16x64_bf16 v[48:51], v[24:27], a[72:79], v2
    v_smfmac_f32_16x16x64_bf16 v[48:51], v[32:35], a[88:95], v2
    v_smfmac_f32_16x16x64_bf16 v[48:51], v[36:39], a[96:103], v2
    v_smfmac_f32_16x16x64_bf16 v[48:51], v[40:43], a[104:111], v2
    v_smfmac_f32_16x16x64_bf16 v[52:55], v[16:19], a[112:119], v2
    v_smfmac_f32_16x16x64_bf16 v[52:55], v[20:23], a[120:127], v2
    s_nop 5
    v_permlane32_swap_b32 v44, v48
    v_permlane32_swap_b32 v45, v49
    v_permlane32_swap_b32 v46, v50
    v_permlane32_swap_b32 v47, v51
    v_add_f32 v44, v44, v48
    v_add_f32 v45, v45, v49
    v_add_f32 v46, v46, v50
    v_add_f32 v47, v47, v51
    v_cvt_pk_bf16_f32 v72, v44, v45
    v_cvt_pk_bf16_f32 v73, v46, v47
    ds_write_b64 v6, v[72:73] offset:0
    ds_read_b64_tr_b16 v[74:75], v7 offset:0
    ds_read_b64_tr_b16 v[76:77], v7 offset:256
    v_smfmac_f32_16x16x64_bf16 v[52:55], v[24:27], a[128:135], v2
    v_smfmac_f32_16x16x64_bf16 v[52:55], v[32:35], a[144:151], v2
    v_smfmac_f32_16x16x64_bf16 v[52:55], v[36:39], a[152:159], v2
    ds_read2_b64 v[94:97], v8 offset0:64 offset1:96
    ds_read_b128 v[98:101], v9 offset:1024
    ds_read_b128 v[102:105], v9 offset:5120
    v_smfmac_f32_16x16x64_bf16 v[52:55], v[40:43], a[160:167], v2
    v_smfmac_f32_16x16x64_bf16 v[56:59], v[16:19], a[168:175], v2
    v_smfmac_f32_16x16x64_bf16 v[56:59], v[20:23], a[176:183], v2
    v_smfmac_f32_16x16x64_bf16 v[56:59], v[24:27], a[184:191], v2
    v_smfmac_f32_16x16x64_bf16 v[56:59], v[32:35], a[200:207], v2
    v_smfmac_f32_16x16x64_bf16 v[56:59], v[36:39], a[208:215], v2
    v_smfmac_f32_16x16x64_bf16 v[56:59], v[40:43], a[216:223], v2
    v_smfmac_f32_16x16x64_bf16 v[60:63], v[16:19], a[224:231], v2
    v_smfmac_f32_16x16x64_bf16 v[60:63], v[20:23], a[232:239], v2
    s_waitcnt lgkmcnt(0)
    v_mfma_f32_16x16x32_bf16 v[106:109], v[82:85], v[74:77], v[106:109]
    s_nop 3
    v_permlane32_swap_b32 v52, v56
    v_permlane32_swap_b32 v53, v57
    v_mfma_f32_16x16x32_bf16 v[110:113], v[86:89], v[74:77], v[110:113]
    v_permlane32_swap_b32 v54, v58
    v_permlane32_swap_b32 v55, v59
    v_mfma_f32_16x16x32_bf16 v[114:117], v[90:93], v[74:77], v[114:117]
    v_add_f32 v52, v52, v56
    v_add_f32 v53, v53, v57
    v_add_f32 v54, v54, v58
    v_add_f32 v55, v55, v59
    v_cvt_pk_bf16_f32 v72, v52, v53
    v_cvt_pk_bf16_f32 v73, v54, v55
    ds_write_b64 v6, v[72:73] offset:512
    ds_read_b64_tr_b16 v[78:79], v7 offset:512
    ds_read_b64_tr_b16 v[80:81], v7 offset:768
    v_smfmac_f32_16x16x64_bf16 v[60:63], v[24:27], a[240:247], v2
    v_smfmac_f32_16x16x64_bf16 v[60:63], v[32:35], v[120:127], v2
    v_mov_b32 v44, 0
    v_mov_b32 v45, 0
    v_mov_b32 v46, 0
    v_mov_b32 v47, 0
    v_smfmac_f32_16x16x64_bf16 v[60:63], v[36:39], v[128:135], v2
    ds_read2_b64 v[82:85], v8 offset0:128 offset1:160
    ds_read_b128 v[86:89], v9 offset:2048
    ds_read_b128 v[90:93], v9 offset:6144
    v_smfmac_f32_16x16x64_bf16 v[60:63], v[40:43], v[136:143], v2
    v_smfmac_f32_16x16x64_bf16 v[64:67], v[16:19], v[144:151], v2
    v_smfmac_f32_16x16x64_bf16 v[64:67], v[20:23], v[152:159], v2
    v_smfmac_f32_16x16x64_bf16 v[64:67], v[24:27], v[160:167], v2
    v_smfmac_f32_16x16x64_bf16 v[64:67], v[32:35], v[176:183], v2
    v_smfmac_f32_16x16x64_bf16 v[64:67], v[36:39], v[184:191], v2
    v_smfmac_f32_16x16x64_bf16 v[64:67], v[40:43], v[192:199], v2
    v_smfmac_f32_16x16x64_bf16 v[68:71], v[16:19], v[200:207], v2
    v_smfmac_f32_16x16x64_bf16 v[68:71], v[20:23], v[208:215], v2
    s_waitcnt lgkmcnt(0)
    v_mfma_f32_16x16x32_bf16 v[106:109], v[94:97], v[78:81], v[106:109]
    s_nop 3
    v_permlane32_swap_b32 v60, v64
    v_permlane32_swap_b32 v61, v65
    v_mfma_f32_16x16x32_bf16 v[110:113], v[98:101], v[78:81], v[110:113]
    v_permlane32_swap_b32 v62, v66
    v_permlane32_swap_b32 v63, v67
    v_mfma_f32_16x16x32_bf16 v[114:117], v[102:105], v[78:81], v[114:117]
    v_add_f32 v60, v60, v64
    v_add_f32 v61, v61, v65
    v_add_f32 v62, v62, v66
    v_add_f32 v63, v63, v67
    v_cvt_pk_bf16_f32 v72, v60, v61
    v_cvt_pk_bf16_f32 v73, v62, v63
    ds_write_b64 v6, v[72:73] offset:1024
    ds_read_b64_tr_b16 v[74:75], v7 offset:1024
    ds_read_b64_tr_b16 v[76:77], v7 offset:1280
    v_smfmac_f32_16x16x64_bf16 v[68:71], v[24:27], v[216:223], v2
    v_smfmac_f32_16x16x64_bf16 v[68:71], v[32:35], v[232:239], v2
    ds_read_b64 v[94:95], v8 offset:1536
    ds_read_b64 v[98:99], v9 offset:3072
    ds_read_b64 v[102:103], v9 offset:7168
    v_smfmac_f32_16x16x64_bf16 v[68:71], v[36:39], v[240:247], v2
    v_smfmac_f32_16x16x64_bf16 v[68:71], v[40:43], v[248:255], v2
    v_smfmac_f32_16x16x64_bf16 v[68:71], v[28:31], v[224:231], v2
    s_waitcnt lgkmcnt(0)
    v_mfma_f32_16x16x32_bf16 v[106:109], v[82:85], v[74:77], v[106:109]
    v_mfma_f32_16x16x32_bf16 v[110:113], v[86:89], v[74:77], v[110:113]
    s_nop 4
    v_cvt_pk_bf16_f32 v72, v68, v69
    v_cvt_pk_bf16_f32 v73, v70, v71
    v_mfma_f32_16x16x32_bf16 v[114:117], v[90:93], v[74:77], v[114:117]
    s_nop 0
    v_mfma_f32_16x16x16_bf16 v[44:47], v[72:73], v[14:15], v[44:47]
    s_nop 7
    v_cvt_pk_bf16_f32 v78, v44, v45
    v_cvt_pk_bf16_f32 v79, v46, v47
    s_nop 1
    v_mfma_f32_16x16x16_bf16 v[106:109], v[94:95], v[78:79], v[106:109]
    v_mfma_f32_16x16x16_bf16 v[110:113], v[98:99], v[78:79], v[110:113]
    v_mfma_f32_16x16x16_bf16 v[114:117], v[102:103], v[78:79], v[114:117]
    s_mov_b32 exec_lo, 0x00ff00ff
    s_mov_b32 exec_hi, 0x00ff00ff
    s_nop 3
    ds_write_b128 v10, v[106:109] offset:0
    ds_write_b128 v10, v[110:113] offset:576
    ds_write_b128 v10, v[114:117] offset:1152
    s_mov_b64 exec, -1
    s_waitcnt lgkmcnt(0)
    s_barrier
    ds_read_b64 v[16:17], v11 offset:0
    ds_read_b64 v[18:19], v11 offset:1728
    ds_read_b64 v[20:21], v11 offset:3456
    ds_read_b64 v[22:23], v11 offset:5184
    s_waitcnt lgkmcnt(2)
    v_pk_add_f32 v[16:17], v[16:17], v[18:19]
    s_waitcnt lgkmcnt(0)
    v_pk_add_f32 v[20:21], v[20:21], v[22:23]
    v_pk_add_f32 v[16:17], v[16:17], v[20:21]
    v_max_f32 v24, v16, v17
    s_nop 1
    v_max_f32_dpp v24, v24, v24 quad_perm:[1,0,3,2] row_mask:0xf bank_mask:0xf
    s_nop 1
    v_max_f32_dpp v24, v24, v24 quad_perm:[2,3,0,1] row_mask:0xf bank_mask:0xf
    s_nop 1
    v_max_f32_dpp v24, v24, v24 row_half_mirror row_mask:0xf bank_mask:0xf
    s_nop 1
    v_max_f32_dpp v24, v24, v24 row_mirror row_mask:0xf bank_mask:0xf
    v_mov_b32 v25, v24
    s_nop 1
    v_permlane16_swap_b32 v24, v25
    v_max_f32 v24, v24, v25
    v_sub_f32 v16, v16, v24
    v_sub_f32 v17, v17, v24
    v_exp_f32 v16, v16
    v_exp_f32 v17, v17
    s_nop 0
    v_add_f32 v26, v16, v17
    v_mul_f32 v26, v26, v13
    s_nop 1
    v_add_f32_dpp v26, v26, v26 quad_perm:[1,0,3,2] row_mask:0xf bank_mask:0xf
    s_nop 1
    v_add_f32_dpp v26, v26, v26 quad_perm:[2,3,0,1] row_mask:0xf bank_mask:0xf
    s_nop 1
    v_add_f32_dpp v26, v26, v26 row_half_mirror row_mask:0xf bank_mask:0xf
    s_nop 1
    v_add_f32_dpp v26, v26, v26 row_mirror row_mask:0xf bank_mask:0xf
    v_mov_b32 v25, v26
    s_nop 1
    v_permlane16_swap_b32 v26, v25
    v_add_f32 v26, v26, v25
    v_rcp_f32 v26, v26
    s_nop 0
    v_mul_f32 v16, v16, v26
    v_mul_f32 v17, v17, v26
    v_cvt_pk_bf16_f32 v16, v16, v17
    buffer_store_dword v16, v12, s[8:11], s16 offen
    s_add_u32 s15, s15, 8192
    s_add_u32 s16, s16, 10240
    s_add_u32 s34, s34, 128
    s_add_u32 s33, s33, 128
    s_add_u32 s14, s14, 1
    s_cmp_lt_u32 s14, 63
    s_cbranch_scc1 A3_LOOP
    s_waitcnt vmcnt(0)
    s_endpgm
ROLE_C:
    s_sub_u32 s27, s12, 16
    v_lshlrev_b32 v5, 4, v1
    v_lshlrev_b32 v3, 4, v0
    v_add_u32 v4, 4096, v3
    v_and_b32 v104, 15, v1
    v_lshrrev_b32 v105, 4, v1
    v_mov_b32 v2, 0x44444444
    v_mov_b32 v106, 0xeeeeeeee
    v_cmp_lt_u32 vcc, 7, v104
    s_nop 1
    v_cndmask_b32 v2, v2, v106, vcc
    s_mul_i32 s18, s13, 14336
    s_add_u32 s18, s18, 16384
    v_add_u32 v6, s18, v5
    s_lshl_b32 s20, s13, 13
    s_add_u32 s26, s20, 73728
    v_add_u32 v7, s26, v5
    v_and_b32 v106, 7, v1
    v_lshlrev_b32 v107, 7, v105
    v_lshl_add_u32 v12, v106, 4, v107
    v_lshrrev_b32 v107, 3, v104
    v_lshlrev_b32 v8, 9, v107
    v_lshl_add_u32 v8, v106, 6, v8
    v_lshl_add_u32 v8, v105, 4, v8
    s_lshl_b32 s18, s13, 11
    s_add_u32 s20, s18, 8192
    v_add_u32 v9, s20, v5
    v_lshlrev_b32 v108, 10, v107
    v_lshl_add_u32 v108, v105, 8, v108
    v_lshl_add_u32 v108, v106, 4, v108
    v_add_u32 v10, 8192, v108
    v_lshrrev_b32 v108, 1, v105
    v_lshl_add_u32 v108, v107, 1, v108
    v_lshlrev_b32 v108, 7, v108
    v_lshl_add_u32 v108, v106, 4, v108
    v_and_b32 v109, 1, v105
    v_lshl_add_u32 v11, v109, 3, v108
    s_lshl_b32 s18, s27, 2
    s_add_u32 s18, s18, s13
    s_mul_i32 s18, s18, 114688
    s_add_u32 s18, s18, 6815744
    s_add_u32 s20, s18, 100352
    buffer_load_dwordx4 a[0:3], v5, s[8:11], s18 offen offset:0
    buffer_load_dwordx4 a[4:7], v5, s[8:11], s18 offen offset:1024
    buffer_load_dwordx4 a[8:11], v5, s[8:11], s18 offen offset:2048
    buffer_load_dwordx4 a[12:15], v5, s[8:11], s18 offen offset:3072
    s_add_u32 s18, s18, 4096
    buffer_load_dwordx4 a[16:19], v5, s[8:11], s18 offen offset:0
    buffer_load_dwordx4 a[20:23], v5, s[8:11], s18 offen offset:1024
    buffer_load_dwordx4 a[24:27], v5, s[8:11], s18 offen offset:2048
    buffer_load_dwordx4 a[28:31], v5, s[8:11], s18 offen offset:3072
    s_add_u32 s18, s18, 4096
    buffer_load_dwordx4 a[32:35], v5, s[8:11], s18 offen offset:0
    buffer_load_dwordx4 a[36:39], v5, s[8:11], s18 offen offset:1024
    buffer_load_dwordx4 a[40:43], v5, s[8:11], s18 offen offset:2048
    buffer_load_dwordx4 a[44:47], v5, s[8:11], s18 offen offset:3072
    s_add_u32 s18, s18, 4096
    buffer_load_dwordx4 a[48:51], v5, s[8:11], s18 offen offset:0
    buffer_load_dwordx4 a[52:55], v5, s[8:11], s18 offen offset:1024
    buffer_load_dwordx4 a[56:59], v5, s[8:11], s18 offen offset:2048
    buffer_load_dwordx4 a[60:63], v5, s[8:11], s18 offen offset:3072
    s_add_u32 s18, s18, 4096
    buffer_load_dwordx4 a[64:67], v5, s[8:11], s18 offen offset:0
    buffer_load_dwordx4 a[68:71], v5, s[8:11], s18 offen offset:1024
    buffer_load_dwordx4 a[72:75], v5, s[8:11], s18 offen offset:2048
    buffer_load_dwordx4 a[76:79], v5, s[8:11], s18 offen offset:3072
    s_add_u32 s18, s18, 4096
    buffer_load_dwordx4 a[80:83], v5, s[8:11], s18 offen offset:0
    buffer_load_dwordx4 a[84:87], v5, s[8:11], s18 offen offset:1024
    buffer_load_dwordx4 a[88:91], v5, s[8:11], s18 offen offset:2048
    buffer_load_dwordx4 a[92:95], v5, s[8:11], s18 offen offset:3072
    s_add_u32 s18, s18, 4096
    buffer_load_dwordx4 a[96:99], v5, s[8:11], s18 offen offset:0
    buffer_load_dwordx4 a[100:103], v5, s[8:11], s18 offen offset:1024
    buffer_load_dwordx4 a[104:107], v5, s[8:11], s18 offen offset:2048
    buffer_load_dwordx4 a[108:111], v5, s[8:11], s18 offen offset:3072
    s_add_u32 s18, s18, 4096
    buffer_load_dwordx4 a[112:115], v5, s[8:11], s18 offen offset:0
    buffer_load_dwordx4 a[116:119], v5, s[8:11], s18 offen offset:1024
    buffer_load_dwordx4 a[120:123], v5, s[8:11], s18 offen offset:2048
    buffer_load_dwordx4 a[124:127], v5, s[8:11], s18 offen offset:3072
    s_add_u32 s18, s18, 4096
    buffer_load_dwordx4 a[128:131], v5, s[8:11], s18 offen offset:0
    buffer_load_dwordx4 a[132:135], v5, s[8:11], s18 offen offset:1024
    buffer_load_dwordx4 a[136:139], v5, s[8:11], s18 offen offset:2048
    buffer_load_dwordx4 a[140:143], v5, s[8:11], s18 offen offset:3072
    s_add_u32 s18, s18, 4096
    buffer_load_dwordx4 a[144:147], v5, s[8:11], s18 offen offset:0
    buffer_load_dwordx4 a[148:151], v5, s[8:11], s18 offen offset:1024
    buffer_load_dwordx4 a[152:155], v5, s[8:11], s18 offen offset:2048
    buffer_load_dwordx4 a[156:159], v5, s[8:11], s18 offen offset:3072
    s_add_u32 s18, s18, 4096
    buffer_load_dwordx4 a[160:163], v5, s[8:11], s18 offen offset:0
    buffer_load_dwordx4 a[164:167], v5, s[8:11], s18 offen offset:1024
    buffer_load_dwordx4 a[168:171], v5, s[8:11], s18 offen offset:2048
    buffer_load_dwordx4 a[172:175], v5, s[8:11], s18 offen offset:3072
    s_add_u32 s18, s18, 4096
    buffer_load_dwordx4 a[176:179], v5, s[8:11], s18 offen offset:0
    buffer_load_dwordx4 a[180:183], v5, s[8:11], s18 offen offset:1024
    buffer_load_dwordx4 a[184:187], v5, s[8:11], s18 offen offset:2048
    buffer_load_dwordx4 a[188:191], v5, s[8:11], s18 offen offset:3072
    s_add_u32 s18, s18, 4096
    buffer_load_dwordx4 a[192:195], v5, s[8:11], s18 offen offset:0
    buffer_load_dwordx4 a[196:199], v5, s[8:11], s18 offen offset:1024
    buffer_load_dwordx4 a[200:203], v5, s[8:11], s18 offen offset:2048
    buffer_load_dwordx4 a[204:207], v5, s[8:11], s18 offen offset:3072
    s_add_u32 s18, s18, 4096
    buffer_load_dwordx4 a[208:211], v5, s[8:11], s18 offen offset:0
    buffer_load_dwordx4 a[212:215], v5, s[8:11], s18 offen offset:1024
    buffer_load_dwordx4 a[216:219], v5, s[8:11], s18 offen offset:2048
    buffer_load_dwordx4 a[220:223], v5, s[8:11], s18 offen offset:3072
    s_add_u32 s18, s18, 4096
    buffer_load_dwordx4 a[224:227], v5, s[8:11], s18 offen offset:0
    buffer_load_dwordx4 a[228:231], v5, s[8:11], s18 offen offset:1024
    buffer_load_dwordx4 a[232:235], v5, s[8:11], s18 offen offset:2048
    buffer_load_dwordx4 a[236:239], v5, s[8:11], s18 offen offset:3072
    s_add_u32 s18, s18, 4096
    buffer_load_dwordx4 a[240:243], v5, s[8:11], s18 offen offset:0
    buffer_load_dwordx4 a[244:247], v5, s[8:11], s18 offen offset:1024
    buffer_load_dwordx4 a[248:251], v5, s[8:11], s18 offen offset:2048
    buffer_load_dwordx4 a[252:255], v5, s[8:11], s18 offen offset:3072
    s_add_u32 s18, s18, 4096
    buffer_load_dwordx4 v[120:123], v5, s[8:11], s18 offen offset:0
    buffer_load_dwordx4 v[124:127], v5, s[8:11], s18 offen offset:1024
    buffer_load_dwordx4 v[128:131], v5, s[8:11], s18 offen offset:2048
    buffer_load_dwordx4 v[132:135], v5, s[8:11], s18 offen offset:3072
    s_add_u32 s18, s18, 4096
    buffer_load_dwordx4 v[136:139], v5, s[8:11], s18 offen offset:0
    buffer_load_dwordx4 v[140:143], v5, s[8:11], s18 offen offset:1024
    buffer_load_dwordx4 v[144:147], v5, s[8:11], s18 offen offset:2048
    buffer_load_dwordx4 v[148:151], v5, s[8:11], s18 offen offset:3072
    s_add_u32 s18, s18, 4096
    buffer_load_dwordx4 v[152:155], v5, s[8:11], s18 offen offset:0
    buffer_load_dwordx4 v[156:159], v5, s[8:11], s18 offen offset:1024
    buffer_load_dwordx4 v[160:163], v5, s[8:11], s18 offen offset:2048
    buffer_load_dwordx4 v[164:167], v5, s[8:11], s18 offen offset:3072
    s_add_u32 s18, s18, 4096
    buffer_load_dwordx4 v[168:171], v5, s[8:11], s18 offen offset:0
    buffer_load_dwordx4 v[172:175], v5, s[8:11], s18 offen offset:1024
    buffer_load_dwordx4 v[176:179], v5, s[8:11], s18 offen offset:2048
    buffer_load_dwordx4 v[180:183], v5, s[8:11], s18 offen offset:3072
    s_add_u32 s18, s18, 4096
    buffer_load_dwordx4 v[184:187], v5, s[8:11], s18 offen offset:0
    buffer_load_dwordx4 v[188:191], v5, s[8:11], s18 offen offset:1024
    buffer_load_dwordx4 v[192:195], v5, s[8:11], s18 offen offset:2048
    buffer_load_dwordx4 v[196:199], v5, s[8:11], s18 offen offset:3072
    s_add_u32 s18, s18, 4096
    buffer_load_dwordx4 v[200:203], v5, s[8:11], s18 offen offset:0
    buffer_load_dwordx4 v[204:207], v5, s[8:11], s18 offen offset:1024
    buffer_load_dwordx4 v[208:211], v5, s[8:11], s18 offen offset:2048
    buffer_load_dwordx4 v[212:215], v5, s[8:11], s18 offen offset:3072
    s_add_u32 s18, s18, 4096
    buffer_load_dwordx4 v[216:219], v5, s[8:11], s18 offen offset:0
    buffer_load_dwordx4 v[220:223], v5, s[8:11], s18 offen offset:1024
    buffer_load_dwordx4 v[224:227], v5, s[8:11], s18 offen offset:2048
    buffer_load_dwordx4 v[228:231], v5, s[8:11], s18 offen offset:3072
    s_add_u32 s18, s18, 4096
    buffer_load_dwordx4 v[232:235], v5, s[8:11], s18 offen offset:0
    buffer_load_dwordx4 v[236:239], v5, s[8:11], s18 offen offset:1024
    buffer_load_dwordx4 v[240:243], v5, s[8:11], s18 offen offset:2048
    buffer_load_dwordx4 v[244:247], v5, s[8:11], s18 offen offset:3072
    s_add_u32 s18, s18, 4096
    buffer_load_dwordx4 v[248:251], v5, s[8:11], s18 offen offset:0
    buffer_load_dwordx4 v[252:255], v5, s[8:11], s18 offen offset:1024
    s_mul_i32 s21, s13, 14336
    s_add_u32 s21, s21, 16384
    s_add_u32 m0, s21, 0
    s_add_u32 s22, s20, 0
    buffer_load_dwordx4 v5, s[8:11], s22 offen offset:0 lds
    buffer_load_dwordx4 v5, s[8:11], s22 offen offset:1024 lds
    buffer_load_dwordx4 v5, s[8:11], s22 offen offset:2048 lds
    buffer_load_dwordx4 v5, s[8:11], s22 offen offset:3072 lds
    s_add_u32 m0, s21, 4096
    s_add_u32 s22, s20, 4096
    buffer_load_dwordx4 v5, s[8:11], s22 offen offset:0 lds
    buffer_load_dwordx4 v5, s[8:11], s22 offen offset:1024 lds
    buffer_load_dwordx4 v5, s[8:11], s22 offen offset:2048 lds
    buffer_load_dwordx4 v5, s[8:11], s22 offen offset:3072 lds
    s_add_u32 m0, s21, 8192
    s_add_u32 s22, s20, 8192
    buffer_load_dwordx4 v5, s[8:11], s22 offen offset:0 lds
    buffer_load_dwordx4 v5, s[8:11], s22 offen offset:1024 lds
    buffer_load_dwordx4 v5, s[8:11], s22 offen offset:2048 lds
    buffer_load_dwordx4 v5, s[8:11], s22 offen offset:3072 lds
    s_add_u32 m0, s21, 12288
    s_add_u32 s22, s20, 12288
    buffer_load_dwordx4 v5, s[8:11], s22 offen offset:0 lds
    buffer_load_dwordx4 v5, s[8:11], s22 offen offset:1024 lds
    s_mov_b32 s14, 0
    s_mov_b32 s15, 16252928
    s_mul_i32 s16, s13, 2560
    s_add_u32 s16, s16, 16777216
    s_lshl_b32 s17, s27, 15
    s_lshl_b32 s18, s13, 13
    s_add_u32 s17, s17, s18
    s_add_u32 s17, s17, 17825792
    s_add_u32 s29, s17, 4096
    s_lshl_b32 s24, s27, 13
    s_lshl_b32 s18, s13, 11
    s_add_u32 s24, s24, s18
    s_add_u32 s24, s24, 48119808
    s_lshl_b32 s23, s27, 9
    s_add_u32 s32, s23, 111157248
    s_add_u32 s23, s23, 16261120
    s_mov_b32 s19, 0x40000
    s_lshl_b32 s25, s13, 12
    s_add_u32 s25, s25, 139264
    s_mov_b32 s28, 32768
    s_mov_b32 s31, 112213888
    s_lshl_b32 s33, s27, 2
    s_add_u32 s33, s33, 112240000
    s_mov_b32 s52, 0
    s_mov_b32 s54, 0
    v_mov_b32 v14, 0
    v_mov_b32 v15, 1
    s_mov_b32 s34, 112248320
    v_lshrrev_b32 v117, 2, v5
    v_and_b32 v117, 60, v117
    s_nop 1
C_D0POLL:
    s_mov_b32 s18, 112197632
    buffer_load_dword v104, v14, s[8:11], s18 offen sc1
    s_waitcnt vmcnt(0)
    v_readfirstlane_b32 s20, v104
    s_nop 0
    s_cmp_ge_u32 s20, 28
    s_nop 2
    s_cbranch_scc1 C_D0OK
    s_sleep 4
    s_sub_u32 s19, s19, 1
    s_cbranch_scc0 C_D0POLL
    s_mov_b32 s19, 0
C_D0OK:
    s_mov_b32 m0, s26
    s_nop 0
    buffer_load_dwordx4 v5, s[8:11], s17 offen offset:0 sc1 lds
    buffer_load_dwordx4 v5, s[8:11], s17 offen offset:1024 sc1 lds
    buffer_load_dwordx4 v5, s[8:11], s17 offen offset:2048 sc1 lds
    buffer_load_dwordx4 v5, s[8:11], s17 offen offset:3072 sc1 lds
    s_add_u32 m0, s26, 4096
    s_nop 0
    buffer_load_dwordx4 v5, s[8:11], s29 offen offset:0 sc1 lds
    buffer_load_dwordx4 v5, s[8:11], s29 offen offset:1024 sc1 lds
    buffer_load_dwordx4 v5, s[8:11], s29 offen offset:2048 sc1 lds
    buffer_load_dwordx4 v5, s[8:11], s29 offen offset:3072 sc1 lds
    s_add_u32 s17, s17, 458752
    s_add_u32 s29, s29, 458752
    s_add_u32 s26, s26, s28
    s_sub_u32 s28, 0, s28
    v_mov_b32 v80, 0
    v_mov_b32 v81, 0
    v_mov_b32 v82, 0
    v_mov_b32 v83, 0
    v_mov_b32 v84, 0
    v_mov_b32 v85, 0
    v_mov_b32 v86, 0
    v_mov_b32 v87, 0
    s_waitcnt vmcnt(0)
    s_cmp_eq_u32 s13, 1
    s_cbranch_scc1 C1_LOOP
    s_cmp_eq_u32 s13, 2
    s_cbranch_scc1 C2_LOOP
    s_cmp_eq_u32 s13, 3
    s_cbranch_scc1 C3_LOOP
C0_LOOP:
    v_mov_b32 v48, 0
    v_mov_b32 v49, 0
    v_mov_b32 v50, 0
    v_mov_b32 v51, 0
    v_mov_b32 v52, 0
    v_mov_b32 v53, 0
    v_mov_b32 v54, 0
    v_mov_b32 v55, 0
    v_mov_b32 v56, 0
    v_mov_b32 v57, 0
    v_mov_b32 v58, 0
    v_mov_b32 v59, 0
    v_mov_b32 v60, 0
    v_mov_b32 v61, 0
    v_mov_b32 v62, 0
    v_mov_b32 v63, 0
    v_mov_b32 v64, 0
    v_mov_b32 v65, 0
    v_mov_b32 v66, 0
    v_mov_b32 v67, 0
    v_mov_b32 v68, 0
    v_mov_b32 v69, 0
    v_mov_b32 v70, 0
    v_mov_b32 v71, 0
    v_mov_b32 v72, 0
    v_mov_b32 v73, 0
    v_mov_b32 v74, 0
    v_mov_b32 v75, 0
    v_mov_b32 v76, 0
    v_mov_b32 v77, 0
    v_mov_b32 v78, 0
    v_mov_b32 v79, 0
    s_nop 1
C0M_PL:
    buffer_load_dwordx4 v[104:107], v3, s[8:11], s15 offen sc1
    buffer_load_dwordx4 v[108:111], v4, s[8:11], s15 offen sc1
    s_waitcnt vmcnt(0)
    v_max3_u32 v0, v104, v105, v106
    v_max3_u32 v1, v107, v108, v109
    v_max3_u32 v1, v1, v110, v111
    v_max_u32 v0, v0, v1
    v_cmp_eq_u32 vcc, -1, v0
    s_nop 0
    s_cbranch_vccz C0M_GOTA
    s_sub_u32 s19, s19, 1
    s_cbranch_scc0 C0M_PL
    s_mov_b32 s19, 0
    s_branch C0M_GOTA
C0M_GOTA:
    ds_write_b128 v3, v[104:107]
    ds_write_b128 v4, v[108:111]
    v_smfmac_f32_16x16x64_bf16 v[48:51], v[104:107], a[0:7], v2
    v_smfmac_f32_16x16x64_bf16 v[52:55], v[104:107], a[56:63], v2
    v_smfmac_f32_16x16x64_bf16 v[56:59], v[104:107], a[112:119], v2
    v_smfmac_f32_16x16x64_bf16 v[60:63], v[104:107], a[168:175], v2
    v_smfmac_f32_16x16x64_bf16 v[64:67], v[104:107], a[224:231], v2
    v_smfmac_f32_16x16x64_bf16 v[68:71], v[104:107], v[144:151], v2
    v_smfmac_f32_16x16x64_bf16 v[72:75], v[104:107], v[200:207], v2
    s_waitcnt lgkmcnt(0)
    s_barrier
    ds_read_b128 v[20:23], v5 offset:1024
    ds_read_b128 v[24:27], v5 offset:2048
    ds_read_b128 v[28:31], v5 offset:3072
    ds_read_b128 v[36:39], v5 offset:5120
    ds_read_b128 v[40:43], v5 offset:6144
    v_smfmac_f32_16x16x64_bf16 v[48:51], v[108:111], a[32:39], v2
    buffer_store_dwordx4 v[80:83], v5, s[8:11], s24 offen offset:0 sc1
    v_smfmac_f32_16x16x64_bf16 v[52:55], v[108:111], a[88:95], v2
    buffer_store_dwordx4 v[84:87], v5, s[8:11], s24 offen offset:1024 sc1
    v_smfmac_f32_16x16x64_bf16 v[56:59], v[108:111], a[144:151], v2
    s_add_u32 s24, s24, 114688
    v_smfmac_f32_16x16x64_bf16 v[60:63], v[108:111], a[200:207], v2
    v_smfmac_f32_16x16x64_bf16 v[64:67], v[108:111], v[120:127], v2
    v_smfmac_f32_16x16x64_bf16 v[68:71], v[108:111], v[176:183], v2
    v_smfmac_f32_16x16x64_bf16 v[72:75], v[108:111], v[232:239], v2
    s_waitcnt lgkmcnt(4)
    v_smfmac_f32_16x16x64_bf16 v[48:51], v[20:23], a[8:15], v2
    s_waitcnt lgkmcnt(3)
    v_smfmac_f32_16x16x64_bf16 v[48:51], v[24:27], a[16:23], v2
    s_waitcnt lgkmcnt(2)
    v_smfmac_f32_16x16x64_bf16 v[48:51], v[28:31], a[24:31], v2
    s_waitcnt lgkmcnt(1)
    v_smfmac_f32_16x16x64_bf16 v[48:51], v[36:39], a[40:47], v2
    s_waitcnt lgkmcnt(0)
    v_smfmac_f32_16x16x64_bf16 v[48:51], v[40:43], a[48:55], v2
    v_smfmac_f32_16x16x64_bf16 v[52:55], v[20:23], a[64:71], v2
    v_smfmac_f32_16x16x64_bf16 v[52:55], v[24:27], a[72:79], v2
    s_mov_b32 m0, s26
    s_nop 0
    buffer_load_dwordx4 v5, s[8:11], s17 offen offset:0 sc1 lds
    v_smfmac_f32_16x16x64_bf16 v[52:55], v[28:31], a[80:87], v2
    v_smfmac_f32_16x16x64_bf16 v[52:55], v[36:39], a[96:103], v2
    buffer_load_dwordx4 v5, s[8:11], s17 offen offset:1024 sc1 lds
    v_smfmac_f32_16x16x64_bf16 v[52:55], v[40:43], a[104:111], v2
    v_smfmac_f32_16x16x64_bf16 v[56:59], v[20:23], a[120:127], v2
    buffer_load_dwordx4 v5, s[8:11], s17 offen offset:2048 sc1 lds
    v_smfmac_f32_16x16x64_bf16 v[56:59], v[24:27], a[128:135], v2
    v_smfmac_f32_16x16x64_bf16 v[56:59], v[28:31], a[136:143], v2
    buffer_load_dwordx4 v5, s[8:11], s17 offen offset:3072 sc1 lds
    v_smfmac_f32_16x16x64_bf16 v[56:59], v[36:39], a[152:159], v2
    v_smfmac_f32_16x16x64_bf16 v[56:59], v[40:43], a[160:167], v2
    s_add_u32 m0, s26, 4096
    s_nop 0
    buffer_load_dwordx4 v5, s[8:11], s29 offen offset:0 sc1 lds
    v_smfmac_f32_16x16x64_bf16 v[60:63], v[20:23], a[176:183], v2
    v_smfmac_f32_16x16x64_bf16 v[60:63], v[24:27], a[184:191], v2
    buffer_load_dwordx4 v5, s[8:11], s29 offen offset:1024 sc1 lds
    v_smfmac_f32_16x16x64_bf16 v[60:63], v[28:31], a[192:199], v2
    v_smfmac_f32_16x16x64_bf16 v[60:63], v[36:39], a[208:215], v2
    buffer_load_dwordx4 v5, s[8:11], s29 offen offset:2048 sc1 lds
    v_smfmac_f32_16x16x64_bf16 v[60:63], v[40:43], a[216:223], v2
    v_smfmac_f32_16x16x64_bf16 v[64:67], v[20:23], a[232:239], v2
    buffer_load_dwordx4 v5, s[8:11], s29 offen offset:3072 sc1 lds
    v_smfmac_f32_16x16x64_bf16 v[64:67], v[24:27], a[240:247], v2
    v_smfmac_f32_16x16x64_bf16 v[64:67], v[28:31], a[248:255], v2
    v_smfmac_f32_16x16x64_bf16 v[64:67], v[36:39], v[128:135], v2
    v_smfmac_f32_16x16x64_bf16 v[64:67], v[40:43], v[136:143], v2
    v_smfmac_f32_16x16x64_bf16 v[68:71], v[20:23], v[152:159], v2
    v_smfmac_f32_16x16x64_bf16 v[68:71], v[24:27], v[160:167], v2
    s_add_u32 s17, s17, 458752
    s_add_u32 s29, s29, 458752
    s_add_u32 s26, s26, s28
    s_sub_u32 s28, 0, s28
    v_smfmac_f32_16x16x64_bf16 v[68:71], v[28:31], v[168:175], v2
    v_smfmac_f32_16x16x64_bf16 v[68:71], v[36:39], v[184:191], v2
    v_smfmac_f32_16x16x64_bf16 v[68:71], v[40:43], v[192:199], v2
    v_smfmac_f32_16x16x64_bf16 v[72:75], v[20:23], v[208:215], v2
    v_smfmac_f32_16x16x64_bf16 v[72:75], v[24:27], v[216:223], v2
    v_smfmac_f32_16x16x64_bf16 v[72:75], v[28:31], v[224:231], v2
    ds_read_b128 v[88:91], v6 offset:0
    ds_read_b128 v[92:95], v6 offset:1024
    v_smfmac_f32_16x16x64_bf16 v[72:75], v[36:39], v[240:247], v2
    ds_read_b128 v[96:99], v6 offset:2048
    ds_read_b128 v[100:103], v6 offset:3072
    v_smfmac_f32_16x16x64_bf16 v[72:75], v[40:43], v[248:255], v2
    s_waitcnt lgkmcnt(2)
    v_smfmac_f32_16x16x64_bf16 v[76:79], v[104:107], v[88:95], v2
    ds_read_b128 v[88:91], v6 offset:4096
    ds_read_b128 v[92:95], v6 offset:5120
    s_waitcnt lgkmcnt(2)
    v_smfmac_f32_16x16x64_bf16 v[76:79], v[20:23], v[96:103], v2
    ds_read_b128 v[96:99], v6 offset:6144
    ds_read_b128 v[100:103], v6 offset:7168
    s_waitcnt lgkmcnt(2)
    v_smfmac_f32_16x16x64_bf16 v[76:79], v[24:27], v[88:95], v2
    ds_read_b128 v[88:91], v6 offset:8192
    ds_read_b128 v[92:95], v6 offset:9216
    s_waitcnt lgkmcnt(2)
    v_smfmac_f32_16x16x64_bf16 v[76:79], v[28:31], v[96:103], v2
    ds_read_b128 v[96:99], v6 offset:10240
    ds_read_b128 v[100:103], v6 offset:11264
    s_waitcnt lgkmcnt(2)
    v_smfmac_f32_16x16x64_bf16 v[76:79], v[108:111], v[88:95], v2
    ds_read_b128 v[88:91], v6 offset:12288
    ds_read_b128 v[92:95], v6 offset:13312
    s_waitcnt lgkmcnt(2)
    v_smfmac_f32_16x16x64_bf16 v[76:79], v[36:39], v[96:103], v2
    s_waitcnt lgkmcnt(0)
    v_smfmac_f32_16x16x64_bf16 v[76:79], v[40:43], v[88:95], v2
    ds_read_b128 v[16:19], v7 offset:0
    ds_read_b128 v[20:23], v7 offset:1024
    ds_read_b128 v[24:27], v7 offset:2048
    ds_read_b128 v[28:31], v7 offset:3072
    ds_read_b128 v[32:35], v7 offset:4096
    ds_read_b128 v[36:39], v7 offset:5120
    ds_read_b128 v[40:43], v7 offset:6144
    ds_read_b128 v[44:47], v7 offset:7168
    v_permlane32_swap_b32 v48, v56
    v_permlane32_swap_b32 v49, v57
    v_permlane32_swap_b32 v50, v58
    v_permlane32_swap_b32 v51, v59
    v_add_f32 v48, v48, v56
    v_add_f32 v49, v49, v57
    v_add_f32 v50, v50, v58
    v_add_f32 v51, v51, v59
    v_cvt_pk_bf16_f32 v80, v48, v49
    v_cvt_pk_bf16_f32 v81, v50, v51
    v_permlane32_swap_b32 v64, v72
    v_permlane32_swap_b32 v65, v73
    v_permlane32_swap_b32 v66, v74
    v_permlane32_swap_b32 v67, v75
    v_add_f32 v64, v64, v72
    v_add_f32 v65, v65, v73
    v_add_f32 v66, v66, v74
    v_add_f32 v67, v67, v75
    v_cvt_pk_bf16_f32 v82, v64, v65
    v_cvt_pk_bf16_f32 v83, v66, v67
    v_permlane32_swap_b32 v52, v60
    v_permlane32_swap_b32 v53, v61
    v_permlane32_swap_b32 v54, v62
    v_permlane32_swap_b32 v55, v63
    v_add_f32 v52, v52, v60
    v_add_f32 v53, v53, v61
    v_add_f32 v54, v54, v62
    v_add_f32 v55, v55, v63
    v_cvt_pk_bf16_f32 v84, v52, v53
    v_cvt_pk_bf16_f32 v85, v54, v55
    v_permlane32_swap_b32 v68, v76
    v_permlane32_swap_b32 v69, v77
    v_permlane32_swap_b32 v70, v78
    v_permlane32_swap_b32 v71, v79
    v_add_f32 v68, v68, v76
    v_add_f32 v69, v69, v77
    v_add_f32 v70, v70, v78
    v_add_f32 v71, v71, v79
    v_cvt_pk_bf16_f32 v86, v68, v69
    v_cvt_pk_bf16_f32 v87, v70, v71
    v_add_u32 v7, s28, v7
    s_cmp_ge_u32 s14, 63
    s_nop 0
    s_cbranch_scc1 C0_DONE
    v_mov_b32 v48, 0
    v_mov_b32 v49, 0
    v_mov_b32 v50, 0
    v_mov_b32 v51, 0
    v_mov_b32 v52, 0
    v_mov_b32 v53, 0
    v_mov_b32 v54, 0
    v_mov_b32 v55, 0
    v_mov_b32 v56, 0
    v_mov_b32 v57, 0
    v_mov_b32 v58, 0
    v_mov_b32 v59, 0
    v_mov_b32 v60, 0
    v_mov_b32 v61, 0
    v_mov_b32 v62, 0
    v_mov_b32 v63, 0
    s_nop 1
C0P_PL:
    buffer_load_dwordx4 v[88:91], v8, s[8:11], s16 offen sc1
    buffer_load_dwordx4 v[92:95], v8, s[8:11], s16 offen offset:1024 sc1
    buffer_load_dwordx4 v[96:99], v12, s[8:11], s16 offen offset:2048 sc1
    s_waitcnt vmcnt(0)
    v_max3_u32 v0, v88, v89, v90
    v_max3_u32 v1, v91, v92, v93
    v_max3_u32 v1, v1, v94, v95
    v_max3_u32 v0, v0, v96, v97
    v_max3_u32 v1, v1, v98, v99
    v_max_u32 v0, v0, v1
    v_cmp_eq_u32 vcc, -1, v0
    s_nop 0
    s_cbranch_vccz C0P_GOTA
    s_sub_u32 s19, s19, 1
    s_cbranch_scc0 C0P_PL
    s_mov_b32 s19, 0
    s_branch C0P_GOTA
C0P_GOTA:
    s_waitcnt lgkmcnt(0)
    v_mfma_f32_16x16x32_bf16 v[56:59], v[24:27], v[88:91], v[56:59]
    v_mfma_f32_16x16x32_bf16 v[56:59], v[40:43], v[92:95], v[56:59]
    v_mfma_f32_16x16x32_bf16 v[48:51], v[16:19], v[88:91], v[48:51]
    v_mfma_f32_16x16x32_bf16 v[48:51], v[32:35], v[92:95], v[48:51]
    v_mfma_f32_16x16x32_bf16 v[48:51], v[80:83], v[96:99], v[48:51]
    v_mfma_f32_16x16x32_bf16 v[60:63], v[28:31], v[88:91], v[60:63]
    v_mfma_f32_16x16x32_bf16 v[60:63], v[44:47], v[92:95], v[60:63]
    v_mfma_f32_16x16x32_bf16 v[52:55], v[20:23], v[88:91], v[52:55]
    v_mfma_f32_16x16x32_bf16 v[52:55], v[36:39], v[92:95], v[52:55]
    v_mfma_f32_16x16x32_bf16 v[52:55], v[84:87], v[96:99], v[52:55]
    s_nop 7
    s_branch C0P_GOT
C0P_GOTB:
    s_waitcnt lgkmcnt(0)
    v_mfma_f32_16x16x32_bf16 v[56:59], v[24:27], v[100:103], v[56:59]
    v_mfma_f32_16x16x32_bf16 v[56:59], v[40:43], v[104:107], v[56:59]
    v_mfma_f32_16x16x32_bf16 v[48:51], v[16:19], v[100:103], v[48:51]
    v_mfma_f32_16x16x32_bf16 v[48:51], v[32:35], v[104:107], v[48:51]
    v_mfma_f32_16x16x32_bf16 v[48:51], v[80:83], v[108:111], v[48:51]
    v_mfma_f32_16x16x32_bf16 v[60:63], v[28:31], v[100:103], v[60:63]
    v_mfma_f32_16x16x32_bf16 v[60:63], v[44:47], v[104:107], v[60:63]
    v_mfma_f32_16x16x32_bf16 v[52:55], v[20:23], v[100:103], v[52:55]
    v_mfma_f32_16x16x32_bf16 v[52:55], v[36:39], v[104:107], v[52:55]
    v_mfma_f32_16x16x32_bf16 v[52:55], v[84:87], v[108:111], v[52:55]
    s_nop 7
C0P_GOT:
    v_add_f32_dpp v48, v56, v48 row_ror:8 row_mask:0xf bank_mask:0xf
    v_add_f32_dpp v49, v57, v49 row_ror:8 row_mask:0xf bank_mask:0xf
    v_add_f32_dpp v50, v58, v50 row_ror:8 row_mask:0xf bank_mask:0xf
    v_add_f32_dpp v51, v59, v51 row_ror:8 row_mask:0xf bank_mask:0xf
    ds_write_b128 v9, v[48:51] offset:0
    v_add_f32_dpp v52, v60, v52 row_ror:8 row_mask:0xf bank_mask:0xf
    v_add_f32_dpp v53, v61, v53 row_ror:8 row_mask:0xf bank_mask:0xf
    v_add_f32_dpp v54, v62, v54 row_ror:8 row_mask:0xf bank_mask:0xf
    v_add_f32_dpp v55, v63, v55 row_ror:8 row_mask:0xf bank_mask:0xf
    ds_write_b128 v9, v[52:55] offset:1024
    s_waitcnt lgkmcnt(0)
    s_barrier
    ds_read_b128 v[16:19], v10 offset:0
    ds_read_b128 v[20:23], v10 offset:2048
    ds_read_b128 v[24:27], v10 offset:4096
    ds_read_b128 v[28:31], v10 offset:6144
    s_waitcnt lgkmcnt(2)
    v_pk_add_f32 v[16:17], v[16:17], v[20:21]
    v_pk_add_f32 v[18:19], v[18:19], v[22:23]
    s_waitcnt lgkmcnt(0)
    v_pk_add_f32 v[24:25], v[24:25], v[28:29]
    v_pk_add_f32 v[26:27], v[26:27], v[30:31]
    v_pk_add_f32 v[16:17], v[16:17], v[24:25]
    v_pk_add_f32 v[18:19], v[18:19], v[26:27]
    v_cvt_pk_bf16_f32 v16, v16, v17
    v_cvt_pk_bf16_f32 v17, v18, v19
    buffer_store_dwordx2 v[16:17], v11, s[8:11], s23 offen
    buffer_store_dword v15, v14, s[8:11], s33 offen
    s_add_u32 s15, s15, 8192
    s_add_u32 s16, s16, 10240
    s_add_u32 s23, s23, 8192
    s_add_u32 s32, s32, 8192
    s_add_u32 s31, s31, 128
    s_add_u32 s33, s33, 128
    s_add_u32 s34, s34, 128
    s_add_u32 s14, s14, 1
    s_branch C0_LOOP
C0_DONE:
    buffer_store_dwordx4 v[80:83], v5, s[8:11], s24 offen offset:0 sc1
    buffer_store_dwordx4 v[84:87], v5, s[8:11], s24 offen offset:1024 sc1
    s_waitcnt vmcnt(0)
    s_barrier
    s_mov_b64 exec, 1
    buffer_atomic_add v15, v14, s[8:11], s31 offen
    buffer_atomic_add v15, v14, s[8:11], s31 offen offset:128
    s_waitcnt vmcnt(0)
    s_endpgm
C1_LOOP:
    v_mov_b32 v48, 0
    v_mov_b32 v49, 0
    v_mov_b32 v50, 0
    v_mov_b32 v51, 0
    v_mov_b32 v52, 0
    v_mov_b32 v53, 0
    v_mov_b32 v54, 0
    v_mov_b32 v55, 0
    v_mov_b32 v56, 0
    v_mov_b32 v57, 0
    v_mov_b32 v58, 0
    v_mov_b32 v59, 0
    v_mov_b32 v60, 0
    v_mov_b32 v61, 0
    v_mov_b32 v62, 0
    v_mov_b32 v63, 0
    v_mov_b32 v64, 0
    v_mov_b32 v65, 0
    v_mov_b32 v66, 0
    v_mov_b32 v67, 0
    v_mov_b32 v68, 0
    v_mov_b32 v69, 0
    v_mov_b32 v70, 0
    v_mov_b32 v71, 0
    v_mov_b32 v72, 0
    v_mov_b32 v73, 0
    v_mov_b32 v74, 0
    v_mov_b32 v75, 0
    v_mov_b32 v76, 0
    v_mov_b32 v77, 0
    v_mov_b32 v78, 0
    v_mov_b32 v79, 0
    s_nop 1
C1M_PL:
    buffer_load_dwordx4 v[104:107], v3, s[8:11], s15 offen sc1
    buffer_load_dwordx4 v[108:111], v4, s[8:11], s15 offen sc1
    s_waitcnt vmcnt(0)
    v_max3_u32 v0, v104, v105, v106
    v_max3_u32 v1, v107, v108, v109
    v_max3_u32 v1, v1, v110, v111
    v_max_u32 v0, v0, v1
    v_cmp_eq_u32 vcc, -1, v0
    s_nop 0
    s_cbranch_vccz C1M_GOTA
    s_sub_u32 s19, s19, 1
    s_cbranch_scc0 C1M_PL
    s_mov_b32 s19, 0
    s_branch C1M_GOTA
C1M_GOTA:
    ds_write_b128 v3, v[104:107]
    ds_write_b128 v4, v[108:111]
    v_smfmac_f32_16x16x64_bf16 v[48:51], v[104:107], a[8:15], v2
    v_smfmac_f32_16x16x64_bf16 v[52:55], v[104:107], a[64:71], v2
    v_smfmac_f32_16x16x64_bf16 v[56:59], v[104:107], a[120:127], v2
    v_smfmac_f32_16x16x64_bf16 v[60:63], v[104:107], a[176:183], v2
    v_smfmac_f32_16x16x64_bf16 v[64:67], v[104:107], a[232:239], v2
    v_smfmac_f32_16x16x64_bf16 v[68:71], v[104:107], v[152:159], v2
    v_smfmac_f32_16x16x64_bf16 v[72:75], v[104:107], v[208:215], v2
    s_waitcnt lgkmcnt(0)
    s_barrier
    ds_read_b128 v[16:19], v5 offset:0
    ds_read_b128 v[24:27], v5 offset:2048
    ds_read_b128 v[28:31], v5 offset:3072
    ds_read_b128 v[32:35], v5 offset:4096
    ds_read_b128 v[40:43], v5 offset:6144
    v_smfmac_f32_16x16x64_bf16 v[48:51], v[108:111], a[40:47], v2
    buffer_store_dwordx4 v[80:83], v5, s[8:11], s24 offen offset:0 sc1
    v_smfmac_f32_16x16x64_bf16 v[52:55], v[108:111], a[96:103], v2
    buffer_store_dwordx4 v[84:87], v5, s[8:11], s24 offen offset:1024 sc1
    v_smfmac_f32_16x16x64_bf16 v[56:59], v[108:111], a[152:159], v2
    s_add_u32 s24, s24, 114688
    v_smfmac_f32_16x16x64_bf16 v[60:63], v[108:111], a[208:215], v2
    v_smfmac_f32_16x16x64_bf16 v[64:67], v[108:111], v[128:135], v2
    v_smfmac_f32_16x16x64_bf16 v[68:71], v[108:111], v[184:191], v2
    v_smfmac_f32_16x16x64_bf16 v[72:75], v[108:111], v[240:247], v2
    s_waitcnt lgkmcnt(4)
    v_smfmac_f32_16x16x64_bf16 v[48:51], v[16:19], a[0:7], v2
    s_waitcnt lgkmcnt(3)
    v_smfmac_f32_16x16x64_bf16 v[48:51], v[24:27], a[16:23], v2
    s_waitcnt lgkmcnt(2)
    v_smfmac_f32_16x16x64_bf16 v[48:51], v[28:31], a[24:31], v2
    s_waitcnt lgkmcnt(1)
    v_smfmac_f32_16x16x64_bf16 v[48:51], v[32:35], a[32:39], v2
    s_waitcnt lgkmcnt(0)
    v_smfmac_f32_16x16x64_bf16 v[48:51], v[40:43], a[48:55], v2
    v_smfmac_f32_16x16x64_bf16 v[52:55], v[16:19], a[56:63], v2
    v_smfmac_f32_16x16x64_bf16 v[52:55], v[24:27], a[72:79], v2
    v_smfmac_f32_16x16x64_bf16 v[52:55], v[28:31], a[80:87], v2
    s_mov_b32 m0, s26
    s_nop 0
    buffer_load_dwordx4 v5, s[8:11], s17 offen offset:0 sc1 lds
    v_smfmac_f32_16x16x64_bf16 v[52:55], v[32:35], a[88:95], v2
    v_smfmac_f32_16x16x64_bf16 v[52:55], v[40:43], a[104:111], v2
    buffer_load_dwordx4 v5, s[8:11], s17 offen offset:1024 sc1 lds
    v_smfmac_f32_16x16x64_bf16 v[56:59], v[16:19], a[112:119], v2
    v_smfmac_f32_16x16x64_bf16 v[56:59], v[24:27], a[128:135], v2
    buffer_load_dwordx4 v5, s[8:11], s17 offen offset:2048 sc1 lds
    v_smfmac_f32_16x16x64_bf16 v[56:59], v[28:31], a[136:143], v2
    v_smfmac_f32_16x16x64_bf16 v[56:59], v[32:35], a[144:151], v2
    buffer_load_dwordx4 v5, s[8:11], s17 offen offset:3072 sc1 lds
    v_smfmac_f32_16x16x64_bf16 v[56:59], v[40:43], a[160:167], v2
    v_smfmac_f32_16x16x64_bf16 v[60:63], v[16:19], a[168:175], v2
    s_add_u32 m0, s26, 4096
    s_nop 0
    buffer_load_dwordx4 v5, s[8:11], s29 offen offset:0 sc1 lds
    v_smfmac_f32_16x16x64_bf16 v[60:63], v[24:27], a[184:191], v2
    v_smfmac_f32_16x16x64_bf16 v[60:63], v[28:31], a[192:199], v2
    buffer_load_dwordx4 v5, s[8:11], s29 offen offset:1024 sc1 lds
    v_smfmac_f32_16x16x64_bf16 v[60:63], v[32:35], a[200:207], v2
    v_smfmac_f32_16x16x64_bf16 v[60:63], v[40:43], a[216:223], v2
    buffer_load_dwordx4 v5, s[8:11], s29 offen offset:2048 sc1 lds
    v_smfmac_f32_16x16x64_bf16 v[64:67], v[16:19], a[224:231], v2
    v_smfmac_f32_16x16x64_bf16 v[64:67], v[24:27], a[240:247], v2
    buffer_load_dwordx4 v5, s[8:11], s29 offen offset:3072 sc1 lds
    v_smfmac_f32_16x16x64_bf16 v[64:67], v[28:31], a[248:255], v2
    v_smfmac_f32_16x16x64_bf16 v[64:67], v[32:35], v[120:127], v2
    v_smfmac_f32_16x16x64_bf16 v[64:67], v[40:43], v[136:143], v2
    v_smfmac_f32_16x16x64_bf16 v[68:71], v[16:19], v[144:151], v2
    v_smfmac_f32_16x16x64_bf16 v[68:71], v[24:27], v[160:167], v2
    s_add_u32 s17, s17, 458752
    s_add_u32 s29, s29, 458752
    s_add_u32 s26, s26, s28
    s_sub_u32 s28, 0, s28
    v_smfmac_f32_16x16x64_bf16 v[68:71], v[28:31], v[168:175], v2
    v_smfmac_f32_16x16x64_bf16 v[68:71], v[32:35], v[176:183], v2
    v_smfmac_f32_16x16x64_bf16 v[68:71], v[40:43], v[192:199], v2
    v_smfmac_f32_16x16x64_bf16 v[72:75], v[16:19], v[200:207], v2
    v_smfmac_f32_16x16x64_bf16 v[72:75], v[24:27], v[216:223], v2
    v_smfmac_f32_16x16x64_bf16 v[72:75], v[28:31], v[224:231], v2
    ds_read_b128 v[88:91], v6 offset:0
    ds_read_b128 v[92:95], v6 offset:1024
    v_smfmac_f32_16x16x64_bf16 v[72:75], v[32:35], v[232:239], v2
    ds_read_b128 v[96:99], v6 offset:2048
    ds_read_b128 v[100:103], v6 offset:3072
    v_smfmac_f32_16x16x64_bf16 v[72:75], v[40:43], v[248:255], v2
    s_waitcnt lgkmcnt(2)
    v_smfmac_f32_16x16x64_bf16 v[76:79], v[16:19], v[88:95], v2
    ds_read_b128 v[88:91], v6 offset:4096
    ds_read_b128 v[92:95], v6 offset:5120
    s_waitcnt lgkmcnt(2)
    v_smfmac_f32_16x16x64_bf16 v[76:79], v[104:107], v[96:103], v2
    ds_read_b128 v[96:99], v6 offset:6144
    ds_read_b128 v[100:103], v6 offset:7168
    s_waitcnt lgkmcnt(2)
    v_smfmac_f32_16x16x64_bf16 v[76:79], v[24:27], v[88:95], v2
    ds_read_b128 v[88:91], v6 offset:8192
    ds_read_b128 v[92:95], v6 offset:9216
    s_waitcnt lgkmcnt(2)
    v_smfmac_f32_16x16x64_bf16 v[76:79], v[28:31], v[96:103], v2
    ds_read_b128 v[96:99], v6 offset:10240
    ds_read_b128 v[100:103], v6 offset:11264
    s_waitcnt lgkmcnt(2)
    v_smfmac_f32_16x16x64_bf16 v[76:79], v[32:35], v[88:95], v2
    ds_read_b128 v[88:91], v6 offset:12288
    ds_read_b128 v[92:95], v6 offset:13312
    s_waitcnt lgkmcnt(2)
    v_smfmac_f32_16x16x64_bf16 v[76:79], v[108:111], v[96:103], v2
    s_waitcnt lgkmcnt(0)
    v_smfmac_f32_16x16x64_bf16 v[76:79], v[40:43], v[88:95], v2
    ds_read_b128 v[16:19], v7 offset:0
    ds_read_b128 v[20:23], v7 offset:1024
    ds_read_b128 v[24:27], v7 offset:2048
    ds_read_b128 v[28:31], v7 offset:3072
    ds_read_b128 v[32:35], v7 offset:4096
    ds_read_b128 v[36:39], v7 offset:5120
    ds_read_b128 v[40:43], v7 offset:6144
    ds_read_b128 v[44:47], v7 offset:7168
    v_permlane32_swap_b32 v48, v56
    v_permlane32_swap_b32 v49, v57
    v_permlane32_swap_b32 v50, v58
    v_permlane32_swap_b32 v51, v59
    v_add_f32 v48, v48, v56
    v_add_f32 v49, v49, v57
    v_add_f32 v50, v50, v58
    v_add_f32 v51, v51, v59
    v_cvt_pk_bf16_f32 v80, v48, v49
    v_cvt_pk_bf16_f32 v81, v50, v51
    v_permlane32_swap_b32 v64, v72
    v_permlane32_swap_b32 v65, v73
    v_permlane32_swap_b32 v66, v74
    v_permlane32_swap_b32 v67, v75
    v_add_f32 v64, v64, v72
    v_add_f32 v65, v65, v73
    v_add_f32 v66, v66, v74
    v_add_f32 v67, v67, v75
    v_cvt_pk_bf16_f32 v82, v64, v65
    v_cvt_pk_bf16_f32 v83, v66, v67
    v_permlane32_swap_b32 v52, v60
    v_permlane32_swap_b32 v53, v61
    v_permlane32_swap_b32 v54, v62
    v_permlane32_swap_b32 v55, v63
    v_add_f32 v52, v52, v60
    v_add_f32 v53, v53, v61
    v_add_f32 v54, v54, v62
    v_add_f32 v55, v55, v63
    v_cvt_pk_bf16_f32 v84, v52, v53
    v_cvt_pk_bf16_f32 v85, v54, v55
    v_permlane32_swap_b32 v68, v76
    v_permlane32_swap_b32 v69, v77
    v_permlane32_swap_b32 v70, v78
    v_permlane32_swap_b32 v71, v79
    v_add_f32 v68, v68, v76
    v_add_f32 v69, v69, v77
    v_add_f32 v70, v70, v78
    v_add_f32 v71, v71, v79
    v_cvt_pk_bf16_f32 v86, v68, v69
    v_cvt_pk_bf16_f32 v87, v70, v71
    v_add_u32 v7, s28, v7
    s_cmp_ge_u32 s14, 63
    s_nop 0
    s_cbranch_scc1 C1_DONE
    v_mov_b32 v48, 0
    v_mov_b32 v49, 0
    v_mov_b32 v50, 0
    v_mov_b32 v51, 0
    v_mov_b32 v52, 0
    v_mov_b32 v53, 0
    v_mov_b32 v54, 0
    v_mov_b32 v55, 0
    v_mov_b32 v56, 0
    v_mov_b32 v57, 0
    v_mov_b32 v58, 0
    v_mov_b32 v59, 0
    v_mov_b32 v60, 0
    v_mov_b32 v61, 0
    v_mov_b32 v62, 0
    v_mov_b32 v63, 0
    s_nop 1
C1P_PL:
    buffer_load_dwordx4 v[88:91], v8, s[8:11], s16 offen sc1
    buffer_load_dwordx4 v[92:95], v8, s[8:11], s16 offen offset:1024 sc1
    buffer_load_dwordx4 v[96:99], v12, s[8:11], s16 offen offset:2048 sc1
    s_waitcnt vmcnt(0)
    v_max3_u32 v0, v88, v89, v90
    v_max3_u32 v1, v91, v92, v93
    v_max3_u32 v1, v1, v94, v95
    v_max3_u32 v0, v0, v96, v97
    v_max3_u32 v1, v1, v98, v99
    v_max_u32 v0, v0, v1
    v_cmp_eq_u32 vcc, -1, v0
    s_nop 0
    s_cbranch_vccz C1P_GOTA
    s_sub_u32 s19, s19, 1
    s_cbranch_scc0 C1P_PL
    s_mov_b32 s19, 0
    s_branch C1P_GOTA
C1P_GOTA:
    s_waitcnt lgkmcnt(0)
    v_mfma_f32_16x16x32_bf16 v[56:59], v[24:27], v[88:91], v[56:59]
    v_mfma_f32_16x16x32_bf16 v[56:59], v[40:43], v[92:95], v[56:59]
    v_mfma_f32_16x16x32_bf16 v[48:51], v[16:19], v[88:91], v[48:51]
    v_mfma_f32_16x16x32_bf16 v[48:51], v[32:35], v[92:95], v[48:51]
    v_mfma_f32_16x16x32_bf16 v[48:51], v[80:83], v[96:99], v[48:51]
    v_mfma_f32_16x16x32_bf16 v[60:63], v[28:31], v[88:91], v[60:63]
    v_mfma_f32_16x16x32_bf16 v[60:63], v[44:47], v[92:95], v[60:63]
    v_mfma_f32_16x16x32_bf16 v[52:55], v[20:23], v[88:91], v[52:55]
    v_mfma_f32_16x16x32_bf16 v[52:55], v[36:39], v[92:95], v[52:55]
    v_mfma_f32_16x16x32_bf16 v[52:55], v[84:87], v[96:99], v[52:55]
    s_nop 7
    s_branch C1P_GOT
C1P_GOTB:
    s_waitcnt lgkmcnt(0)
    v_mfma_f32_16x16x32_bf16 v[56:59], v[24:27], v[100:103], v[56:59]
    v_mfma_f32_16x16x32_bf16 v[56:59], v[40:43], v[104:107], v[56:59]
    v_mfma_f32_16x16x32_bf16 v[48:51], v[16:19], v[100:103], v[48:51]
    v_mfma_f32_16x16x32_bf16 v[48:51], v[32:35], v[104:107], v[48:51]
    v_mfma_f32_16x16x32_bf16 v[48:51], v[80:83], v[108:111], v[48:51]
    v_mfma_f32_16x16x32_bf16 v[60:63], v[28:31], v[100:103], v[60:63]
    v_mfma_f32_16x16x32_bf16 v[60:63], v[44:47], v[104:107], v[60:63]
    v_mfma_f32_16x16x32_bf16 v[52:55], v[20:23], v[100:103], v[52:55]
    v_mfma_f32_16x16x32_bf16 v[52:55], v[36:39], v[104:107], v[52:55]
    v_mfma_f32_16x16x32_bf16 v[52:55], v[84:87], v[108:111], v[52:55]
    s_nop 7
C1P_GOT:
    v_add_f32_dpp v48, v56, v48 row_ror:8 row_mask:0xf bank_mask:0xf
    v_add_f32_dpp v49, v57, v49 row_ror:8 row_mask:0xf bank_mask:0xf
    v_add_f32_dpp v50, v58, v50 row_ror:8 row_mask:0xf bank_mask:0xf
    v_add_f32_dpp v51, v59, v51 row_ror:8 row_mask:0xf bank_mask:0xf
    ds_write_b128 v9, v[48:51] offset:0
    v_add_f32_dpp v52, v60, v52 row_ror:8 row_mask:0xf bank_mask:0xf
    v_add_f32_dpp v53, v61, v53 row_ror:8 row_mask:0xf bank_mask:0xf
    v_add_f32_dpp v54, v62, v54 row_ror:8 row_mask:0xf bank_mask:0xf
    v_add_f32_dpp v55, v63, v55 row_ror:8 row_mask:0xf bank_mask:0xf
    ds_write_b128 v9, v[52:55] offset:1024
    s_waitcnt lgkmcnt(0)
    s_barrier
    s_add_u32 s15, s15, 8192
    s_add_u32 s16, s16, 10240
    s_add_u32 s23, s23, 8192
    s_add_u32 s32, s32, 8192
    s_add_u32 s31, s31, 128
    s_add_u32 s33, s33, 128
    s_add_u32 s34, s34, 128
    s_add_u32 s14, s14, 1
    s_branch C1_LOOP
C1_DONE:
    buffer_store_dwordx4 v[80:83], v5, s[8:11], s24 offen offset:0 sc1
    buffer_store_dwordx4 v[84:87], v5, s[8:11], s24 offen offset:1024 sc1
    s_waitcnt vmcnt(0)
    s_barrier
    s_endpgm
C2_LOOP:
    v_mov_b32 v48, 0
    v_mov_b32 v49, 0
    v_mov_b32 v50, 0
    v_mov_b32 v51, 0
    v_mov_b32 v52, 0
    v_mov_b32 v53, 0
    v_mov_b32 v54, 0
    v_mov_b32 v55, 0
    v_mov_b32 v56, 0
    v_mov_b32 v57, 0
    v_mov_b32 v58, 0
    v_mov_b32 v59, 0
    v_mov_b32 v60, 0
    v_mov_b32 v61, 0
    v_mov_b32 v62, 0
    v_mov_b32 v63, 0
    v_mov_b32 v64, 0
    v_mov_b32 v65, 0
    v_mov_b32 v66, 0
    v_mov_b32 v67, 0
    v_mov_b32 v68, 0
    v_mov_b32 v69, 0
    v_mov_b32 v70, 0
    v_mov_b32 v71, 0
    v_mov_b32 v72, 0
    v_mov_b32 v73, 0
    v_mov_b32 v74, 0
    v_mov_b32 v75, 0
    v_mov_b32 v76, 0
    v_mov_b32 v77, 0
    v_mov_b32 v78, 0
    v_mov_b32 v79, 0
    s_nop 1
C2M_PL:
    buffer_load_dwordx4 v[104:107], v3, s[8:11], s15 offen sc1
    buffer_load_dwordx4 v[108:111], v4, s[8:11], s15 offen sc1
    s_waitcnt vmcnt(0)
    v_max3_u32 v0, v104, v105, v106
    v_max3_u32 v1, v107, v108, v109
    v_max3_u32 v1, v1, v110, v111
    v_max_u32 v0, v0, v1
    v_cmp_eq_u32 vcc, -1, v0
    s_nop 0
    s_cbranch_vccz C2M_GOTA
    s_sub_u32 s19, s19, 1
    s_cbranch_scc0 C2M_PL
    s_mov_b32 s19, 0
    s_branch C2M_GOTA
C2M_GOTA:
    ds_write_b128 v3, v[104:107]
    ds_write_b128 v4, v[108:111]
    v_smfmac_f32_16x16x64_bf16 v[48:51], v[104:107], a[16:23], v2
    v_smfmac_f32_16x16x64_bf16 v[52:55], v[104:107], a[72:79], v2
    v_smfmac_f32_16x16x64_bf16 v[56:59], v[104:107], a[128:135], v2
    v_smfmac_f32_16x16x64_bf16 v[60:63], v[104:107], a[184:191], v2
    v_smfmac_f32_16x16x64_bf16 v[64:67], v[104:107], a[240:247], v2
    v_smfmac_f32_16x16x64_bf16 v[68:71], v[104:107], v[160:167], v2
    v_smfmac_f32_16x16x64_bf16 v[72:75], v[104:107], v[216:223], v2
    s_waitcnt lgkmcnt(0)
    s_barrier
    ds_read_b128 v[16:19], v5 offset:0
    ds_read_b128 v[20:23], v5 offset:1024
    ds_read_b128 v[28:31], v5 offset:3072
    ds_read_b128 v[32:35], v5 offset:4096
    ds_read_b128 v[36:39], v5 offset:5120
    v_smfmac_f32_16x16x64_bf16 v[48:51], v[108:111], a[48:55], v2
    buffer_store_dwordx4 v[80:83], v5, s[8:11], s24 offen offset:0 sc1
    v_smfmac_f32_16x16x64_bf16 v[52:55], v[108:111], a[104:111], v2
    buffer_store_dwordx4 v[84:87], v5, s[8:11], s24 offen offset:1024 sc1
    v_smfmac_f32_16x16x64_bf16 v[56:59], v[108:111], a[160:167], v2
    s_add_u32 s24, s24, 114688
    v_smfmac_f32_16x16x64_bf16 v[60:63], v[108:111], a[216:223], v2
    v_smfmac_f32_16x16x64_bf16 v[64:67], v[108:111], v[136:143], v2
    v_smfmac_f32_16x16x64_bf16 v[68:71], v[108:111], v[192:199], v2
    v_smfmac_f32_16x16x64_bf16 v[72:75], v[108:111], v[248:255], v2
    s_waitcnt lgkmcnt(4)
    v_smfmac_f32_16x16x64_bf16 v[48:51], v[16:19], a[0:7], v2
    s_waitcnt lgkmcnt(3)
    v_smfmac_f32_16x16x64_bf16 v[48:51], v[20:23], a[8:15], v2
    s_waitcnt lgkmcnt(2)
    v_smfmac_f32_16x16x64_bf16 v[48:51], v[28:31], a[24:31], v2
    s_waitcnt lgkmcnt(1)
    v_smfmac_f32_16x16x64_bf16 v[48:51], v[32:35], a[32:39], v2
    s_waitcnt lgkmcnt(0)
    v_smfmac_f32_16x16x64_bf16 v[48:51], v[36:39], a[40:47], v2
    v_smfmac_f32_16x16x64_bf16 v[52:55], v[16:19], a[56:63], v2
    v_smfmac_f32_16x16x64_bf16 v[52:55], v[20:23], a[64:71], v2
    v_smfmac_f32_16x16x64_bf16 v[52:55], v[28:31], a[80:87], v2
    v_smfmac_f32_16x16x64_bf16 v[52:55], v[32:35], a[88:95], v2
    s_mov_b32 m0, s26
    s_nop 0
    buffer_load_dwordx4 v5, s[8:11], s17 offen offset:0 sc1 lds
    v_smfmac_f32_16x16x64_bf16 v[52:55], v[36:39], a[96:103], v2
    v_smfmac_f32_16x16x64_bf16 v[56:59], v[16:19], a[112:119], v2
    buffer_load_dwordx4 v5, s[8:11], s17 offen offset:1024 sc1 lds
    v_smfmac_f32_16x16x64_bf16 v[56:59], v[20:23], a[120:127], v2
    v_smfmac_f32_16x16x64_bf16 v[56:59], v[28:31], a[136:143], v2
    buffer_load_dwordx4 v5, s[8:11], s17 offen offset:2048 sc1 lds
    v_smfmac_f32_16x16x64_bf16 v[56:59], v[32:35], a[144:151], v2
    v_smfmac_f32_16x16x64_bf16 v[56:59], v[36:39], a[152:159], v2
    buffer_load_dwordx4 v5, s[8:11], s17 offen offset:3072 sc1 lds
    v_smfmac_f32_16x16x64_bf16 v[60:63], v[16:19], a[168:175], v2
    v_smfmac_f32_16x16x64_bf16 v[60:63], v[20:23], a[176:183], v2
    s_add_u32 m0, s26, 4096
    s_nop 0
    buffer_load_dwordx4 v5, s[8:11], s29 offen offset:0 sc1 lds
    v_smfmac_f32_16x16x64_bf16 v[60:63], v[28:31], a[192:199], v2
    v_smfmac_f32_16x16x64_bf16 v[60:63], v[32:35], a[200:207], v2
    buffer_load_dwordx4 v5, s[8:11], s29 offen offset:1024 sc1 lds
    v_smfmac_f32_16x16x64_bf16 v[60:63], v[36:39], a[208:215], v2
    v_smfmac_f32_16x16x64_bf16 v[64:67], v[16:19], a[224:231], v2
    buffer_load_dwordx4 v5, s[8:11], s29 offen offset:2048 sc1 lds
    v_smfmac_f32_16x16x64_bf16 v[64:67], v[20:23], a[232:239], v2
    v_smfmac_f32_16x16x64_bf16 v[64:67], v[28:31], a[248:255], v2
    buffer_load_dwordx4 v5, s[8:11], s29 offen offset:3072 sc1 lds
    v_smfmac_f32_16x16x64_bf16 v[64:67], v[32:35], v[120:127], v2
    v_smfmac_f32_16x16x64_bf16 v[64:67], v[36:39], v[128:135], v2
    v_smfmac_f32_16x16x64_bf16 v[68:71], v[16:19], v[144:151], v2
    v_smfmac_f32_16x16x64_bf16 v[68:71], v[20:23], v[152:159], v2
    s_add_u32 s17, s17, 458752
    s_add_u32 s29, s29, 458752
    s_add_u32 s26, s26, s28
    s_sub_u32 s28, 0, s28
    v_smfmac_f32_16x16x64_bf16 v[68:71], v[28:31], v[168:175], v2
    v_smfmac_f32_16x16x64_bf16 v[68:71], v[32:35], v[176:183], v2
    v_smfmac_f32_16x16x64_bf16 v[68:71], v[36:39], v[184:191], v2
    v_smfmac_f32_16x16x64_bf16 v[72:75], v[16:19], v[200:207], v2
    v_smfmac_f32_16x16x64_bf16 v[72:75], v[20:23], v[208:215], v2
    v_smfmac_f32_16x16x64_bf16 v[72:75], v[28:31], v[224:231], v2
    ds_read_b128 v[88:91], v6 offset:0
    ds_read_b128 v[92:95], v6 offset:1024
    v_smfmac_f32_16x16x64_bf16 v[72:75], v[32:35], v[232:239], v2
    ds_read_b128 v[96:99], v6 offset:2048
    ds_read_b128 v[100:103], v6 offset:3072
    v_smfmac_f32_16x16x64_bf16 v[72:75], v[36:39], v[240:247], v2
    s_waitcnt lgkmcnt(2)
    v_smfmac_f32_16x16x64_bf16 v[76:79], v[16:19], v[88:95], v2
    ds_read_b128 v[88:91], v6 offset:4096
    ds_read_b128 v[92:95], v6 offset:5120
    s_waitcnt lgkmcnt(2)
    v_smfmac_f32_16x16x64_bf16 v[76:79], v[20:23], v[96:103], v2
    ds_read_b128 v[96:99], v6 offset:6144
    ds_read_b128 v[100:103], v6 offset:7168
    s_waitcnt lgkmcnt(2)
    v_smfmac_f32_16x16x64_bf16 v[76:79], v[104:107], v[88:95], v2
    ds_read_b128 v[88:91], v6 offset:8192
    ds_read_b128 v[92:95], v6 offset:9216
    s_waitcnt lgkmcnt(2)
    v_smfmac_f32_16x16x64_bf16 v[76:79], v[28:31], v[96:103], v2
    ds_read_b128 v[96:99], v6 offset:10240
    ds_read_b128 v[100:103], v6 offset:11264
    s_waitcnt lgkmcnt(2)
    v_smfmac_f32_16x16x64_bf16 v[76:79], v[32:35], v[88:95], v2
    ds_read_b128 v[88:91], v6 offset:12288
    ds_read_b128 v[92:95], v6 offset:13312
    s_waitcnt lgkmcnt(2)
    v_smfmac_f32_16x16x64_bf16 v[76:79], v[36:39], v[96:103], v2
    s_waitcnt lgkmcnt(0)
    v_smfmac_f32_16x16x64_bf16 v[76:79], v[108:111], v[88:95], v2
    ds_read_b128 v[16:19], v7 offset:0
    ds_read_b128 v[20:23], v7 offset:1024
    ds_read_b128 v[24:27], v7 offset:2048
    ds_read_b128 v[28:31], v7 offset:3072
    ds_read_b128 v[32:35], v7 offset:4096
    ds_read_b128 v[36:39], v7 offset:5120
    ds_read_b128 v[40:43], v7 offset:6144
    ds_read_b128 v[44:47], v7 offset:7168
    v_permlane32_swap_b32 v48, v56
    v_permlane32_swap_b32 v49, v57
    v_permlane32_swap_b32 v50, v58
    v_permlane32_swap_b32 v51, v59
    v_add_f32 v48, v48, v56
    v_add_f32 v49, v49, v57
    v_add_f32 v50, v50, v58
    v_add_f32 v51, v51, v59
    v_cvt_pk_bf16_f32 v80, v48, v49
    v_cvt_pk_bf16_f32 v81, v50, v51
    v_permlane32_swap_b32 v64, v72
    v_permlane32_swap_b32 v65, v73
    v_permlane32_swap_b32 v66, v74
    v_permlane32_swap_b32 v67, v75
    v_add_f32 v64, v64, v72
    v_add_f32 v65, v65, v73
    v_add_f32 v66, v66, v74
    v_add_f32 v67, v67, v75
    v_cvt_pk_bf16_f32 v82, v64, v65
    v_cvt_pk_bf16_f32 v83, v66, v67
    v_permlane32_swap_b32 v52, v60
    v_permlane32_swap_b32 v53, v61
    v_permlane32_swap_b32 v54, v62
    v_permlane32_swap_b32 v55, v63
    v_add_f32 v52, v52, v60
    v_add_f32 v53, v53, v61
    v_add_f32 v54, v54, v62
    v_add_f32 v55, v55, v63
    v_cvt_pk_bf16_f32 v84, v52, v53
    v_cvt_pk_bf16_f32 v85, v54, v55
    v_permlane32_swap_b32 v68, v76
    v_permlane32_swap_b32 v69, v77
    v_permlane32_swap_b32 v70, v78
    v_permlane32_swap_b32 v71, v79
    v_add_f32 v68, v68, v76
    v_add_f32 v69, v69, v77
    v_add_f32 v70, v70, v78
    v_add_f32 v71, v71, v79
    v_cvt_pk_bf16_f32 v86, v68, v69
    v_cvt_pk_bf16_f32 v87, v70, v71
    v_add_u32 v7, s28, v7
    s_cmp_ge_u32 s14, 63
    s_nop 0
    s_cbranch_scc1 C2_DONE
    v_mov_b32 v48, 0
    v_mov_b32 v49, 0
    v_mov_b32 v50, 0
    v_mov_b32 v51, 0
    v_mov_b32 v52, 0
    v_mov_b32 v53, 0
    v_mov_b32 v54, 0
    v_mov_b32 v55, 0
    v_mov_b32 v56, 0
    v_mov_b32 v57, 0
    v_mov_b32 v58, 0
    v_mov_b32 v59, 0
    v_mov_b32 v60, 0
    v_mov_b32 v61, 0
    v_mov_b32 v62, 0
    v_mov_b32 v63, 0
    s_nop 1
C2P_PL:
    buffer_load_dwordx4 v[88:91], v8, s[8:11], s16 offen sc1
    buffer_load_dwordx4 v[92:95], v8, s[8:11], s16 offen offset:1024 sc1
    buffer_load_dwordx4 v[96:99], v12, s[8:11], s16 offen offset:2048 sc1
    s_waitcnt vmcnt(0)
    v_max3_u32 v0, v88, v89, v90
    v_max3_u32 v1, v91, v92, v93
    v_max3_u32 v1, v1, v94, v95
    v_max3_u32 v0, v0, v96, v97
    v_max3_u32 v1, v1, v98, v99
    v_max_u32 v0, v0, v1
    v_cmp_eq_u32 vcc, -1, v0
    s_nop 0
    s_cbranch_vccz C2P_GOTA
    s_sub_u32 s19, s19, 1
    s_cbranch_scc0 C2P_PL
    s_mov_b32 s19, 0
    s_branch C2P_GOTA
C2P_GOTA:
    s_waitcnt lgkmcnt(0)
    v_mfma_f32_16x16x32_bf16 v[56:59], v[24:27], v[88:91], v[56:59]
    v_mfma_f32_16x16x32_bf16 v[56:59], v[40:43], v[92:95], v[56:59]
    v_mfma_f32_16x16x32_bf16 v[48:51], v[16:19], v[88:91], v[48:51]
    v_mfma_f32_16x16x32_bf16 v[48:51], v[32:35], v[92:95], v[48:51]
    v_mfma_f32_16x16x32_bf16 v[48:51], v[80:83], v[96:99], v[48:51]
    v_mfma_f32_16x16x32_bf16 v[60:63], v[28:31], v[88:91], v[60:63]
    v_mfma_f32_16x16x32_bf16 v[60:63], v[44:47], v[92:95], v[60:63]
    v_mfma_f32_16x16x32_bf16 v[52:55], v[20:23], v[88:91], v[52:55]
    v_mfma_f32_16x16x32_bf16 v[52:55], v[36:39], v[92:95], v[52:55]
    v_mfma_f32_16x16x32_bf16 v[52:55], v[84:87], v[96:99], v[52:55]
    s_nop 7
    s_branch C2P_GOT
C2P_GOTB:
    s_waitcnt lgkmcnt(0)
    v_mfma_f32_16x16x32_bf16 v[56:59], v[24:27], v[100:103], v[56:59]
    v_mfma_f32_16x16x32_bf16 v[56:59], v[40:43], v[104:107], v[56:59]
    v_mfma_f32_16x16x32_bf16 v[48:51], v[16:19], v[100:103], v[48:51]
    v_mfma_f32_16x16x32_bf16 v[48:51], v[32:35], v[104:107], v[48:51]
    v_mfma_f32_16x16x32_bf16 v[48:51], v[80:83], v[108:111], v[48:51]
    v_mfma_f32_16x16x32_bf16 v[60:63], v[28:31], v[100:103], v[60:63]
    v_mfma_f32_16x16x32_bf16 v[60:63], v[44:47], v[104:107], v[60:63]
    v_mfma_f32_16x16x32_bf16 v[52:55], v[20:23], v[100:103], v[52:55]
    v_mfma_f32_16x16x32_bf16 v[52:55], v[36:39], v[104:107], v[52:55]
    v_mfma_f32_16x16x32_bf16 v[52:55], v[84:87], v[108:111], v[52:55]
    s_nop 7
C2P_GOT:
    v_add_f32_dpp v48, v56, v48 row_ror:8 row_mask:0xf bank_mask:0xf
    v_add_f32_dpp v49, v57, v49 row_ror:8 row_mask:0xf bank_mask:0xf
    v_add_f32_dpp v50, v58, v50 row_ror:8 row_mask:0xf bank_mask:0xf
    v_add_f32_dpp v51, v59, v51 row_ror:8 row_mask:0xf bank_mask:0xf
    ds_write_b128 v9, v[48:51] offset:0
    v_add_f32_dpp v52, v60, v52 row_ror:8 row_mask:0xf bank_mask:0xf
    v_add_f32_dpp v53, v61, v53 row_ror:8 row_mask:0xf bank_mask:0xf
    v_add_f32_dpp v54, v62, v54 row_ror:8 row_mask:0xf bank_mask:0xf
    v_add_f32_dpp v55, v63, v55 row_ror:8 row_mask:0xf bank_mask:0xf
    ds_write_b128 v9, v[52:55] offset:1024
    s_waitcnt lgkmcnt(0)
    s_barrier
    s_add_u32 s15, s15, 8192
    s_add_u32 s16, s16, 10240
    s_add_u32 s23, s23, 8192
    s_add_u32 s32, s32, 8192
    s_add_u32 s31, s31, 128
    s_add_u32 s33, s33, 128
    s_add_u32 s34, s34, 128
    s_add_u32 s14, s14, 1
    s_branch C2_LOOP
C2_DONE:
    buffer_store_dwordx4 v[80:83], v5, s[8:11], s24 offen offset:0 sc1
    buffer_store_dwordx4 v[84:87], v5, s[8:11], s24 offen offset:1024 sc1
    s_waitcnt vmcnt(0)
    s_barrier
    s_endpgm
C3_LOOP:
    v_mov_b32 v48, 0
    v_mov_b32 v49, 0
    v_mov_b32 v50, 0
    v_mov_b32 v51, 0
    v_mov_b32 v52, 0
    v_mov_b32 v53, 0
    v_mov_b32 v54, 0
    v_mov_b32 v55, 0
    v_mov_b32 v56, 0
    v_mov_b32 v57, 0
    v_mov_b32 v58, 0
    v_mov_b32 v59, 0
    v_mov_b32 v60, 0
    v_mov_b32 v61, 0
    v_mov_b32 v62, 0
    v_mov_b32 v63, 0
    v_mov_b32 v64, 0
    v_mov_b32 v65, 0
    v_mov_b32 v66, 0
    v_mov_b32 v67, 0
    v_mov_b32 v68, 0
    v_mov_b32 v69, 0
    v_mov_b32 v70, 0
    v_mov_b32 v71, 0
    v_mov_b32 v72, 0
    v_mov_b32 v73, 0
    v_mov_b32 v74, 0
    v_mov_b32 v75, 0
    v_mov_b32 v76, 0
    v_mov_b32 v77, 0
    v_mov_b32 v78, 0
    v_mov_b32 v79, 0
    s_nop 1
C3M_PL:
    buffer_load_dwordx4 v[104:107], v3, s[8:11], s15 offen sc1
    buffer_load_dwordx4 v[108:111], v4, s[8:11], s15 offen sc1
    s_waitcnt vmcnt(0)
    v_max3_u32 v0, v104, v105, v106
    v_max3_u32 v1, v107, v108, v109
    v_max3_u32 v1, v1, v110, v111
    v_max_u32 v0, v0, v1
    v_cmp_eq_u32 vcc, -1, v0
    s_nop 0
    s_cbranch_vccz C3M_GOTA
    s_sub_u32 s19, s19, 1
    s_cbranch_scc0 C3M_PL
    s_mov_b32 s19, 0
    s_branch C3M_GOTA
C3M_GOTA:
    ds_write_b128 v3, v[104:107]
    ds_write_b128 v4, v[108:111]
    v_smfmac_f32_16x16x64_bf16 v[48:51], v[104:107], a[24:31], v2
    v_smfmac_f32_16x16x64_bf16 v[52:55], v[104:107], a[80:87], v2
    v_smfmac_f32_16x16x64_bf16 v[56:59], v[104:107], a[136:143], v2
    v_smfmac_f32_16x16x64_bf16 v[60:63], v[104:107], a[192:199], v2
    v_smfmac_f32_16x16x64_bf16 v[64:67], v[104:107], a[248:255], v2
    v_smfmac_f32_16x16x64_bf16 v[68:71], v[104:107], v[168:175], v2
    v_smfmac_f32_16x16x64_bf16 v[72:75], v[104:107], v[224:231], v2
    s_waitcnt lgkmcnt(0)
    s_barrier
    ds_read_b128 v[16:19], v5 offset:0
    ds_read_b128 v[20:23], v5 offset:1024
    ds_read_b128 v[24:27], v5 offset:2048
    ds_read_b128 v[32:35], v5 offset:4096
    ds_read_b128 v[36:39], v5 offset:5120
    ds_read_b128 v[40:43], v5 offset:6144
    s_waitcnt lgkmcnt(5)
    v_smfmac_f32_16x16x64_bf16 v[48:51], v[16:19], a[0:7], v2
    buffer_store_dwordx4 v[80:83], v5, s[8:11], s24 offen offset:0 sc1
    s_waitcnt lgkmcnt(4)
    v_smfmac_f32_16x16x64_bf16 v[48:51], v[20:23], a[8:15], v2
    buffer_store_dwordx4 v[84:87], v5, s[8:11], s24 offen offset:1024 sc1
    s_waitcnt lgkmcnt(3)
    v_smfmac_f32_16x16x64_bf16 v[48:51], v[24:27], a[16:23], v2
    s_add_u32 s24, s24, 114688
    s_waitcnt lgkmcnt(2)
    v_smfmac_f32_16x16x64_bf16 v[48:51], v[32:35], a[32:39], v2
    s_waitcnt lgkmcnt(1)
    v_smfmac_f32_16x16x64_bf16 v[48:51], v[36:39], a[40:47], v2
    s_waitcnt lgkmcnt(0)
    v_smfmac_f32_16x16x64_bf16 v[48:51], v[40:43], a[48:55], v2
    v_smfmac_f32_16x16x64_bf16 v[52:55], v[16:19], a[56:63], v2
    v_smfmac_f32_16x16x64_bf16 v[52:55], v[20:23], a[64:71], v2
    v_smfmac_f32_16x16x64_bf16 v[52:55], v[24:27], a[72:79], v2
    v_smfmac_f32_16x16x64_bf16 v[52:55], v[32:35], a[88:95], v2
    v_smfmac_f32_16x16x64_bf16 v[52:55], v[36:39], a[96:103], v2
    v_smfmac_f32_16x16x64_bf16 v[52:55], v[40:43], a[104:111], v2
    v_smfmac_f32_16x16x64_bf16 v[56:59], v[16:19], a[112:119], v2
    v_smfmac_f32_16x16x64_bf16 v[56:59], v[20:23], a[120:127], v2
    v_smfmac_f32_16x16x64_bf16 v[56:59], v[24:27], a[128:135], v2
    v_smfmac_f32_16x16x64_bf16 v[56:59], v[32:35], a[144:151], v2
    v_smfmac_f32_16x16x64_bf16 v[56:59], v[36:39], a[152:159], v2
    s_mov_b32 m0, s26
    s_nop 0
    buffer_load_dwordx4 v5, s[8:11], s17 offen offset:0 sc1 lds
    v_smfmac_f32_16x16x64_bf16 v[56:59], v[40:43], a[160:167], v2
    v_smfmac_f32_16x16x64_bf16 v[60:63], v[16:19], a[168:175], v2
    buffer_load_dwordx4 v5, s[8:11], s17 offen offset:1024 sc1 lds
    v_smfmac_f32_16x16x64_bf16 v[60:63], v[20:23], a[176:183], v2
    v_smfmac_f32_16x16x64_bf16 v[60:63], v[24:27], a[184:191], v2
    buffer_load_dwordx4 v5, s[8:11], s17 offen offset:2048 sc1 lds
    v_smfmac_f32_16x16x64_bf16 v[60:63], v[32:35], a[200:207], v2
    v_smfmac_f32_16x16x64_bf16 v[60:63], v[36:39], a[208:215], v2
    buffer_load_dwordx4 v5, s[8:11], s17 offen offset:3072 sc1 lds
    v_smfmac_f32_16x16x64_bf16 v[60:63], v[40:43], a[216:223], v2
    v_smfmac_f32_16x16x64_bf16 v[64:67], v[16:19], a[224:231], v2
    s_add_u32 m0, s26, 4096
    s_nop 0
    buffer_load_dwordx4 v5, s[8:11], s29 offen offset:0 sc1 lds
    v_smfmac_f32_16x16x64_bf16 v[64:67], v[20:23], a[232:239], v2
    v_smfmac_f32_16x16x64_bf16 v[64:67], v[24:27], a[240:247], v2
    buffer_load_dwordx4 v5, s[8:11], s29 offen offset:1024 sc1 lds
    v_smfmac_f32_16x16x64_bf16 v[64:67], v[32:35], v[120:127], v2
    v_smfmac_f32_16x16x64_bf16 v[64:67], v[36:39], v[128:135], v2
    buffer_load_dwordx4 v5, s[8:11], s29 offen offset:2048 sc1 lds
    v_smfmac_f32_16x16x64_bf16 v[64:67], v[40:43], v[136:143], v2
    v_smfmac_f32_16x16x64_bf16 v[68:71], v[16:19], v[144:151], v2
    buffer_load_dwordx4 v5, s[8:11], s29 offen offset:3072 sc1 lds
    v_smfmac_f32_16x16x64_bf16 v[68:71], v[20:23], v[152:159], v2
    v_smfmac_f32_16x16x64_bf16 v[68:71], v[24:27], v[160:167], v2
    v_smfmac_f32_16x16x64_bf16 v[68:71], v[32:35], v[176:183], v2
    s_add_u32 s17, s17, 458752
    s_add_u32 s29, s29, 458752
    s_add_u32 s26, s26, s28
    s_sub_u32 s28, 0, s28
    v_smfmac_f32_16x16x64_bf16 v[68:71], v[36:39], v[184:191], v2
    v_smfmac_f32_16x16x64_bf16 v[68:71], v[40:43], v[192:199], v2
    v_smfmac_f32_16x16x64_bf16 v[72:75], v[16:19], v[200:207], v2
    v_smfmac_f32_16x16x64_bf16 v[72:75], v[20:23], v[208:215], v2
    v_smfmac_f32_16x16x64_bf16 v[72:75], v[24:27], v[216:223], v2
    v_smfmac_f32_16x16x64_bf16 v[72:75], v[32:35], v[232:239], v2
    ds_read_b128 v[88:91], v6 offset:0
    ds_read_b128 v[92:95], v6 offset:1024
    v_smfmac_f32_16x16x64_bf16 v[72:75], v[36:39], v[240:247], v2
    ds_read_b128 v[96:99], v6 offset:2048
    ds_read_b128 v[100:103], v6 offset:3072
    v_smfmac_f32_16x16x64_bf16 v[72:75], v[40:43], v[248:255], v2
    s_waitcnt lgkmcnt(2)
    v_smfmac_f32_16x16x64_bf16 v[76:79], v[16:19], v[88:95], v2
    ds_read_b128 v[88:91], v6 offset:4096
    ds_read_b128 v[92:95], v6 offset:5120
    s_waitcnt lgkmcnt(2)
    v_smfmac_f32_16x16x64_bf16 v[76:79], v[20:23], v[96:103], v2
    ds_read_b128 v[96:99], v6 offset:6144
    ds_read_b128 v[100:103], v6 offset:7168
    s_waitcnt lgkmcnt(2)
    v_smfmac_f32_16x16x64_bf16 v[76:79], v[24:27], v[88:95], v2
    ds_read_b128 v[88:91], v6 offset:8192
    ds_read_b128 v[92:95], v6 offset:9216
    s_waitcnt lgkmcnt(2)
    v_smfmac_f32_16x16x64_bf16 v[76:79], v[104:107], v[96:103], v2
    ds_read_b128 v[96:99], v6 offset:10240
    ds_read_b128 v[100:103], v6 offset:11264
    s_waitcnt lgkmcnt(2)
    v_smfmac_f32_16x16x64_bf16 v[76:79], v[32:35], v[88:95], v2
    ds_read_b128 v[88:91], v6 offset:12288
    ds_read_b128 v[92:95], v6 offset:13312
    s_waitcnt lgkmcnt(2)
    v_smfmac_f32_16x16x64_bf16 v[76:79], v[36:39], v[96:103], v2
    s_waitcnt lgkmcnt(0)
    v_smfmac_f32_16x16x64_bf16 v[76:79], v[40:43], v[88:95], v2
    ds_read_b128 v[16:19], v7 offset:0
    ds_read_b128 v[20:23], v7 offset:1024
    ds_read_b128 v[24:27], v7 offset:2048
    ds_read_b128 v[28:31], v7 offset:3072
    ds_read_b128 v[32:35], v7 offset:4096
    ds_read_b128 v[36:39], v7 offset:5120
    ds_read_b128 v[40:43], v7 offset:6144
    ds_read_b128 v[44:47], v7 offset:7168
    v_permlane32_swap_b32 v48, v56
    v_permlane32_swap_b32 v49, v57
    v_permlane32_swap_b32 v50, v58
    v_permlane32_swap_b32 v51, v59
    v_add_f32 v48, v48, v56
    v_add_f32 v49, v49, v57
    v_add_f32 v50, v50, v58
    v_add_f32 v51, v51, v59
    v_cvt_pk_bf16_f32 v80, v48, v49
    v_cvt_pk_bf16_f32 v81, v50, v51
    v_permlane32_swap_b32 v64, v72
    v_permlane32_swap_b32 v65, v73
    v_permlane32_swap_b32 v66, v74
    v_permlane32_swap_b32 v67, v75
    v_add_f32 v64, v64, v72
    v_add_f32 v65, v65, v73
    v_add_f32 v66, v66, v74
    v_add_f32 v67, v67, v75
    v_cvt_pk_bf16_f32 v82, v64, v65
    v_cvt_pk_bf16_f32 v83, v66, v67
    v_permlane32_swap_b32 v52, v60
    v_permlane32_swap_b32 v53, v61
    v_permlane32_swap_b32 v54, v62
    v_permlane32_swap_b32 v55, v63
    v_add_f32 v52, v52, v60
    v_add_f32 v53, v53, v61
    v_add_f32 v54, v54, v62
    v_add_f32 v55, v55, v63
    v_cvt_pk_bf16_f32 v84, v52, v53
    v_cvt_pk_bf16_f32 v85, v54, v55
    v_permlane32_swap_b32 v68, v76
    v_permlane32_swap_b32 v69, v77
    v_permlane32_swap_b32 v70, v78
    v_permlane32_swap_b32 v71, v79
    v_add_f32 v68, v68, v76
    v_add_f32 v69, v69, v77
    v_add_f32 v70, v70, v78
    v_add_f32 v71, v71, v79
    v_cvt_pk_bf16_f32 v86, v68, v69
    v_cvt_pk_bf16_f32 v87, v70, v71
    v_add_u32 v7, s28, v7
    s_cmp_ge_u32 s14, 63
    s_nop 0
    s_cbranch_scc1 C3_DONE
    v_mov_b32 v48, 0
    v_mov_b32 v49, 0
    v_mov_b32 v50, 0
    v_mov_b32 v51, 0
    v_mov_b32 v52, 0
    v_mov_b32 v53, 0
    v_mov_b32 v54, 0
    v_mov_b32 v55, 0
    v_mov_b32 v56, 0
    v_mov_b32 v57, 0
    v_mov_b32 v58, 0
    v_mov_b32 v59, 0
    v_mov_b32 v60, 0
    v_mov_b32 v61, 0
    v_mov_b32 v62, 0
    v_mov_b32 v63, 0
    s_nop 1
C3P_PL:
    buffer_load_dwordx4 v[88:91], v8, s[8:11], s16 offen sc1
    buffer_load_dwordx4 v[92:95], v8, s[8:11], s16 offen offset:1024 sc1
    buffer_load_dwordx4 v[96:99], v12, s[8:11], s16 offen offset:2048 sc1
    s_waitcnt vmcnt(0)
    v_max3_u32 v0, v88, v89, v90
    v_max3_u32 v1, v91, v92, v93
    v_max3_u32 v1, v1, v94, v95
    v_max3_u32 v0, v0, v96, v97
    v_max3_u32 v1, v1, v98, v99
    v_max_u32 v0, v0, v1
    v_cmp_eq_u32 vcc, -1, v0
    s_nop 0
    s_cbranch_vccz C3P_GOTA
    s_sub_u32 s19, s19, 1
    s_cbranch_scc0 C3P_PL
    s_mov_b32 s19, 0
    s_branch C3P_GOTA
C3P_GOTA:
    s_waitcnt lgkmcnt(0)
    v_mfma_f32_16x16x32_bf16 v[56:59], v[24:27], v[88:91], v[56:59]
    v_mfma_f32_16x16x32_bf16 v[56:59], v[40:43], v[92:95], v[56:59]
    v_mfma_f32_16x16x32_bf16 v[48:51], v[16:19], v[88:91], v[48:51]
    v_mfma_f32_16x16x32_bf16 v[48:51], v[32:35], v[92:95], v[48:51]
    v_mfma_f32_16x16x32_bf16 v[48:51], v[80:83], v[96:99], v[48:51]
    v_mfma_f32_16x16x32_bf16 v[60:63], v[28:31], v[88:91], v[60:63]
    v_mfma_f32_16x16x32_bf16 v[60:63], v[44:47], v[92:95], v[60:63]
    v_mfma_f32_16x16x32_bf16 v[52:55], v[20:23], v[88:91], v[52:55]
    v_mfma_f32_16x16x32_bf16 v[52:55], v[36:39], v[92:95], v[52:55]
    v_mfma_f32_16x16x32_bf16 v[52:55], v[84:87], v[96:99], v[52:55]
    s_nop 7
    s_branch C3P_GOT
C3P_GOTB:
    s_waitcnt lgkmcnt(0)
    v_mfma_f32_16x16x32_bf16 v[56:59], v[24:27], v[100:103], v[56:59]
    v_mfma_f32_16x16x32_bf16 v[56:59], v[40:43], v[104:107], v[56:59]
    v_mfma_f32_16x16x32_bf16 v[48:51], v[16:19], v[100:103], v[48:51]
    v_mfma_f32_16x16x32_bf16 v[48:51], v[32:35], v[104:107], v[48:51]
    v_mfma_f32_16x16x32_bf16 v[48:51], v[80:83], v[108:111], v[48:51]
    v_mfma_f32_16x16x32_bf16 v[60:63], v[28:31], v[100:103], v[60:63]
    v_mfma_f32_16x16x32_bf16 v[60:63], v[44:47], v[104:107], v[60:63]
    v_mfma_f32_16x16x32_bf16 v[52:55], v[20:23], v[100:103], v[52:55]
    v_mfma_f32_16x16x32_bf16 v[52:55], v[36:39], v[104:107], v[52:55]
    v_mfma_f32_16x16x32_bf16 v[52:55], v[84:87], v[108:111], v[52:55]
    s_nop 7
C3P_GOT:
    v_add_f32_dpp v48, v56, v48 row_ror:8 row_mask:0xf bank_mask:0xf
    v_add_f32_dpp v49, v57, v49 row_ror:8 row_mask:0xf bank_mask:0xf
    v_add_f32_dpp v50, v58, v50 row_ror:8 row_mask:0xf bank_mask:0xf
    v_add_f32_dpp v51, v59, v51 row_ror:8 row_mask:0xf bank_mask:0xf
    ds_write_b128 v9, v[48:51] offset:0
    v_add_f32_dpp v52, v60, v52 row_ror:8 row_mask:0xf bank_mask:0xf
    v_add_f32_dpp v53, v61, v53 row_ror:8 row_mask:0xf bank_mask:0xf
    v_add_f32_dpp v54, v62, v54 row_ror:8 row_mask:0xf bank_mask:0xf
    v_add_f32_dpp v55, v63, v55 row_ror:8 row_mask:0xf bank_mask:0xf
    ds_write_b128 v9, v[52:55] offset:1024
    s_waitcnt lgkmcnt(0)
    s_barrier
    s_add_u32 s15, s15, 8192
    s_add_u32 s16, s16, 10240
    s_add_u32 s23, s23, 8192
    s_add_u32 s32, s32, 8192
    s_add_u32 s31, s31, 128
    s_add_u32 s33, s33, 128
    s_add_u32 s34, s34, 128
    s_add_u32 s14, s14, 1
    s_branch C3_LOOP
C3_DONE:
    buffer_store_dwordx4 v[80:83], v5, s[8:11], s24 offen offset:0 sc1
    buffer_store_dwordx4 v[84:87], v5, s[8:11], s24 offen offset:1024 sc1
    s_waitcnt vmcnt(0)
    s_barrier
    s_endpgm
ROLE_PF:
    s_cmp_eq_u32 s12, 31
    s_cbranch_scc0 PF0_START
    s_cmp_eq_u32 s13, 1
    s_cbranch_scc1 PF2_START
    s_cmp_eq_u32 s13, 2
    s_cbranch_scc1 PF3_START
    s_cmp_lg_u32 s13, 0
    s_cbranch_scc1 PF1_END
    v_lshlrev_b32 v2, 4, v1
    v_mov_b32 v3, 0
    v_mov_b32 v8, 0
    v_mov_b32 v9, 0
    v_mov_b32 v10, 0
    v_mov_b32 v11, 0
    s_mov_b32 s14, 0
    s_mov_b32 s19, 0x40000
    s_mov_b32 s18, 112197760
PF1_POLL1:
    buffer_load_dword v4, v3, s[8:11], s18 offen sc1
    s_waitcnt vmcnt(0)
    v_readfirstlane_b32 s21, v4
    s_nop 0
    s_cmp_ge_u32 s21, 28
    s_nop 2
    s_cbranch_scc1 PF1_OK1
    s_sleep 4
    s_sub_u32 s19, s19, 1
    s_cbranch_scc0 PF1_POLL1
    s_mov_b32 s19, 0
PF1_OK1:
    s_mov_b32 s18, 112197888
    s_mov_b32 s20, 16260096
PF1_LOOP:
    s_cmp_ge_u32 s14, 62
    s_cbranch_scc1 PF1_OK
PF1_POLL:
    buffer_load_dword v4, v3, s[8:11], s18 offen sc1
    s_waitcnt vmcnt(0)
    v_readfirstlane_b32 s21, v4
    s_nop 0
    s_cmp_ge_u32 s21, 28
    s_nop 2
    s_cbranch_scc1 PF1_OK
    s_sleep 4
    s_sub_u32 s19, s19, 1
    s_cbranch_scc0 PF1_POLL
    s_mov_b32 s19, 0
PF1_OK:
    buffer_store_dwordx4 v[8:11], v2, s[8:11], s20 offen
    s_add_u32 s18, s18, 128
    s_add_u32 s20, s20, 8192
    s_add_u32 s14, s14, 1
    s_cmp_lt_u32 s14, 64
    s_cbranch_scc1 PF1_LOOP
    s_waitcnt vmcnt(0)
PF1_END:
    s_endpgm
PF2_START:
    v_min_u32 v2, 13, v1
    v_lshlrev_b32 v2, 2, v2
    v_mov_b32 v3, 0
    v_mov_b32 v5, 14
    v_lshlrev_b32 v6, 4, v1
    s_mov_b32 s14, 0
    s_mov_b32 s19, 0x80000
    s_mov_b32 s18, 112240128
    s_mov_b32 s20, 112214016
    s_mov_b32 s15, 16252928
    s_mov_b32 s32, 111149056
PF2_LOOP:
    s_add_u32 s21, s15, 4096
    buffer_load_dwordx4 v[16:19], v6, s[8:11], s15 offen offset:0 sc1
    buffer_load_dwordx4 v[20:23], v6, s[8:11], s15 offen offset:1024 sc1
    buffer_load_dwordx4 v[24:27], v6, s[8:11], s15 offen offset:2048 sc1
    buffer_load_dwordx4 v[28:31], v6, s[8:11], s15 offen offset:3072 sc1
    buffer_load_dwordx4 v[32:35], v6, s[8:11], s21 offen offset:0 sc1
    buffer_load_dwordx4 v[36:39], v6, s[8:11], s21 offen offset:1024 sc1
    buffer_load_dwordx4 v[40:43], v6, s[8:11], s21 offen offset:2048 sc1
    s_waitcnt vmcnt(0)
    v_max3_u32 v8, v16, v17, v18
    v_max3_u32 v9, v19, v20, v21
    v_max3_u32 v9, v9, v22, v23
    v_max3_u32 v8, v8, v24, v25
    v_max3_u32 v9, v9, v26, v27
    v_max3_u32 v8, v8, v28, v29
    v_max3_u32 v9, v9, v30, v31
    v_max3_u32 v8, v8, v32, v33
    v_max3_u32 v9, v9, v34, v35
    v_max3_u32 v8, v8, v36, v37
    v_max3_u32 v9, v9, v38, v39
    v_max3_u32 v8, v8, v40, v41
    v_max3_u32 v9, v9, v42, v43
    v_max_u32 v8, v8, v9
    v_cmp_eq_u32 vcc, -1, v8
    s_nop 0
    s_cbranch_vccz PF2_MOK
    s_sleep 2
    s_sub_u32 s19, s19, 1
    s_cbranch_scc0 PF2_LOOP
    s_mov_b32 s19, 0
PF2_MOK:
    s_add_u32 s21, s32, 4096
    buffer_store_dwordx4 v[16:19], v6, s[8:11], s32 offen offset:0 sc1
    buffer_store_dwordx4 v[20:23], v6, s[8:11], s32 offen offset:1024 sc1
    buffer_store_dwordx4 v[24:27], v6, s[8:11], s32 offen offset:2048 sc1
    buffer_store_dwordx4 v[28:31], v6, s[8:11], s32 offen offset:3072 sc1
    buffer_store_dwordx4 v[32:35], v6, s[8:11], s21 offen offset:0 sc1
    buffer_store_dwordx4 v[36:39], v6, s[8:11], s21 offen offset:1024 sc1
    buffer_store_dwordx4 v[40:43], v6, s[8:11], s21 offen offset:2048 sc1
    s_waitcnt vmcnt(0)
    s_add_u32 s21, s20, 43008
    buffer_store_dword v5, v3, s[8:11], s21 offen sc1
    s_add_u32 s20, s20, 128
    s_add_u32 s15, s15, 8192
    s_add_u32 s32, s32, 8192
    s_add_u32 s14, s14, 1
    s_cmp_lt_u32 s14, 64
    s_cbranch_scc1 PF2_LOOP
    s_waitcnt vmcnt(0)
    s_endpgm
PF3_START:
    v_min_u32 v2, 13, v1
    v_lshlrev_b32 v2, 2, v2
    v_mov_b32 v3, 0
    v_mov_b32 v5, 14
    s_mov_b32 s14, 0
    s_mov_b32 s19, 0x80000
    s_mov_b32 s18, 112240128
    s_mov_b32 s20, 112214016
PF3_UP:
    buffer_load_dword v4, v2, s[8:11], s18 offen sc1
    s_waitcnt vmcnt(0)
    v_cmp_eq_u32 vcc, 0, v4
    s_cbranch_vccz PF3_OK
    s_sleep 1
    s_sub_u32 s19, s19, 1
    s_cbranch_scc0 PF3_UP
    s_mov_b32 s19, 0
PF3_OK:
    buffer_store_dword v5, v3, s[8:11], s20 offen sc1
    s_add_u32 s18, s18, 128
    s_add_u32 s20, s20, 128
    s_add_u32 s14, s14, 1
    s_cmp_lt_u32 s14, 62
    s_cbranch_scc1 PF3_UP
    s_waitcnt vmcnt(0)
    s_endpgm
PF0_START:
    v_lshlrev_b32 v2, 7, v1
    v_mov_b32 v3, 0
    s_mov_b32 s14, 0
    s_mov_b32 s19, 0x40000
    s_mov_b32 s15, 16252928
    s_lshl_b32 s27, s13, 13
    v_lshlrev_b32 v12, 4, v1
    v_mov_b32 v16, -1
    v_mov_b32 v17, -1
    v_mov_b32 v18, -1
    v_mov_b32 v19, -1
    s_mov_b32 s18, 112248320
    buffer_load_dword v10, v2, s[8:11], s18 offen
    s_mov_b32 s18, 112240128
    buffer_load_dword v11, v2, s[8:11], s18 offen
    s_mov_b32 s22, 1
    s_lshl_b32 s18, s22, 15
    s_add_u32 s18, s18, s27
    s_add_u32 s18, s18, 13631488
    buffer_load_dword v8, v2, s[8:11], s18 offen
    s_lshl_b32 s18, s22, 13
    s_add_u32 s18, s18, 16252928
    s_mul_i32 s21, s22, 10240
    s_add_u32 s21, s21, s27
    s_add_u32 s21, s21, 16769024
    s_cmp_eq_u32 s13, 0
    s_cselect_b32 s18, s18, s21
    buffer_load_dword v9, v2, s[8:11], s18 offen
    s_mov_b32 s22, 2
    s_lshl_b32 s18, s22, 15
    s_add_u32 s18, s18, s27
    s_add_u32 s18, s18, 13631488
    buffer_load_dword v8, v2, s[8:11], s18 offen
    s_lshl_b32 s18, s22, 13
    s_add_u32 s18, s18, 16252928
    s_mul_i32 s21, s22, 10240
    s_add_u32 s21, s21, s27
    s_add_u32 s21, s21, 16769024
    s_cmp_eq_u32 s13, 0
    s_cselect_b32 s18, s18, s21
    buffer_load_dword v9, v2, s[8:11], s18 offen
PF_LOOP:
PF_POLL:
    buffer_load_dword v4, v3, s[8:11], s15 offen sc1
    s_waitcnt vmcnt(0)
    v_readfirstlane_b32 s31, v4
    s_nop 0
    s_cmp_lg_u32 s31, -1
    s_nop 2
    s_cbranch_scc1 PF_GOT
    s_sleep 4
    s_sub_u32 s19, s19, 1
    s_cbranch_scc0 PF_POLL
    s_mov_b32 s19, 0
PF_GOT:
    s_add_u32 s22, s14, 3
    s_lshl_b32 s18, s22, 15
    s_add_u32 s18, s18, s27
    s_add_u32 s18, s18, 13631488
    buffer_load_dword v8, v2, s[8:11], s18 offen
    s_lshl_b32 s18, s22, 13
    s_add_u32 s18, s18, 16252928
    s_mul_i32 s21, s22, 10240
    s_add_u32 s21, s21, s27
    s_add_u32 s21, s21, 16769024
    s_cmp_eq_u32 s13, 0
    s_cselect_b32 s18, s18, s21
    buffer_load_dword v9, v2, s[8:11], s18 offen
    s_add_u32 s15, s15, 8192
    s_add_u32 s14, s14, 1
    s_cmp_lt_u32 s14, 61
    s_cbranch_scc1 PF_LOOP
    s_waitcnt vmcnt(0)
    s_endpgm
BULK:
    s_sub_u32 s80, s12, 256
    s_mov_b32 s18, s13
    s_mov_b32 s84, 0x100000
    s_cmp_ge_u32 s80, 224
    s_cbranch_scc1 BK_Q
    s_and_b32 s86, s80, 3
    s_mul_i32 s86, s86, 56
    s_lshr_b32 s87, s80, 2
    s_add_u32 s85, s86, s87
    s_mul_hi_u32 s21, s85, 76695845
    s_mul_i32 s22, s21, 56
    s_sub_u32 s20, s85, s22
    v_lshlrev_b32 v2, 4, v1
    s_cmp_ge_u32 s20, 28
    s_cselect_b32 s23, 1, 0
    s_cselect_b32 s24, 28, 0
    s_sub_u32 s20, s20, s24
    s_lshl_b32 s24, s20, 4
    s_lshl_b32 s25, s18, 2
    s_add_u32 s24, s24, s25
    s_mul_i32 s25, s24, 14336
    s_cmp_eq_u32 s23, 0
    s_cselect_b32 s26, 0, 6815744
    s_add_u32 s25, s25, s26
    buffer_load_dwordx4 a[0:3], v2, s[8:11], s25 offen offset:0
    buffer_load_dwordx4 a[4:7], v2, s[8:11], s25 offen offset:1024
    buffer_load_dwordx4 a[8:11], v2, s[8:11], s25 offen offset:2048
    buffer_load_dwordx4 a[12:15], v2, s[8:11], s25 offen offset:3072
    s_add_u32 s25, s25, 4096
    buffer_load_dwordx4 a[16:19], v2, s[8:11], s25 offen offset:0
    buffer_load_dwordx4 a[20:23], v2, s[8:11], s25 offen offset:1024
    buffer_load_dwordx4 a[24:27], v2, s[8:11], s25 offen offset:2048
    buffer_load_dwordx4 a[28:31], v2, s[8:11], s25 offen offset:3072
    s_add_u32 s25, s25, 4096
    buffer_load_dwordx4 a[32:35], v2, s[8:11], s25 offen offset:0
    buffer_load_dwordx4 a[36:39], v2, s[8:11], s25 offen offset:1024
    buffer_load_dwordx4 a[40:43], v2, s[8:11], s25 offen offset:2048
    buffer_load_dwordx4 a[44:47], v2, s[8:11], s25 offen offset:3072
    s_add_u32 s25, s25, 4096
    buffer_load_dwordx4 a[48:51], v2, s[8:11], s25 offen offset:0
    buffer_load_dwordx4 a[52:55], v2, s[8:11], s25 offen offset:1024
    s_add_u32 s25, s25, 2048
    buffer_load_dwordx4 a[56:59], v2, s[8:11], s25 offen offset:0
    buffer_load_dwordx4 a[60:63], v2, s[8:11], s25 offen offset:1024
    buffer_load_dwordx4 a[64:67], v2, s[8:11], s25 offen offset:2048
    buffer_load_dwordx4 a[68:71], v2, s[8:11], s25 offen offset:3072
    s_add_u32 s25, s25, 4096
    buffer_load_dwordx4 a[72:75], v2, s[8:11], s25 offen offset:0
    buffer_load_dwordx4 a[76:79], v2, s[8:11], s25 offen offset:1024
    buffer_load_dwordx4 a[80:83], v2, s[8:11], s25 offen offset:2048
    buffer_load_dwordx4 a[84:87], v2, s[8:11], s25 offen offset:3072
    s_add_u32 s25, s25, 4096
    buffer_load_dwordx4 a[88:91], v2, s[8:11], s25 offen offset:0
    buffer_load_dwordx4 a[92:95], v2, s[8:11], s25 offen offset:1024
    buffer_load_dwordx4 a[96:99], v2, s[8:11], s25 offen offset:2048
    buffer_load_dwordx4 a[100:103], v2, s[8:11], s25 offen offset:3072
    s_add_u32 s25, s25, 4096
    buffer_load_dwordx4 a[104:107], v2, s[8:11], s25 offen offset:0
    buffer_load_dwordx4 a[108:111], v2, s[8:11], s25 offen offset:1024
    s_add_u32 s25, s25, 2048
    buffer_load_dwordx4 a[112:115], v2, s[8:11], s25 offen offset:0
    buffer_load_dwordx4 a[116:119], v2, s[8:11], s25 offen offset:1024
    buffer_load_dwordx4 a[120:123], v2, s[8:11], s25 offen offset:2048
    buffer_load_dwordx4 a[124:127], v2, s[8:11], s25 offen offset:3072
    s_add_u32 s25, s25, 4096
    buffer_load_dwordx4 a[128:131], v2, s[8:11], s25 offen offset:0
    buffer_load_dwordx4 a[132:135], v2, s[8:11], s25 offen offset:1024
    buffer_load_dwordx4 a[136:139], v2, s[8:11], s25 offen offset:2048
    buffer_load_dwordx4 a[140:143], v2, s[8:11], s25 offen offset:3072
    s_add_u32 s25, s25, 4096
    buffer_load_dwordx4 a[144:147], v2, s[8:11], s25 offen offset:0
    buffer_load_dwordx4 a[148:151], v2, s[8:11], s25 offen offset:1024
    buffer_load_dwordx4 a[152:155], v2, s[8:11], s25 offen offset:2048
    buffer_load_dwordx4 a[156:159], v2, s[8:11], s25 offen offset:3072
    s_add_u32 s25, s25, 4096
    buffer_load_dwordx4 a[160:163], v2, s[8:11], s25 offen offset:0
    buffer_load_dwordx4 a[164:167], v2, s[8:11], s25 offen offset:1024
    s_add_u32 s25, s25, 2048
    buffer_load_dwordx4 a[168:171], v2, s[8:11], s25 offen offset:0
    buffer_load_dwordx4 a[172:175], v2, s[8:11], s25 offen offset:1024
    buffer_load_dwordx4 a[176:179], v2, s[8:11], s25 offen offset:2048
    buffer_load_dwordx4 a[180:183], v2, s[8:11], s25 offen offset:3072
    s_add_u32 s25, s25, 4096
    buffer_load_dwordx4 a[184:187], v2, s[8:11], s25 offen offset:0
    buffer_load_dwordx4 a[188:191], v2, s[8:11], s25 offen offset:1024
    buffer_load_dwordx4 a[192:195], v2, s[8:11], s25 offen offset:2048
    buffer_load_dwordx4 a[196:199], v2, s[8:11], s25 offen offset:3072
    s_add_u32 s25, s25, 4096
    buffer_load_dwordx4 a[200:203], v2, s[8:11], s25 offen offset:0
    buffer_load_dwordx4 a[204:207], v2, s[8:11], s25 offen offset:1024
    buffer_load_dwordx4 a[208:211], v2, s[8:11], s25 offen offset:2048
    buffer_load_dwordx4 a[212:215], v2, s[8:11], s25 offen offset:3072
    s_add_u32 s25, s25, 4096
    buffer_load_dwordx4 a[216:219], v2, s[8:11], s25 offen offset:0
    buffer_load_dwordx4 a[220:223], v2, s[8:11], s25 offen offset:1024
    s_add_u32 s25, s25, 2048
    s_mul_hi_u32 s26, s24, 153391690
    s_mul_i32 s27, s26, 28
    s_sub_u32 s27, s24, s27
    s_lshr_b32 s27, s27, 1
    s_mul_i32 s26, s26, 1835008
    s_lshl_b32 s27, s27, 10
    s_add_u32 s26, s26, s27
    s_add_u32 s26, s26, 60817408
    s_lshl_b32 s27, s24, 10
    s_add_u32 s27, s27, 17825792
    s_cmp_eq_u32 s23, 0
    s_cselect_b32 s28, s26, s27
    s_mov_b32 s29, 458752
    s_cselect_b32 s29, 28672, s29
    s_mul_i32 s30, s21, s29
    s_add_u32 s28, s28, s30
    s_mul_i32 s29, s29, 4
    s_mul_i32 s30, s21, 28672
    s_mul_i32 s31, s18, 7168
    s_add_u32 s30, s30, s31
    s_add_u32 s30, s30, 56623104
    s_mov_b32 s32, s31
    s_add_u32 m0, s32, 0
    s_add_u32 s33, s30, 0
    buffer_load_dwordx4 v2, s[8:11], s33 offen offset:0 lds
    buffer_load_dwordx4 v2, s[8:11], s33 offen offset:1024 lds
    buffer_load_dwordx4 v2, s[8:11], s33 offen offset:2048 lds
    buffer_load_dwordx4 v2, s[8:11], s33 offen offset:3072 lds
    s_add_u32 m0, s32, 4096
    s_add_u32 s33, s30, 4096
    buffer_load_dwordx4 v2, s[8:11], s33 offen offset:0 lds
    buffer_load_dwordx4 v2, s[8:11], s33 offen offset:1024 lds
    buffer_load_dwordx4 v2, s[8:11], s33 offen offset:2048 lds
    s_add_u32 s30, s30, 114688
    s_xor_b32 s32, s32, 32768
    v_mov_b32 v3, v2
    s_mov_b32 s34, 0
    s_mov_b32 s35, 112197632
    s_cmp_eq_u32 s23, 0
    s_cselect_b32 s35, 112205824, s35
    s_lshl_b32 s36, s21, 7
    s_add_u32 s35, s35, s36
    v_mov_b32 v4, 0
    v_mov_b32 v5, 1
    s_nop 1
G1_LOOP:
    s_waitcnt vmcnt(0)
    s_barrier
    s_cmp_eq_u32 s34, 0
    s_cbranch_scc1 G1_NOSIG
    s_cmp_lg_u32 s18, 0
    s_cbranch_scc1 G1_NOSIG2
    s_mov_b64 exec, 1
    buffer_atomic_add v5, v4, s[8:11], s35 offen
    s_mov_b64 exec, -1
G1_NOSIG2:
    s_add_u32 s35, s35, 512
G1_NOSIG:
    s_add_u32 m0, s32, 0
    s_add_u32 s33, s30, 0
    buffer_load_dwordx4 v2, s[8:11], s33 offen offset:0 lds
    buffer_load_dwordx4 v2, s[8:11], s33 offen offset:1024 lds
    buffer_load_dwordx4 v2, s[8:11], s33 offen offset:2048 lds
    buffer_load_dwordx4 v2, s[8:11], s33 offen offset:3072 lds
    s_add_u32 m0, s32, 4096
    s_add_u32 s33, s30, 4096
    buffer_load_dwordx4 v2, s[8:11], s33 offen offset:0 lds
    buffer_load_dwordx4 v2, s[8:11], s33 offen offset:1024 lds
    buffer_load_dwordx4 v2, s[8:11], s33 offen offset:2048 lds
    s_add_u32 s30, s30, 114688
    s_xor_b32 s32, s32, 32768
    v_mov_b32 v32, 0
    v_mov_b32 v33, 0
    v_mov_b32 v34, 0
    v_mov_b32 v35, 0
    v_mov_b32 v36, 0
    v_mov_b32 v37, 0
    v_mov_b32 v38, 0
    v_mov_b32 v39, 0
    v_mov_b32 v40, 0
    v_mov_b32 v41, 0
    v_mov_b32 v42, 0
    v_mov_b32 v43, 0
    v_mov_b32 v44, 0
    v_mov_b32 v45, 0
    v_mov_b32 v46, 0
    v_mov_b32 v47, 0
    v_mov_b32 v48, 0
    v_mov_b32 v49, 0
    v_mov_b32 v50, 0
    v_mov_b32 v51, 0
    v_mov_b32 v52, 0
    v_mov_b32 v53, 0
    v_mov_b32 v54, 0
    v_mov_b32 v55, 0
    v_mov_b32 v56, 0
    v_mov_b32 v57, 0
    v_mov_b32 v58, 0
    v_mov_b32 v59, 0
    v_mov_b32 v60, 0
    v_mov_b32 v61, 0
    v_mov_b32 v62, 0
    v_mov_b32 v63, 0
    s_cmp_eq_u32 s23, 0
    s_nop 0
    s_cbranch_scc0 G1_TC
    ds_read_b128 v[8:11], v3 offset:0
    ds_read_b128 v[12:15], v3 offset:14336
    ds_read_b128 v[16:19], v3 offset:1024
    ds_read_b128 v[20:23], v3 offset:15360
    s_waitcnt lgkmcnt(2)
    v_mfma_f32_16x16x32_bf16 v[32:35], a[0:3], v[8:11], v[32:35]
    v_mfma_f32_16x16x32_bf16 v[36:39], a[0:3], v[12:15], v[36:39]
    v_mfma_f32_16x16x32_bf16 v[40:43], a[56:59], v[8:11], v[40:43]
    v_mfma_f32_16x16x32_bf16 v[44:47], a[56:59], v[12:15], v[44:47]
    v_mfma_f32_16x16x32_bf16 v[48:51], a[112:115], v[8:11], v[48:51]
    v_mfma_f32_16x16x32_bf16 v[52:55], a[112:115], v[12:15], v[52:55]
    v_mfma_f32_16x16x32_bf16 v[56:59], a[168:171], v[8:11], v[56:59]
    v_mfma_f32_16x16x32_bf16 v[60:63], a[168:171], v[12:15], v[60:63]
    ds_read_b128 v[8:11], v3 offset:2048
    ds_read_b128 v[12:15], v3 offset:16384
    s_waitcnt lgkmcnt(2)
    v_mfma_f32_16x16x32_bf16 v[32:35], a[4:7], v[16:19], v[32:35]
    v_mfma_f32_16x16x32_bf16 v[36:39], a[4:7], v[20:23], v[36:39]
    v_mfma_f32_16x16x32_bf16 v[40:43], a[60:63], v[16:19], v[40:43]
    v_mfma_f32_16x16x32_bf16 v[44:47], a[60:63], v[20:23], v[44:47]
    v_mfma_f32_16x16x32_bf16 v[48:51], a[116:119], v[16:19], v[48:51]
    v_mfma_f32_16x16x32_bf16 v[52:55], a[116:119], v[20:23], v[52:55]
    v_mfma_f32_16x16x32_bf16 v[56:59], a[172:175], v[16:19], v[56:59]
    v_mfma_f32_16x16x32_bf16 v[60:63], a[172:175], v[20:23], v[60:63]
    ds_read_b128 v[16:19], v3 offset:3072
    ds_read_b128 v[20:23], v3 offset:17408
    s_waitcnt lgkmcnt(2)
    v_mfma_f32_16x16x32_bf16 v[32:35], a[8:11], v[8:11], v[32:35]
    v_mfma_f32_16x16x32_bf16 v[36:39], a[8:11], v[12:15], v[36:39]
    v_mfma_f32_16x16x32_bf16 v[40:43], a[64:67], v[8:11], v[40:43]
    v_mfma_f32_16x16x32_bf16 v[44:47], a[64:67], v[12:15], v[44:47]
    v_mfma_f32_16x16x32_bf16 v[48:51], a[120:123], v[8:11], v[48:51]
    v_mfma_f32_16x16x32_bf16 v[52:55], a[120:123], v[12:15], v[52:55]
    v_mfma_f32_16x16x32_bf16 v[56:59], a[176:179], v[8:11], v[56:59]
    v_mfma_f32_16x16x32_bf16 v[60:63], a[176:179], v[12:15], v[60:63]
    ds_read_b128 v[8:11], v3 offset:4096
    ds_read_b128 v[12:15], v3 offset:18432
    s_waitcnt lgkmcnt(2)
    v_mfma_f32_16x16x32_bf16 v[32:35], a[12:15], v[16:19], v[32:35]
    v_mfma_f32_16x16x32_bf16 v[36:39], a[12:15], v[20:23], v[36:39]
    v_mfma_f32_16x16x32_bf16 v[40:43], a[68:71], v[16:19], v[40:43]
    v_mfma_f32_16x16x32_bf16 v[44:47], a[68:71], v[20:23], v[44:47]
    v_mfma_f32_16x16x32_bf16 v[48:51], a[124:127], v[16:19], v[48:51]
    v_mfma_f32_16x16x32_bf16 v[52:55], a[124:127], v[20:23], v[52:55]
    v_mfma_f32_16x16x32_bf16 v[56:59], a[180:183], v[16:19], v[56:59]
    v_mfma_f32_16x16x32_bf16 v[60:63], a[180:183], v[20:23], v[60:63]
    ds_read_b128 v[16:19], v3 offset:5120
    ds_read_b128 v[20:23], v3 offset:19456
    s_waitcnt lgkmcnt(2)
    v_mfma_f32_16x16x32_bf16 v[32:35], a[16:19], v[8:11], v[32:35]
    v_mfma_f32_16x16x32_bf16 v[36:39], a[16:19], v[12:15], v[36:39]
    v_mfma_f32_16x16x32_bf16 v[40:43], a[72:75], v[8:11], v[40:43]
    v_mfma_f32_16x16x32_bf16 v[44:47], a[72:75], v[12:15], v[44:47]
    v_mfma_f32_16x16x32_bf16 v[48:51], a[128:131], v[8:11], v[48:51]
    v_mfma_f32_16x16x32_bf16 v[52:55], a[128:131], v[12:15], v[52:55]
    v_mfma_f32_16x16x32_bf16 v[56:59], a[184:187], v[8:11], v[56:59]
    v_mfma_f32_16x16x32_bf16 v[60:63], a[184:187], v[12:15], v[60:63]
    ds_read_b128 v[8:11], v3 offset:6144
    ds_read_b128 v[12:15], v3 offset:20480
    s_waitcnt lgkmcnt(2)
    v_mfma_f32_16x16x32_bf16 v[32:35], a[20:23], v[16:19], v[32:35]
    v_mfma_f32_16x16x32_bf16 v[36:39], a[20:23], v[20:23], v[36:39]
    v_mfma_f32_16x16x32_bf16 v[40:43], a[76:79], v[16:19], v[40:43]
    v_mfma_f32_16x16x32_bf16 v[44:47], a[76:79], v[20:23], v[44:47]
    v_mfma_f32_16x16x32_bf16 v[48:51], a[132:135], v[16:19], v[48:51]
    v_mfma_f32_16x16x32_bf16 v[52:55], a[132:135], v[20:23], v[52:55]
    v_mfma_f32_16x16x32_bf16 v[56:59], a[188:191], v[16:19], v[56:59]
    v_mfma_f32_16x16x32_bf16 v[60:63], a[188:191], v[20:23], v[60:63]
    ds_read_b128 v[16:19], v3 offset:7168
    ds_read_b128 v[20:23], v3 offset:21504
    s_waitcnt lgkmcnt(2)
    v_mfma_f32_16x16x32_bf16 v[32:35], a[24:27], v[8:11], v[32:35]
    v_mfma_f32_16x16x32_bf16 v[36:39], a[24:27], v[12:15], v[36:39]
    v_mfma_f32_16x16x32_bf16 v[40:43], a[80:83], v[8:11], v[40:43]
    v_mfma_f32_16x16x32_bf16 v[44:47], a[80:83], v[12:15], v[44:47]
    v_mfma_f32_16x16x32_bf16 v[48:51], a[136:139], v[8:11], v[48:51]
    v_mfma_f32_16x16x32_bf16 v[52:55], a[136:139], v[12:15], v[52:55]
    v_mfma_f32_16x16x32_bf16 v[56:59], a[192:195], v[8:11], v[56:59]
    v_mfma_f32_16x16x32_bf16 v[60:63], a[192:195], v[12:15], v[60:63]
    ds_read_b128 v[8:11], v3 offset:8192
    ds_read_b128 v[12:15], v3 offset:22528
    s_waitcnt lgkmcnt(2)
    v_mfma_f32_16x16x32_bf16 v[32:35], a[28:31], v[16:19], v[32:35]
    v_mfma_f32_16x16x32_bf16 v[36:39], a[28:31], v[20:23], v[36:39]
    v_mfma_f32_16x16x32_bf16 v[40:43], a[84:87], v[16:19], v[40:43]
    v_mfma_f32_16x16x32_bf16 v[44:47], a[84:87], v[20:23], v[44:47]
    v_mfma_f32_16x16x32_bf16 v[48:51], a[140:143], v[16:19], v[48:51]
    v_mfma_f32_16x16x32_bf16 v[52:55], a[140:143], v[20:23], v[52:55]
    v_mfma_f32_16x16x32_bf16 v[56:59], a[196:199], v[16:19], v[56:59]
    v_mfma_f32_16x16x32_bf16 v[60:63], a[196:199], v[20:23], v[60:63]
    ds_read_b128 v[16:19], v3 offset:9216
    ds_read_b128 v[20:23], v3 offset:23552
    s_waitcnt lgkmcnt(2)
    v_mfma_f32_16x16x32_bf16 v[32:35], a[32:35], v[8:11], v[32:35]
    v_mfma_f32_16x16x32_bf16 v[36:39], a[32:35], v[12:15], v[36:39]
    v_mfma_f32_16x16x32_bf16 v[40:43], a[88:91], v[8:11], v[40:43]
    v_mfma_f32_16x16x32_bf16 v[44:47], a[88:91], v[12:15], v[44:47]
    v_mfma_f32_16x16x32_bf16 v[48:51], a[144:147], v[8:11], v[48:51]
    v_mfma_f32_16x16x32_bf16 v[52:55], a[144:147], v[12:15], v[52:55]
    v_mfma_f32_16x16x32_bf16 v[56:59], a[200:203], v[8:11], v[56:59]
    v_mfma_f32_16x16x32_bf16 v[60:63], a[200:203], v[12:15], v[60:63]
    ds_read_b128 v[8:11], v3 offset:10240
    ds_read_b128 v[12:15], v3 offset:24576
    s_waitcnt lgkmcnt(2)
    v_mfma_f32_16x16x32_bf16 v[32:35], a[36:39], v[16:19], v[32:35]
    v_mfma_f32_16x16x32_bf16 v[36:39], a[36:39], v[20:23], v[36:39]
    v_mfma_f32_16x16x32_bf16 v[40:43], a[92:95], v[16:19], v[40:43]
    v_mfma_f32_16x16x32_bf16 v[44:47], a[92:95], v[20:23], v[44:47]
    v_mfma_f32_16x16x32_bf16 v[48:51], a[148:151], v[16:19], v[48:51]
    v_mfma_f32_16x16x32_bf16 v[52:55], a[148:151], v[20:23], v[52:55]
    v_mfma_f32_16x16x32_bf16 v[56:59], a[204:207], v[16:19], v[56:59]
    v_mfma_f32_16x16x32_bf16 v[60:63], a[204:207], v[20:23], v[60:63]
    ds_read_b128 v[16:19], v3 offset:11264
    ds_read_b128 v[20:23], v3 offset:25600
    s_waitcnt lgkmcnt(2)
    v_mfma_f32_16x16x32_bf16 v[32:35], a[40:43], v[8:11], v[32:35]
    v_mfma_f32_16x16x32_bf16 v[36:39], a[40:43], v[12:15], v[36:39]
    v_mfma_f32_16x16x32_bf16 v[40:43], a[96:99], v[8:11], v[40:43]
    v_mfma_f32_16x16x32_bf16 v[44:47], a[96:99], v[12:15], v[44:47]
    v_mfma_f32_16x16x32_bf16 v[48:51], a[152:155], v[8:11], v[48:51]
    v_mfma_f32_16x16x32_bf16 v[52:55], a[152:155], v[12:15], v[52:55]
    v_mfma_f32_16x16x32_bf16 v[56:59], a[208:211], v[8:11], v[56:59]
    v_mfma_f32_16x16x32_bf16 v[60:63], a[208:211], v[12:15], v[60:63]
    ds_read_b128 v[8:11], v3 offset:12288
    ds_read_b128 v[12:15], v3 offset:26624
    s_waitcnt lgkmcnt(2)
    v_mfma_f32_16x16x32_bf16 v[32:35], a[44:47], v[16:19], v[32:35]
    v_mfma_f32_16x16x32_bf16 v[36:39], a[44:47], v[20:23], v[36:39]
    v_mfma_f32_16x16x32_bf16 v[40:43], a[100:103], v[16:19], v[40:43]
    v_mfma_f32_16x16x32_bf16 v[44:47], a[100:103], v[20:23], v[44:47]
    v_mfma_f32_16x16x32_bf16 v[48:51], a[156:159], v[16:19], v[48:51]
    v_mfma_f32_16x16x32_bf16 v[52:55], a[156:159], v[20:23], v[52:55]
    v_mfma_f32_16x16x32_bf16 v[56:59], a[212:215], v[16:19], v[56:59]
    v_mfma_f32_16x16x32_bf16 v[60:63], a[212:215], v[20:23], v[60:63]
    ds_read_b128 v[16:19], v3 offset:13312
    ds_read_b128 v[20:23], v3 offset:27648
    s_waitcnt lgkmcnt(2)
    v_mfma_f32_16x16x32_bf16 v[32:35], a[48:51], v[8:11], v[32:35]
    v_mfma_f32_16x16x32_bf16 v[36:39], a[48:51], v[12:15], v[36:39]
    v_mfma_f32_16x16x32_bf16 v[40:43], a[104:107], v[8:11], v[40:43]
    v_mfma_f32_16x16x32_bf16 v[44:47], a[104:107], v[12:15], v[44:47]
    v_mfma_f32_16x16x32_bf16 v[48:51], a[160:163], v[8:11], v[48:51]
    v_mfma_f32_16x16x32_bf16 v[52:55], a[160:163], v[12:15], v[52:55]
    v_mfma_f32_16x16x32_bf16 v[56:59], a[216:219], v[8:11], v[56:59]
    v_mfma_f32_16x16x32_bf16 v[60:63], a[216:219], v[12:15], v[60:63]
    s_waitcnt lgkmcnt(0)
    v_mfma_f32_16x16x32_bf16 v[32:35], a[52:55], v[16:19], v[32:35]
    v_mfma_f32_16x16x32_bf16 v[36:39], a[52:55], v[20:23], v[36:39]
    v_mfma_f32_16x16x32_bf16 v[40:43], a[108:111], v[16:19], v[40:43]
    v_mfma_f32_16x16x32_bf16 v[44:47], a[108:111], v[20:23], v[44:47]
    v_mfma_f32_16x16x32_bf16 v[48:51], a[164:167], v[16:19], v[48:51]
    v_mfma_f32_16x16x32_bf16 v[52:55], a[164:167], v[20:23], v[52:55]
    v_mfma_f32_16x16x32_bf16 v[56:59], a[220:223], v[16:19], v[56:59]
    v_mfma_f32_16x16x32_bf16 v[60:63], a[220:223], v[20:23], v[60:63]
    s_nop 0
    v_cvt_pk_bf16_f32 v64, v32, v33
    v_cvt_pk_bf16_f32 v65, v34, v35
    v_cvt_pk_bf16_f32 v66, v40, v41
    v_cvt_pk_bf16_f32 v67, v42, v43
    buffer_store_dwordx4 v[64:67], v2, s[8:11], s28 offen offset:0 sc1
    v_cvt_pk_bf16_f32 v68, v48, v49
    v_cvt_pk_bf16_f32 v69, v50, v51
    v_cvt_pk_bf16_f32 v70, v56, v57
    v_cvt_pk_bf16_f32 v71, v58, v59
    buffer_store_dwordx4 v[68:71], v2, s[8:11], s28 offen offset:1024 sc1
    v_cvt_pk_bf16_f32 v72, v36, v37
    v_cvt_pk_bf16_f32 v73, v38, v39
    v_cvt_pk_bf16_f32 v74, v44, v45
    v_cvt_pk_bf16_f32 v75, v46, v47
    s_add_u32 s33, s28, 14336
    buffer_store_dwordx4 v[72:75], v2, s[8:11], s33 offen offset:0 sc1
    v_cvt_pk_bf16_f32 v76, v52, v53
    v_cvt_pk_bf16_f32 v77, v54, v55
    v_cvt_pk_bf16_f32 v78, v60, v61
    v_cvt_pk_bf16_f32 v79, v62, v63
    buffer_store_dwordx4 v[76:79], v2, s[8:11], s33 offen offset:1024 sc1
    s_nop 1
    s_branch G1_TE
G1_TC:
    ds_read_b128 v[8:11], v3 offset:0
    ds_read_b128 v[12:15], v3 offset:14336
    ds_read_b128 v[16:19], v3 offset:1024
    ds_read_b128 v[20:23], v3 offset:15360
    s_waitcnt lgkmcnt(2)
    v_mfma_f32_16x16x32_bf16 v[32:35], v[8:11], a[0:3], v[32:35]
    v_mfma_f32_16x16x32_bf16 v[36:39], v[12:15], a[0:3], v[36:39]
    v_mfma_f32_16x16x32_bf16 v[40:43], v[8:11], a[56:59], v[40:43]
    v_mfma_f32_16x16x32_bf16 v[44:47], v[12:15], a[56:59], v[44:47]
    v_mfma_f32_16x16x32_bf16 v[48:51], v[8:11], a[112:115], v[48:51]
    v_mfma_f32_16x16x32_bf16 v[52:55], v[12:15], a[112:115], v[52:55]
    v_mfma_f32_16x16x32_bf16 v[56:59], v[8:11], a[168:171], v[56:59]
    v_mfma_f32_16x16x32_bf16 v[60:63], v[12:15], a[168:171], v[60:63]
    ds_read_b128 v[8:11], v3 offset:2048
    ds_read_b128 v[12:15], v3 offset:16384
    s_waitcnt lgkmcnt(2)
    v_mfma_f32_16x16x32_bf16 v[32:35], v[16:19], a[4:7], v[32:35]
    v_mfma_f32_16x16x32_bf16 v[36:39], v[20:23], a[4:7], v[36:39]
    v_mfma_f32_16x16x32_bf16 v[40:43], v[16:19], a[60:63], v[40:43]
    v_mfma_f32_16x16x32_bf16 v[44:47], v[20:23], a[60:63], v[44:47]
    v_mfma_f32_16x16x32_bf16 v[48:51], v[16:19], a[116:119], v[48:51]
    v_mfma_f32_16x16x32_bf16 v[52:55], v[20:23], a[116:119], v[52:55]
    v_mfma_f32_16x16x32_bf16 v[56:59], v[16:19], a[172:175], v[56:59]
    v_mfma_f32_16x16x32_bf16 v[60:63], v[20:23], a[172:175], v[60:63]
    ds_read_b128 v[16:19], v3 offset:3072
    ds_read_b128 v[20:23], v3 offset:17408
    s_waitcnt lgkmcnt(2)
    v_mfma_f32_16x16x32_bf16 v[32:35], v[8:11], a[8:11], v[32:35]
    v_mfma_f32_16x16x32_bf16 v[36:39], v[12:15], a[8:11], v[36:39]
    v_mfma_f32_16x16x32_bf16 v[40:43], v[8:11], a[64:67], v[40:43]
    v_mfma_f32_16x16x32_bf16 v[44:47], v[12:15], a[64:67], v[44:47]
    v_mfma_f32_16x16x32_bf16 v[48:51], v[8:11], a[120:123], v[48:51]
    v_mfma_f32_16x16x32_bf16 v[52:55], v[12:15], a[120:123], v[52:55]
    v_mfma_f32_16x16x32_bf16 v[56:59], v[8:11], a[176:179], v[56:59]
    v_mfma_f32_16x16x32_bf16 v[60:63], v[12:15], a[176:179], v[60:63]
    ds_read_b128 v[8:11], v3 offset:4096
    ds_read_b128 v[12:15], v3 offset:18432
    s_waitcnt lgkmcnt(2)
    v_mfma_f32_16x16x32_bf16 v[32:35], v[16:19], a[12:15], v[32:35]
    v_mfma_f32_16x16x32_bf16 v[36:39], v[20:23], a[12:15], v[36:39]
    v_mfma_f32_16x16x32_bf16 v[40:43], v[16:19], a[68:71], v[40:43]
    v_mfma_f32_16x16x32_bf16 v[44:47], v[20:23], a[68:71], v[44:47]
    v_mfma_f32_16x16x32_bf16 v[48:51], v[16:19], a[124:127], v[48:51]
    v_mfma_f32_16x16x32_bf16 v[52:55], v[20:23], a[124:127], v[52:55]
    v_mfma_f32_16x16x32_bf16 v[56:59], v[16:19], a[180:183], v[56:59]
    v_mfma_f32_16x16x32_bf16 v[60:63], v[20:23], a[180:183], v[60:63]
    ds_read_b128 v[16:19], v3 offset:5120
    ds_read_b128 v[20:23], v3 offset:19456
    s_waitcnt lgkmcnt(2)
    v_mfma_f32_16x16x32_bf16 v[32:35], v[8:11], a[16:19], v[32:35]
    v_mfma_f32_16x16x32_bf16 v[36:39], v[12:15], a[16:19], v[36:39]
    v_mfma_f32_16x16x32_bf16 v[40:43], v[8:11], a[72:75], v[40:43]
    v_mfma_f32_16x16x32_bf16 v[44:47], v[12:15], a[72:75], v[44:47]
    v_mfma_f32_16x16x32_bf16 v[48:51], v[8:11], a[128:131], v[48:51]
    v_mfma_f32_16x16x32_bf16 v[52:55], v[12:15], a[128:131], v[52:55]
    v_mfma_f32_16x16x32_bf16 v[56:59], v[8:11], a[184:187], v[56:59]
    v_mfma_f32_16x16x32_bf16 v[60:63], v[12:15], a[184:187], v[60:63]
    ds_read_b128 v[8:11], v3 offset:6144
    ds_read_b128 v[12:15], v3 offset:20480
    s_waitcnt lgkmcnt(2)
    v_mfma_f32_16x16x32_bf16 v[32:35], v[16:19], a[20:23], v[32:35]
    v_mfma_f32_16x16x32_bf16 v[36:39], v[20:23], a[20:23], v[36:39]
    v_mfma_f32_16x16x32_bf16 v[40:43], v[16:19], a[76:79], v[40:43]
    v_mfma_f32_16x16x32_bf16 v[44:47], v[20:23], a[76:79], v[44:47]
    v_mfma_f32_16x16x32_bf16 v[48:51], v[16:19], a[132:135], v[48:51]
    v_mfma_f32_16x16x32_bf16 v[52:55], v[20:23], a[132:135], v[52:55]
    v_mfma_f32_16x16x32_bf16 v[56:59], v[16:19], a[188:191], v[56:59]
    v_mfma_f32_16x16x32_bf16 v[60:63], v[20:23], a[188:191], v[60:63]
    ds_read_b128 v[16:19], v3 offset:7168
    ds_read_b128 v[20:23], v3 offset:21504
    s_waitcnt lgkmcnt(2)
    v_mfma_f32_16x16x32_bf16 v[32:35], v[8:11], a[24:27], v[32:35]
    v_mfma_f32_16x16x32_bf16 v[36:39], v[12:15], a[24:27], v[36:39]
    v_mfma_f32_16x16x32_bf16 v[40:43], v[8:11], a[80:83], v[40:43]
    v_mfma_f32_16x16x32_bf16 v[44:47], v[12:15], a[80:83], v[44:47]
    v_mfma_f32_16x16x32_bf16 v[48:51], v[8:11], a[136:139], v[48:51]
    v_mfma_f32_16x16x32_bf16 v[52:55], v[12:15], a[136:139], v[52:55]
    v_mfma_f32_16x16x32_bf16 v[56:59], v[8:11], a[192:195], v[56:59]
    v_mfma_f32_16x16x32_bf16 v[60:63], v[12:15], a[192:195], v[60:63]
    ds_read_b128 v[8:11], v3 offset:8192
    ds_read_b128 v[12:15], v3 offset:22528
    s_waitcnt lgkmcnt(2)
    v_mfma_f32_16x16x32_bf16 v[32:35], v[16:19], a[28:31], v[32:35]
    v_mfma_f32_16x16x32_bf16 v[36:39], v[20:23], a[28:31], v[36:39]
    v_mfma_f32_16x16x32_bf16 v[40:43], v[16:19], a[84:87], v[40:43]
    v_mfma_f32_16x16x32_bf16 v[44:47], v[20:23], a[84:87], v[44:47]
    v_mfma_f32_16x16x32_bf16 v[48:51], v[16:19], a[140:143], v[48:51]
    v_mfma_f32_16x16x32_bf16 v[52:55], v[20:23], a[140:143], v[52:55]
    v_mfma_f32_16x16x32_bf16 v[56:59], v[16:19], a[196:199], v[56:59]
    v_mfma_f32_16x16x32_bf16 v[60:63], v[20:23], a[196:199], v[60:63]
    ds_read_b128 v[16:19], v3 offset:9216
    ds_read_b128 v[20:23], v3 offset:23552
    s_waitcnt lgkmcnt(2)
    v_mfma_f32_16x16x32_bf16 v[32:35], v[8:11], a[32:35], v[32:35]
    v_mfma_f32_16x16x32_bf16 v[36:39], v[12:15], a[32:35], v[36:39]
    v_mfma_f32_16x16x32_bf16 v[40:43], v[8:11], a[88:91], v[40:43]
    v_mfma_f32_16x16x32_bf16 v[44:47], v[12:15], a[88:91], v[44:47]
    v_mfma_f32_16x16x32_bf16 v[48:51], v[8:11], a[144:147], v[48:51]
    v_mfma_f32_16x16x32_bf16 v[52:55], v[12:15], a[144:147], v[52:55]
    v_mfma_f32_16x16x32_bf16 v[56:59], v[8:11], a[200:203], v[56:59]
    v_mfma_f32_16x16x32_bf16 v[60:63], v[12:15], a[200:203], v[60:63]
    ds_read_b128 v[8:11], v3 offset:10240
    ds_read_b128 v[12:15], v3 offset:24576
    s_waitcnt lgkmcnt(2)
    v_mfma_f32_16x16x32_bf16 v[32:35], v[16:19], a[36:39], v[32:35]
    v_mfma_f32_16x16x32_bf16 v[36:39], v[20:23], a[36:39], v[36:39]
    v_mfma_f32_16x16x32_bf16 v[40:43], v[16:19], a[92:95], v[40:43]
    v_mfma_f32_16x16x32_bf16 v[44:47], v[20:23], a[92:95], v[44:47]
    v_mfma_f32_16x16x32_bf16 v[48:51], v[16:19], a[148:151], v[48:51]
    v_mfma_f32_16x16x32_bf16 v[52:55], v[20:23], a[148:151], v[52:55]
    v_mfma_f32_16x16x32_bf16 v[56:59], v[16:19], a[204:207], v[56:59]
    v_mfma_f32_16x16x32_bf16 v[60:63], v[20:23], a[204:207], v[60:63]
    ds_read_b128 v[16:19], v3 offset:11264
    ds_read_b128 v[20:23], v3 offset:25600
    s_waitcnt lgkmcnt(2)
    v_mfma_f32_16x16x32_bf16 v[32:35], v[8:11], a[40:43], v[32:35]
    v_mfma_f32_16x16x32_bf16 v[36:39], v[12:15], a[40:43], v[36:39]
    v_mfma_f32_16x16x32_bf16 v[40:43], v[8:11], a[96:99], v[40:43]
    v_mfma_f32_16x16x32_bf16 v[44:47], v[12:15], a[96:99], v[44:47]
    v_mfma_f32_16x16x32_bf16 v[48:51], v[8:11], a[152:155], v[48:51]
    v_mfma_f32_16x16x32_bf16 v[52:55], v[12:15], a[152:155], v[52:55]
    v_mfma_f32_16x16x32_bf16 v[56:59], v[8:11], a[208:211], v[56:59]
    v_mfma_f32_16x16x32_bf16 v[60:63], v[12:15], a[208:211], v[60:63]
    ds_read_b128 v[8:11], v3 offset:12288
    ds_read_b128 v[12:15], v3 offset:26624
    s_waitcnt lgkmcnt(2)
    v_mfma_f32_16x16x32_bf16 v[32:35], v[16:19], a[44:47], v[32:35]
    v_mfma_f32_16x16x32_bf16 v[36:39], v[20:23], a[44:47], v[36:39]
    v_mfma_f32_16x16x32_bf16 v[40:43], v[16:19], a[100:103], v[40:43]
    v_mfma_f32_16x16x32_bf16 v[44:47], v[20:23], a[100:103], v[44:47]
    v_mfma_f32_16x16x32_bf16 v[48:51], v[16:19], a[156:159], v[48:51]
    v_mfma_f32_16x16x32_bf16 v[52:55], v[20:23], a[156:159], v[52:55]
    v_mfma_f32_16x16x32_bf16 v[56:59], v[16:19], a[212:215], v[56:59]
    v_mfma_f32_16x16x32_bf16 v[60:63], v[20:23], a[212:215], v[60:63]
    ds_read_b128 v[16:19], v3 offset:13312
    ds_read_b128 v[20:23], v3 offset:27648
    s_waitcnt lgkmcnt(2)
    v_mfma_f32_16x16x32_bf16 v[32:35], v[8:11], a[48:51], v[32:35]
    v_mfma_f32_16x16x32_bf16 v[36:39], v[12:15], a[48:51], v[36:39]
    v_mfma_f32_16x16x32_bf16 v[40:43], v[8:11], a[104:107], v[40:43]
    v_mfma_f32_16x16x32_bf16 v[44:47], v[12:15], a[104:107], v[44:47]
    v_mfma_f32_16x16x32_bf16 v[48:51], v[8:11], a[160:163], v[48:51]
    v_mfma_f32_16x16x32_bf16 v[52:55], v[12:15], a[160:163], v[52:55]
    v_mfma_f32_16x16x32_bf16 v[56:59], v[8:11], a[216:219], v[56:59]
    v_mfma_f32_16x16x32_bf16 v[60:63], v[12:15], a[216:219], v[60:63]
    s_waitcnt lgkmcnt(0)
    v_mfma_f32_16x16x32_bf16 v[32:35], v[16:19], a[52:55], v[32:35]
    v_mfma_f32_16x16x32_bf16 v[36:39], v[20:23], a[52:55], v[36:39]
    v_mfma_f32_16x16x32_bf16 v[40:43], v[16:19], a[108:111], v[40:43]
    v_mfma_f32_16x16x32_bf16 v[44:47], v[20:23], a[108:111], v[44:47]
    v_mfma_f32_16x16x32_bf16 v[48:51], v[16:19], a[164:167], v[48:51]
    v_mfma_f32_16x16x32_bf16 v[52:55], v[20:23], a[164:167], v[52:55]
    v_mfma_f32_16x16x32_bf16 v[56:59], v[16:19], a[220:223], v[56:59]
    v_mfma_f32_16x16x32_bf16 v[60:63], v[20:23], a[220:223], v[60:63]
    s_nop 0
    v_cvt_pk_bf16_f32 v64, v32, v33
    v_cvt_pk_bf16_f32 v65, v34, v35
    v_cvt_pk_bf16_f32 v66, v36, v37
    v_cvt_pk_bf16_f32 v67, v38, v39
    buffer_store_dwordx4 v[64:67], v2, s[8:11], s28 offen offset:0 sc1
    v_cvt_pk_bf16_f32 v68, v40, v41
    v_cvt_pk_bf16_f32 v69, v42, v43
    v_cvt_pk_bf16_f32 v70, v44, v45
    v_cvt_pk_bf16_f32 v71, v46, v47
    buffer_store_dwordx4 v[68:71], v2, s[8:11], s28 offen offset:1024 sc1
    v_cvt_pk_bf16_f32 v72, v48, v49
    v_cvt_pk_bf16_f32 v73, v50, v51
    v_cvt_pk_bf16_f32 v74, v52, v53
    v_cvt_pk_bf16_f32 v75, v54, v55
    buffer_store_dwordx4 v[72:75], v2, s[8:11], s28 offen offset:2048 sc1
    v_cvt_pk_bf16_f32 v76, v56, v57
    v_cvt_pk_bf16_f32 v77, v58, v59
    v_cvt_pk_bf16_f32 v78, v60, v61
    v_cvt_pk_bf16_f32 v79, v62, v63
    buffer_store_dwordx4 v[76:79], v2, s[8:11], s28 offen offset:3072 sc1
    s_nop 1
G1_TE:
    v_xor_b32 v3, 32768, v3
    s_add_u32 s28, s28, s29
    s_add_u32 s34, s34, 1
    s_cmp_lt_u32 s34, 16
    s_cbranch_scc1 G1_LOOP
    s_waitcnt vmcnt(0)
    s_barrier
    s_cmp_lg_u32 s18, 0
    s_cbranch_scc1 G1_NOSIG3
    s_mov_b64 exec, 1
    buffer_atomic_add v5, v4, s[8:11], s35 offen
    s_mov_b64 exec, -1
G1_NOSIG3:
    s_nop 0
BK_Q:
BK_NEXT:
    v_mov_b32 v251, 0
    v_mov_b32 v252, 1
    v_mov_b32 v253, 163832
    s_barrier
    s_cmp_lg_u32 s18, 0
    s_cbranch_scc1 BK_TW
    s_mov_b32 s86, 112238592
    s_mov_b64 exec, 1
    buffer_atomic_add v252, v251, s[8:11], s86 offen sc0
    s_waitcnt vmcnt(0)
    ds_write_b32 v253, v252
    s_waitcnt lgkmcnt(0)
    s_mov_b64 exec, -1
BK_TW:
    s_barrier
    ds_read_b32 v250, v253
    s_waitcnt lgkmcnt(0)
    v_readfirstlane_b32 s81, v250
    s_nop 0
    s_cmp_ge_u32 s81, 1048
    s_nop 2
    s_cbranch_scc1 BK_END
    s_cmp_lt_u32 s81, 88
    s_cbranch_scc1 BK_PRE
    s_sub_u32 s81, s81, 88
    s_mul_hi_u32 s82, s81, 143165577
    s_mul_i32 s86, s82, 30
    s_sub_u32 s83, s81, s86
    s_cmp_lt_u32 s83, 8
    s_cbranch_scc1 BK_ATT
    s_cmp_lt_u32 s83, 22
    s_cbranch_scc1 BK_F1
    s_lshl_b32 s85, s82, 3
    s_add_u32 s85, s85, s83
    s_sub_u32 s85, s85, 22
    s_lshr_b32 s20, s85, 2
    s_and_b32 s21, s85, 3
    v_lshlrev_b32 v2, 4, v1
    s_mul_i32 s22, s21, 401408
    s_mul_i32 s23, s18, 14336
    s_add_u32 s22, s22, s23
    s_add_u32 s22, s22, 99614720
    s_mul_i32 s24, s20, 114688
    s_add_u32 s24, s24, s23
    s_add_u32 s24, s24, 101711872
    s_add_u32 s25, s24, 57344
    s_mov_b32 s87, 112256768
    s_cmp_lg_u32 s18, 0
    s_cbranch_scc1 F2I_W
    v_mov_b32 v117, 0
    s_nop 1
F2I_P:
    buffer_load_dword v116, v117, s[8:11], s87 offen sc1
    s_waitcnt vmcnt(0)
    v_readfirstlane_b32 s86, v116
    s_nop 0
    s_cmp_ge_u32 s86, 28
    s_nop 2
    s_cbranch_scc1 F2I_W
    s_sleep 4
    s_sub_u32 s84, s84, 1
    s_cbranch_scc0 F2I_P
    s_mov_b32 s84, 0
F2I_W:
    s_barrier
    s_add_u32 s26, s22, 0
    buffer_load_dwordx4 a[0:3], v2, s[8:11], s26 offen offset:0 sc1
    buffer_load_dwordx4 a[4:7], v2, s[8:11], s26 offen offset:1024 sc1
    buffer_load_dwordx4 a[8:11], v2, s[8:11], s26 offen offset:2048 sc1
    buffer_load_dwordx4 a[12:15], v2, s[8:11], s26 offen offset:3072 sc1
    s_add_u32 s26, s26, 4096
    buffer_load_dwordx4 a[16:19], v2, s[8:11], s26 offen offset:0 sc1
    buffer_load_dwordx4 a[20:23], v2, s[8:11], s26 offen offset:1024 sc1
    buffer_load_dwordx4 a[24:27], v2, s[8:11], s26 offen offset:2048 sc1
    buffer_load_dwordx4 a[28:31], v2, s[8:11], s26 offen offset:3072 sc1
    s_add_u32 s26, s26, 4096
    buffer_load_dwordx4 a[32:35], v2, s[8:11], s26 offen offset:0 sc1
    buffer_load_dwordx4 a[36:39], v2, s[8:11], s26 offen offset:1024 sc1
    buffer_load_dwordx4 a[40:43], v2, s[8:11], s26 offen offset:2048 sc1
    buffer_load_dwordx4 a[44:47], v2, s[8:11], s26 offen offset:3072 sc1
    s_add_u32 s26, s26, 4096
    buffer_load_dwordx4 a[48:51], v2, s[8:11], s26 offen offset:0 sc1
    buffer_load_dwordx4 a[52:55], v2, s[8:11], s26 offen offset:1024 sc1
    s_add_u32 s26, s22, 57344
    buffer_load_dwordx4 a[56:59], v2, s[8:11], s26 offen offset:0 sc1
    buffer_load_dwordx4 a[60:63], v2, s[8:11], s26 offen offset:1024 sc1
    buffer_load_dwordx4 a[64:67], v2, s[8:11], s26 offen offset:2048 sc1
    buffer_load_dwordx4 a[68:71], v2, s[8:11], s26 offen offset:3072 sc1
    s_add_u32 s26, s26, 4096
    buffer_load_dwordx4 a[72:75], v2, s[8:11], s26 offen offset:0 sc1
    buffer_load_dwordx4 a[76:79], v2, s[8:11], s26 offen offset:1024 sc1
    buffer_load_dwordx4 a[80:83], v2, s[8:11], s26 offen offset:2048 sc1
    buffer_load_dwordx4 a[84:87], v2, s[8:11], s26 offen offset:3072 sc1
    s_add_u32 s26, s26, 4096
    buffer_load_dwordx4 a[88:91], v2, s[8:11], s26 offen offset:0 sc1
    buffer_load_dwordx4 a[92:95], v2, s[8:11], s26 offen offset:1024 sc1
    buffer_load_dwordx4 a[96:99], v2, s[8:11], s26 offen offset:2048 sc1
    buffer_load_dwordx4 a[100:103], v2, s[8:11], s26 offen offset:3072 sc1
    s_add_u32 s26, s26, 4096
    buffer_load_dwordx4 a[104:107], v2, s[8:11], s26 offen offset:0 sc1
    buffer_load_dwordx4 a[108:111], v2, s[8:11], s26 offen offset:1024 sc1
    s_add_u32 s26, s22, 114688
    buffer_load_dwordx4 a[112:115], v2, s[8:11], s26 offen offset:0 sc1
    buffer_load_dwordx4 a[116:119], v2, s[8:11], s26 offen offset:1024 sc1
    buffer_load_dwordx4 a[120:123], v2, s[8:11], s26 offen offset:2048 sc1
    buffer_load_dwordx4 a[124:127], v2, s[8:11], s26 offen offset:3072 sc1
    s_add_u32 s26, s26, 4096
    buffer_load_dwordx4 a[128:131], v2, s[8:11], s26 offen offset:0 sc1
    buffer_load_dwordx4 a[132:135], v2, s[8:11], s26 offen offset:1024 sc1
    buffer_load_dwordx4 a[136:139], v2, s[8:11], s26 offen offset:2048 sc1
    buffer_load_dwordx4 a[140:143], v2, s[8:11], s26 offen offset:3072 sc1
    s_add_u32 s26, s26, 4096
    buffer_load_dwordx4 a[144:147], v2, s[8:11], s26 offen offset:0 sc1
    buffer_load_dwordx4 a[148:151], v2, s[8:11], s26 offen offset:1024 sc1
    buffer_load_dwordx4 a[152:155], v2, s[8:11], s26 offen offset:2048 sc1
    buffer_load_dwordx4 a[156:159], v2, s[8:11], s26 offen offset:3072 sc1
    s_add_u32 s26, s26, 4096
    buffer_load_dwordx4 a[160:163], v2, s[8:11], s26 offen offset:0 sc1
    buffer_load_dwordx4 a[164:167], v2, s[8:11], s26 offen offset:1024 sc1
    s_add_u32 s26, s22, 172032
    buffer_load_dwordx4 a[168:171], v2, s[8:11], s26 offen offset:0 sc1
    buffer_load_dwordx4 a[172:175], v2, s[8:11], s26 offen offset:1024 sc1
    buffer_load_dwordx4 a[176:179], v2, s[8:11], s26 offen offset:2048 sc1
    buffer_load_dwordx4 a[180:183], v2, s[8:11], s26 offen offset:3072 sc1
    s_add_u32 s26, s26, 4096
    buffer_load_dwordx4 a[184:187], v2, s[8:11], s26 offen offset:0 sc1
    buffer_load_dwordx4 a[188:191], v2, s[8:11], s26 offen offset:1024 sc1
    buffer_load_dwordx4 a[192:195], v2, s[8:11], s26 offen offset:2048 sc1
    buffer_load_dwordx4 a[196:199], v2, s[8:11], s26 offen offset:3072 sc1
    s_add_u32 s26, s26, 4096
    buffer_load_dwordx4 a[200:203], v2, s[8:11], s26 offen offset:0 sc1
    buffer_load_dwordx4 a[204:207], v2, s[8:11], s26 offen offset:1024 sc1
    buffer_load_dwordx4 a[208:211], v2, s[8:11], s26 offen offset:2048 sc1
    buffer_load_dwordx4 a[212:215], v2, s[8:11], s26 offen offset:3072 sc1
    s_add_u32 s26, s26, 4096
    buffer_load_dwordx4 a[216:219], v2, s[8:11], s26 offen offset:0 sc1
    buffer_load_dwordx4 a[220:223], v2, s[8:11], s26 offen offset:1024 sc1
    s_add_u32 s26, s22, 229376
    buffer_load_dwordx4 a[224:227], v2, s[8:11], s26 offen offset:0 sc1
    buffer_load_dwordx4 a[228:231], v2, s[8:11], s26 offen offset:1024 sc1
    buffer_load_dwordx4 a[232:235], v2, s[8:11], s26 offen offset:2048 sc1
    buffer_load_dwordx4 a[236:239], v2, s[8:11], s26 offen offset:3072 sc1
    s_add_u32 s26, s26, 4096
    buffer_load_dwordx4 a[240:243], v2, s[8:11], s26 offen offset:0 sc1
    buffer_load_dwordx4 a[244:247], v2, s[8:11], s26 offen offset:1024 sc1
    buffer_load_dwordx4 a[248:251], v2, s[8:11], s26 offen offset:2048 sc1
    buffer_load_dwordx4 a[252:255], v2, s[8:11], s26 offen offset:3072 sc1
    s_add_u32 s26, s26, 4096
    buffer_load_dwordx4 v[120:123], v2, s[8:11], s26 offen offset:0 sc1
    buffer_load_dwordx4 v[124:127], v2, s[8:11], s26 offen offset:1024 sc1
    buffer_load_dwordx4 v[128:131], v2, s[8:11], s26 offen offset:2048 sc1
    buffer_load_dwordx4 v[132:135], v2, s[8:11], s26 offen offset:3072 sc1
    s_add_u32 s26, s26, 4096
    buffer_load_dwordx4 v[136:139], v2, s[8:11], s26 offen offset:0 sc1
    buffer_load_dwordx4 v[140:143], v2, s[8:11], s26 offen offset:1024 sc1
    s_add_u32 s26, s22, 286720
    buffer_load_dwordx4 v[144:147], v2, s[8:11], s26 offen offset:0 sc1
    buffer_load_dwordx4 v[148:151], v2, s[8:11], s26 offen offset:1024 sc1
    buffer_load_dwordx4 v[152:155], v2, s[8:11], s26 offen offset:2048 sc1
    buffer_load_dwordx4 v[156:159], v2, s[8:11], s26 offen offset:3072 sc1
    s_add_u32 s26, s26, 4096
    buffer_load_dwordx4 v[160:163], v2, s[8:11], s26 offen offset:0 sc1
    buffer_load_dwordx4 v[164:167], v2, s[8:11], s26 offen offset:1024 sc1
    buffer_load_dwordx4 v[168:171], v2, s[8:11], s26 offen offset:2048 sc1
    buffer_load_dwordx4 v[172:175], v2, s[8:11], s26 offen offset:3072 sc1
    s_add_u32 s26, s26, 4096
    buffer_load_dwordx4 v[176:179], v2, s[8:11], s26 offen offset:0 sc1
    buffer_load_dwordx4 v[180:183], v2, s[8:11], s26 offen offset:1024 sc1
    buffer_load_dwordx4 v[184:187], v2, s[8:11], s26 offen offset:2048 sc1
    buffer_load_dwordx4 v[188:191], v2, s[8:11], s26 offen offset:3072 sc1
    s_add_u32 s26, s26, 4096
    buffer_load_dwordx4 v[192:195], v2, s[8:11], s26 offen offset:0 sc1
    buffer_load_dwordx4 v[196:199], v2, s[8:11], s26 offen offset:1024 sc1
    s_add_u32 s26, s22, 344064
    buffer_load_dwordx4 v[200:203], v2, s[8:11], s26 offen offset:0 sc1
    buffer_load_dwordx4 v[204:207], v2, s[8:11], s26 offen offset:1024 sc1
    buffer_load_dwordx4 v[208:211], v2, s[8:11], s26 offen offset:2048 sc1
    buffer_load_dwordx4 v[212:215], v2, s[8:11], s26 offen offset:3072 sc1
    s_add_u32 s26, s26, 4096
    buffer_load_dwordx4 v[216:219], v2, s[8:11], s26 offen offset:0 sc1
    buffer_load_dwordx4 v[220:223], v2, s[8:11], s26 offen offset:1024 sc1
    buffer_load_dwordx4 v[224:227], v2, s[8:11], s26 offen offset:2048 sc1
    buffer_load_dwordx4 v[228:231], v2, s[8:11], s26 offen offset:3072 sc1
    s_add_u32 s26, s26, 4096
    buffer_load_dwordx4 v[232:235], v2, s[8:11], s26 offen offset:0 sc1
    buffer_load_dwordx4 v[236:239], v2, s[8:11], s26 offen offset:1024 sc1
    buffer_load_dwordx4 v[240:243], v2, s[8:11], s26 offen offset:2048 sc1
    buffer_load_dwordx4 v[244:247], v2, s[8:11], s26 offen offset:3072 sc1
    s_add_u32 s26, s26, 4096
    buffer_load_dwordx4 v[248:251], v2, s[8:11], s26 offen offset:0 sc1
    buffer_load_dwordx4 v[252:255], v2, s[8:11], s26 offen offset:1024 sc1
    v_mov_b32 v8, 0
    v_mov_b32 v9, 0
    v_mov_b32 v10, 0
    v_mov_b32 v11, 0
    v_mov_b32 v12, 0
    v_mov_b32 v13, 0
    v_mov_b32 v14, 0
    v_mov_b32 v15, 0
    v_mov_b32 v16, 0
    v_mov_b32 v17, 0
    v_mov_b32 v18, 0
    v_mov_b32 v19, 0
    v_mov_b32 v20, 0
    v_mov_b32 v21, 0
    v_mov_b32 v22, 0
    v_mov_b32 v23, 0
    v_mov_b32 v24, 0
    v_mov_b32 v25, 0
    v_mov_b32 v26, 0
    v_mov_b32 v27, 0
    v_mov_b32 v28, 0
    v_mov_b32 v29, 0
    v_mov_b32 v30, 0
    v_mov_b32 v31, 0
    v_mov_b32 v32, 0
    v_mov_b32 v33, 0
    v_mov_b32 v34, 0
    v_mov_b32 v35, 0
    v_mov_b32 v36, 0
    v_mov_b32 v37, 0
    v_mov_b32 v38, 0
    v_mov_b32 v39, 0
    v_mov_b32 v40, 0
    v_mov_b32 v41, 0
    v_mov_b32 v42, 0
    v_mov_b32 v43, 0
    v_mov_b32 v44, 0
    v_mov_b32 v45, 0
    v_mov_b32 v46, 0
    v_mov_b32 v47, 0
    v_mov_b32 v48, 0
    v_mov_b32 v49, 0
    v_mov_b32 v50, 0
    v_mov_b32 v51, 0
    v_mov_b32 v52, 0
    v_mov_b32 v53, 0
    v_mov_b32 v54, 0
    v_mov_b32 v55, 0
    v_mov_b32 v56, 0
    v_mov_b32 v57, 0
    v_mov_b32 v58, 0
    v_mov_b32 v59, 0
    v_mov_b32 v60, 0
    v_mov_b32 v61, 0
    v_mov_b32 v62, 0
    v_mov_b32 v63, 0
    s_load_dwordx2 s[16:17], s[0:1], 88
    s_load_dwordx2 s[28:29], s[0:1], 96
    s_load_dwordx2 s[30:31], s[0:1], 0
    s_waitcnt lgkmcnt(0)
    s_mov_b32 s12, s16
    s_and_b32 s13, s17, 0xffff
    s_mov_b32 s14, 896
    s_mov_b32 s15, 0x00020000
    s_mov_b32 s36, s28
    s_and_b32 s37, s29, 0xffff
    s_mov_b32 s38, 1835008
    s_mov_b32 s39, 0x00020000
    s_mov_b32 s44, s30
    s_and_b32 s45, s31, 0xffff
    s_mov_b32 s46, 1835008
    s_mov_b32 s47, 0x00020000
    s_lshl_b32 s87, s20, 7
    s_add_u32 s87, s87, 112230400
    s_waitcnt vmcnt(0)
    s_cmp_lg_u32 s18, 0
    s_cbranch_scc1 F2W_W
    v_mov_b32 v117, 0
    s_nop 1
F2W_P:
    buffer_load_dword v116, v117, s[8:11], s87 offen sc1
    s_waitcnt vmcnt(0)
    v_readfirstlane_b32 s86, v116
    s_nop 0
    s_cmp_ge_u32 s86, 7
    s_nop 2
    s_cbranch_scc1 F2W_W
    s_sleep 1
    s_sub_u32 s84, s84, 1
    s_cbranch_scc0 F2W_P
    s_mov_b32 s84, 0
F2W_W:
    s_barrier
    s_add_u32 s26, s24, 0
    buffer_load_dwordx4 v[64:67], v2, s[8:11], s26 offen sc1
    s_add_u32 s26, s25, 0
    buffer_load_dwordx4 v[68:71], v2, s[8:11], s26 offen sc1
    s_add_u32 s26, s24, 1024
    buffer_load_dwordx4 v[72:75], v2, s[8:11], s26 offen sc1
    s_add_u32 s26, s25, 1024
    buffer_load_dwordx4 v[76:79], v2, s[8:11], s26 offen sc1
    s_add_u32 s26, s24, 2048
    buffer_load_dwordx4 v[80:83], v2, s[8:11], s26 offen sc1
    s_add_u32 s26, s25, 2048
    buffer_load_dwordx4 v[84:87], v2, s[8:11], s26 offen sc1
    s_add_u32 s26, s24, 3072
    buffer_load_dwordx4 v[88:91], v2, s[8:11], s26 offen sc1
    s_add_u32 s26, s25, 3072
    buffer_load_dwordx4 v[92:95], v2, s[8:11], s26 offen sc1
    s_add_u32 s26, s24, 4096
    buffer_load_dwordx4 v[96:99], v2, s[8:11], s26 offen sc1
    s_add_u32 s26, s25, 4096
    buffer_load_dwordx4 v[100:103], v2, s[8:11], s26 offen sc1
    s_add_u32 s26, s24, 5120
    buffer_load_dwordx4 v[104:107], v2, s[8:11], s26 offen sc1
    s_add_u32 s26, s25, 5120
    buffer_load_dwordx4 v[108:111], v2, s[8:11], s26 offen sc1
    s_add_u32 s26, s24, 6144
    buffer_load_dwordx4 v[112:115], v2, s[8:11], s26 offen sc1
    s_add_u32 s26, s25, 6144
    buffer_load_dwordx4 v[116:119], v2, s[8:11], s26 offen sc1
    s_waitcnt vmcnt(12)
    v_mfma_f32_16x16x32_bf16 v[8:11], a[0:3], v[64:67], v[8:11]
    v_mfma_f32_16x16x32_bf16 v[12:15], a[0:3], v[68:71], v[12:15]
    v_mfma_f32_16x16x32_bf16 v[16:19], a[56:59], v[64:67], v[16:19]
    v_mfma_f32_16x16x32_bf16 v[20:23], a[56:59], v[68:71], v[20:23]
    v_mfma_f32_16x16x32_bf16 v[24:27], a[112:115], v[64:67], v[24:27]
    v_mfma_f32_16x16x32_bf16 v[28:31], a[112:115], v[68:71], v[28:31]
    v_mfma_f32_16x16x32_bf16 v[32:35], a[168:171], v[64:67], v[32:35]
    v_mfma_f32_16x16x32_bf16 v[36:39], a[168:171], v[68:71], v[36:39]
    v_mfma_f32_16x16x32_bf16 v[40:43], a[224:227], v[64:67], v[40:43]
    v_mfma_f32_16x16x32_bf16 v[44:47], a[224:227], v[68:71], v[44:47]
    v_mfma_f32_16x16x32_bf16 v[48:51], v[144:147], v[64:67], v[48:51]
    v_mfma_f32_16x16x32_bf16 v[52:55], v[144:147], v[68:71], v[52:55]
    v_mfma_f32_16x16x32_bf16 v[56:59], v[200:203], v[64:67], v[56:59]
    v_mfma_f32_16x16x32_bf16 v[60:63], v[200:203], v[68:71], v[60:63]
    s_add_u32 s26, s24, 7168
    buffer_load_dwordx4 v[64:67], v2, s[8:11], s26 offen sc1
    s_add_u32 s26, s25, 7168
    buffer_load_dwordx4 v[68:71], v2, s[8:11], s26 offen sc1
    s_waitcnt vmcnt(12)
    v_mfma_f32_16x16x32_bf16 v[8:11], a[4:7], v[72:75], v[8:11]
    v_mfma_f32_16x16x32_bf16 v[12:15], a[4:7], v[76:79], v[12:15]
    v_mfma_f32_16x16x32_bf16 v[16:19], a[60:63], v[72:75], v[16:19]
    v_mfma_f32_16x16x32_bf16 v[20:23], a[60:63], v[76:79], v[20:23]
    v_mfma_f32_16x16x32_bf16 v[24:27], a[116:119], v[72:75], v[24:27]
    v_mfma_f32_16x16x32_bf16 v[28:31], a[116:119], v[76:79], v[28:31]
    v_mfma_f32_16x16x32_bf16 v[32:35], a[172:175], v[72:75], v[32:35]
    v_mfma_f32_16x16x32_bf16 v[36:39], a[172:175], v[76:79], v[36:39]
    v_mfma_f32_16x16x32_bf16 v[40:43], a[228:231], v[72:75], v[40:43]
    v_mfma_f32_16x16x32_bf16 v[44:47], a[228:231], v[76:79], v[44:47]
    v_mfma_f32_16x16x32_bf16 v[48:51], v[148:151], v[72:75], v[48:51]
    v_mfma_f32_16x16x32_bf16 v[52:55], v[148:151], v[76:79], v[52:55]
    v_mfma_f32_16x16x32_bf16 v[56:59], v[204:207], v[72:75], v[56:59]
    v_mfma_f32_16x16x32_bf16 v[60:63], v[204:207], v[76:79], v[60:63]
    s_add_u32 s26, s24, 8192
    buffer_load_dwordx4 v[72:75], v2, s[8:11], s26 offen sc1
    s_add_u32 s26, s25, 8192
    buffer_load_dwordx4 v[76:79], v2, s[8:11], s26 offen sc1
    s_waitcnt vmcnt(12)
    v_mfma_f32_16x16x32_bf16 v[8:11], a[8:11], v[80:83], v[8:11]
    v_mfma_f32_16x16x32_bf16 v[12:15], a[8:11], v[84:87], v[12:15]
    v_mfma_f32_16x16x32_bf16 v[16:19], a[64:67], v[80:83], v[16:19]
    v_mfma_f32_16x16x32_bf16 v[20:23], a[64:67], v[84:87], v[20:23]
    v_mfma_f32_16x16x32_bf16 v[24:27], a[120:123], v[80:83], v[24:27]
    v_mfma_f32_16x16x32_bf16 v[28:31], a[120:123], v[84:87], v[28:31]
    v_mfma_f32_16x16x32_bf16 v[32:35], a[176:179], v[80:83], v[32:35]
    v_mfma_f32_16x16x32_bf16 v[36:39], a[176:179], v[84:87], v[36:39]
    v_mfma_f32_16x16x32_bf16 v[40:43], a[232:235], v[80:83], v[40:43]
    v_mfma_f32_16x16x32_bf16 v[44:47], a[232:235], v[84:87], v[44:47]
    v_mfma_f32_16x16x32_bf16 v[48:51], v[152:155], v[80:83], v[48:51]
    v_mfma_f32_16x16x32_bf16 v[52:55], v[152:155], v[84:87], v[52:55]
    v_mfma_f32_16x16x32_bf16 v[56:59], v[208:211], v[80:83], v[56:59]
    v_mfma_f32_16x16x32_bf16 v[60:63], v[208:211], v[84:87], v[60:63]
    s_add_u32 s26, s24, 9216
    buffer_load_dwordx4 v[80:83], v2, s[8:11], s26 offen sc1
    s_add_u32 s26, s25, 9216
    buffer_load_dwordx4 v[84:87], v2, s[8:11], s26 offen sc1
    s_waitcnt vmcnt(12)
    v_mfma_f32_16x16x32_bf16 v[8:11], a[12:15], v[88:91], v[8:11]
    v_mfma_f32_16x16x32_bf16 v[12:15], a[12:15], v[92:95], v[12:15]
    v_mfma_f32_16x16x32_bf16 v[16:19], a[68:71], v[88:91], v[16:19]
    v_mfma_f32_16x16x32_bf16 v[20:23], a[68:71], v[92:95], v[20:23]
    v_mfma_f32_16x16x32_bf16 v[24:27], a[124:127], v[88:91], v[24:27]
    v_mfma_f32_16x16x32_bf16 v[28:31], a[124:127], v[92:95], v[28:31]
    v_mfma_f32_16x16x32_bf16 v[32:35], a[180:183], v[88:91], v[32:35]
    v_mfma_f32_16x16x32_bf16 v[36:39], a[180:183], v[92:95], v[36:39]
    v_mfma_f32_16x16x32_bf16 v[40:43], a[236:239], v[88:91], v[40:43]
    v_mfma_f32_16x16x32_bf16 v[44:47], a[236:239], v[92:95], v[44:47]
    v_mfma_f32_16x16x32_bf16 v[48:51], v[156:159], v[88:91], v[48:51]
    v_mfma_f32_16x16x32_bf16 v[52:55], v[156:159], v[92:95], v[52:55]
    v_mfma_f32_16x16x32_bf16 v[56:59], v[212:215], v[88:91], v[56:59]
    v_mfma_f32_16x16x32_bf16 v[60:63], v[212:215], v[92:95], v[60:63]
    s_add_u32 s26, s24, 10240
    buffer_load_dwordx4 v[88:91], v2, s[8:11], s26 offen sc1
    s_add_u32 s26, s25, 10240
    buffer_load_dwordx4 v[92:95], v2, s[8:11], s26 offen sc1
    s_waitcnt vmcnt(12)
    v_mfma_f32_16x16x32_bf16 v[8:11], a[16:19], v[96:99], v[8:11]
    v_mfma_f32_16x16x32_bf16 v[12:15], a[16:19], v[100:103], v[12:15]
    v_mfma_f32_16x16x32_bf16 v[16:19], a[72:75], v[96:99], v[16:19]
    v_mfma_f32_16x16x32_bf16 v[20:23], a[72:75], v[100:103], v[20:23]
    v_mfma_f32_16x16x32_bf16 v[24:27], a[128:131], v[96:99], v[24:27]
    v_mfma_f32_16x16x32_bf16 v[28:31], a[128:131], v[100:103], v[28:31]
    v_mfma_f32_16x16x32_bf16 v[32:35], a[184:187], v[96:99], v[32:35]
    v_mfma_f32_16x16x32_bf16 v[36:39], a[184:187], v[100:103], v[36:39]
    v_mfma_f32_16x16x32_bf16 v[40:43], a[240:243], v[96:99], v[40:43]
    v_mfma_f32_16x16x32_bf16 v[44:47], a[240:243], v[100:103], v[44:47]
    v_mfma_f32_16x16x32_bf16 v[48:51], v[160:163], v[96:99], v[48:51]
    v_mfma_f32_16x16x32_bf16 v[52:55], v[160:163], v[100:103], v[52:55]
    v_mfma_f32_16x16x32_bf16 v[56:59], v[216:219], v[96:99], v[56:59]
    v_mfma_f32_16x16x32_bf16 v[60:63], v[216:219], v[100:103], v[60:63]
    s_add_u32 s26, s24, 11264
    buffer_load_dwordx4 v[96:99], v2, s[8:11], s26 offen sc1
    s_add_u32 s26, s25, 11264
    buffer_load_dwordx4 v[100:103], v2, s[8:11], s26 offen sc1
    s_waitcnt vmcnt(12)
    v_mfma_f32_16x16x32_bf16 v[8:11], a[20:23], v[104:107], v[8:11]
    v_mfma_f32_16x16x32_bf16 v[12:15], a[20:23], v[108:111], v[12:15]
    v_mfma_f32_16x16x32_bf16 v[16:19], a[76:79], v[104:107], v[16:19]
    v_mfma_f32_16x16x32_bf16 v[20:23], a[76:79], v[108:111], v[20:23]
    v_mfma_f32_16x16x32_bf16 v[24:27], a[132:135], v[104:107], v[24:27]
    v_mfma_f32_16x16x32_bf16 v[28:31], a[132:135], v[108:111], v[28:31]
    v_mfma_f32_16x16x32_bf16 v[32:35], a[188:191], v[104:107], v[32:35]
    v_mfma_f32_16x16x32_bf16 v[36:39], a[188:191], v[108:111], v[36:39]
    v_mfma_f32_16x16x32_bf16 v[40:43], a[244:247], v[104:107], v[40:43]
    v_mfma_f32_16x16x32_bf16 v[44:47], a[244:247], v[108:111], v[44:47]
    v_mfma_f32_16x16x32_bf16 v[48:51], v[164:167], v[104:107], v[48:51]
    v_mfma_f32_16x16x32_bf16 v[52:55], v[164:167], v[108:111], v[52:55]
    v_mfma_f32_16x16x32_bf16 v[56:59], v[220:223], v[104:107], v[56:59]
    v_mfma_f32_16x16x32_bf16 v[60:63], v[220:223], v[108:111], v[60:63]
    s_add_u32 s26, s24, 12288
    buffer_load_dwordx4 v[104:107], v2, s[8:11], s26 offen sc1
    s_add_u32 s26, s25, 12288
    buffer_load_dwordx4 v[108:111], v2, s[8:11], s26 offen sc1
    s_waitcnt vmcnt(12)
    v_mfma_f32_16x16x32_bf16 v[8:11], a[24:27], v[112:115], v[8:11]
    v_mfma_f32_16x16x32_bf16 v[12:15], a[24:27], v[116:119], v[12:15]
    v_mfma_f32_16x16x32_bf16 v[16:19], a[80:83], v[112:115], v[16:19]
    v_mfma_f32_16x16x32_bf16 v[20:23], a[80:83], v[116:119], v[20:23]
    v_mfma_f32_16x16x32_bf16 v[24:27], a[136:139], v[112:115], v[24:27]
    v_mfma_f32_16x16x32_bf16 v[28:31], a[136:139], v[116:119], v[28:31]
    v_mfma_f32_16x16x32_bf16 v[32:35], a[192:195], v[112:115], v[32:35]
    v_mfma_f32_16x16x32_bf16 v[36:39], a[192:195], v[116:119], v[36:39]
    v_mfma_f32_16x16x32_bf16 v[40:43], a[248:251], v[112:115], v[40:43]
    v_mfma_f32_16x16x32_bf16 v[44:47], a[248:251], v[116:119], v[44:47]
    v_mfma_f32_16x16x32_bf16 v[48:51], v[168:171], v[112:115], v[48:51]
    v_mfma_f32_16x16x32_bf16 v[52:55], v[168:171], v[116:119], v[52:55]
    v_mfma_f32_16x16x32_bf16 v[56:59], v[224:227], v[112:115], v[56:59]
    v_mfma_f32_16x16x32_bf16 v[60:63], v[224:227], v[116:119], v[60:63]
    s_add_u32 s26, s24, 13312
    buffer_load_dwordx4 v[112:115], v2, s[8:11], s26 offen sc1
    s_add_u32 s26, s25, 13312
    buffer_load_dwordx4 v[116:119], v2, s[8:11], s26 offen sc1
    s_waitcnt vmcnt(12)
    v_mfma_f32_16x16x32_bf16 v[8:11], a[28:31], v[64:67], v[8:11]
    v_mfma_f32_16x16x32_bf16 v[12:15], a[28:31], v[68:71], v[12:15]
    v_mfma_f32_16x16x32_bf16 v[16:19], a[84:87], v[64:67], v[16:19]
    v_mfma_f32_16x16x32_bf16 v[20:23], a[84:87], v[68:71], v[20:23]
    v_mfma_f32_16x16x32_bf16 v[24:27], a[140:143], v[64:67], v[24:27]
    v_mfma_f32_16x16x32_bf16 v[28:31], a[140:143], v[68:71], v[28:31]
    v_mfma_f32_16x16x32_bf16 v[32:35], a[196:199], v[64:67], v[32:35]
    v_mfma_f32_16x16x32_bf16 v[36:39], a[196:199], v[68:71], v[36:39]
    v_mfma_f32_16x16x32_bf16 v[40:43], a[252:255], v[64:67], v[40:43]
    v_mfma_f32_16x16x32_bf16 v[44:47], a[252:255], v[68:71], v[44:47]
    v_mfma_f32_16x16x32_bf16 v[48:51], v[172:175], v[64:67], v[48:51]
    v_mfma_f32_16x16x32_bf16 v[52:55], v[172:175], v[68:71], v[52:55]
    v_mfma_f32_16x16x32_bf16 v[56:59], v[228:231], v[64:67], v[56:59]
    v_mfma_f32_16x16x32_bf16 v[60:63], v[228:231], v[68:71], v[60:63]
    s_waitcnt vmcnt(10)
    v_mfma_f32_16x16x32_bf16 v[8:11], a[32:35], v[72:75], v[8:11]
    v_mfma_f32_16x16x32_bf16 v[12:15], a[32:35], v[76:79], v[12:15]
    v_mfma_f32_16x16x32_bf16 v[16:19], a[88:91], v[72:75], v[16:19]
    v_mfma_f32_16x16x32_bf16 v[20:23], a[88:91], v[76:79], v[20:23]
    v_mfma_f32_16x16x32_bf16 v[24:27], a[144:147], v[72:75], v[24:27]
    v_mfma_f32_16x16x32_bf16 v[28:31], a[144:147], v[76:79], v[28:31]
    v_mfma_f32_16x16x32_bf16 v[32:35], a[200:203], v[72:75], v[32:35]
    v_mfma_f32_16x16x32_bf16 v[36:39], a[200:203], v[76:79], v[36:39]
    v_mfma_f32_16x16x32_bf16 v[40:43], v[120:123], v[72:75], v[40:43]
    v_mfma_f32_16x16x32_bf16 v[44:47], v[120:123], v[76:79], v[44:47]
    v_mfma_f32_16x16x32_bf16 v[48:51], v[176:179], v[72:75], v[48:51]
    v_mfma_f32_16x16x32_bf16 v[52:55], v[176:179], v[76:79], v[52:55]
    v_mfma_f32_16x16x32_bf16 v[56:59], v[232:235], v[72:75], v[56:59]
    v_mfma_f32_16x16x32_bf16 v[60:63], v[232:235], v[76:79], v[60:63]
    s_waitcnt vmcnt(8)
    v_mfma_f32_16x16x32_bf16 v[8:11], a[36:39], v[80:83], v[8:11]
    v_mfma_f32_16x16x32_bf16 v[12:15], a[36:39], v[84:87], v[12:15]
    v_mfma_f32_16x16x32_bf16 v[16:19], a[92:95], v[80:83], v[16:19]
    v_mfma_f32_16x16x32_bf16 v[20:23], a[92:95], v[84:87], v[20:23]
    v_mfma_f32_16x16x32_bf16 v[24:27], a[148:151], v[80:83], v[24:27]
    v_mfma_f32_16x16x32_bf16 v[28:31], a[148:151], v[84:87], v[28:31]
    v_mfma_f32_16x16x32_bf16 v[32:35], a[204:207], v[80:83], v[32:35]
    v_mfma_f32_16x16x32_bf16 v[36:39], a[204:207], v[84:87], v[36:39]
    v_mfma_f32_16x16x32_bf16 v[40:43], v[124:127], v[80:83], v[40:43]
    v_mfma_f32_16x16x32_bf16 v[44:47], v[124:127], v[84:87], v[44:47]
    v_mfma_f32_16x16x32_bf16 v[48:51], v[180:183], v[80:83], v[48:51]
    v_mfma_f32_16x16x32_bf16 v[52:55], v[180:183], v[84:87], v[52:55]
    v_mfma_f32_16x16x32_bf16 v[56:59], v[236:239], v[80:83], v[56:59]
    v_mfma_f32_16x16x32_bf16 v[60:63], v[236:239], v[84:87], v[60:63]
    s_waitcnt vmcnt(6)
    v_mfma_f32_16x16x32_bf16 v[8:11], a[40:43], v[88:91], v[8:11]
    v_mfma_f32_16x16x32_bf16 v[12:15], a[40:43], v[92:95], v[12:15]
    v_mfma_f32_16x16x32_bf16 v[16:19], a[96:99], v[88:91], v[16:19]
    v_mfma_f32_16x16x32_bf16 v[20:23], a[96:99], v[92:95], v[20:23]
    v_mfma_f32_16x16x32_bf16 v[24:27], a[152:155], v[88:91], v[24:27]
    v_mfma_f32_16x16x32_bf16 v[28:31], a[152:155], v[92:95], v[28:31]
    v_mfma_f32_16x16x32_bf16 v[32:35], a[208:211], v[88:91], v[32:35]
    v_mfma_f32_16x16x32_bf16 v[36:39], a[208:211], v[92:95], v[36:39]
    v_mfma_f32_16x16x32_bf16 v[40:43], v[128:131], v[88:91], v[40:43]
    v_mfma_f32_16x16x32_bf16 v[44:47], v[128:131], v[92:95], v[44:47]
    v_mfma_f32_16x16x32_bf16 v[48:51], v[184:187], v[88:91], v[48:51]
    v_mfma_f32_16x16x32_bf16 v[52:55], v[184:187], v[92:95], v[52:55]
    v_mfma_f32_16x16x32_bf16 v[56:59], v[240:243], v[88:91], v[56:59]
    v_mfma_f32_16x16x32_bf16 v[60:63], v[240:243], v[92:95], v[60:63]
    s_waitcnt vmcnt(4)
    v_mfma_f32_16x16x32_bf16 v[8:11], a[44:47], v[96:99], v[8:11]
    v_mfma_f32_16x16x32_bf16 v[12:15], a[44:47], v[100:103], v[12:15]
    v_mfma_f32_16x16x32_bf16 v[16:19], a[100:103], v[96:99], v[16:19]
    v_mfma_f32_16x16x32_bf16 v[20:23], a[100:103], v[100:103], v[20:23]
    v_mfma_f32_16x16x32_bf16 v[24:27], a[156:159], v[96:99], v[24:27]
    v_mfma_f32_16x16x32_bf16 v[28:31], a[156:159], v[100:103], v[28:31]
    v_mfma_f32_16x16x32_bf16 v[32:35], a[212:215], v[96:99], v[32:35]
    v_mfma_f32_16x16x32_bf16 v[36:39], a[212:215], v[100:103], v[36:39]
    v_mfma_f32_16x16x32_bf16 v[40:43], v[132:135], v[96:99], v[40:43]
    v_mfma_f32_16x16x32_bf16 v[44:47], v[132:135], v[100:103], v[44:47]
    v_mfma_f32_16x16x32_bf16 v[48:51], v[188:191], v[96:99], v[48:51]
    v_mfma_f32_16x16x32_bf16 v[52:55], v[188:191], v[100:103], v[52:55]
    v_mfma_f32_16x16x32_bf16 v[56:59], v[244:247], v[96:99], v[56:59]
    v_mfma_f32_16x16x32_bf16 v[60:63], v[244:247], v[100:103], v[60:63]
    s_waitcnt vmcnt(2)
    v_mfma_f32_16x16x32_bf16 v[8:11], a[48:51], v[104:107], v[8:11]
    v_mfma_f32_16x16x32_bf16 v[12:15], a[48:51], v[108:111], v[12:15]
    v_mfma_f32_16x16x32_bf16 v[16:19], a[104:107], v[104:107], v[16:19]
    v_mfma_f32_16x16x32_bf16 v[20:23], a[104:107], v[108:111], v[20:23]
    v_mfma_f32_16x16x32_bf16 v[24:27], a[160:163], v[104:107], v[24:27]
    v_mfma_f32_16x16x32_bf16 v[28:31], a[160:163], v[108:111], v[28:31]
    v_mfma_f32_16x16x32_bf16 v[32:35], a[216:219], v[104:107], v[32:35]
    v_mfma_f32_16x16x32_bf16 v[36:39], a[216:219], v[108:111], v[36:39]
    v_mfma_f32_16x16x32_bf16 v[40:43], v[136:139], v[104:107], v[40:43]
    v_mfma_f32_16x16x32_bf16 v[44:47], v[136:139], v[108:111], v[44:47]
    v_mfma_f32_16x16x32_bf16 v[48:51], v[192:195], v[104:107], v[48:51]
    v_mfma_f32_16x16x32_bf16 v[52:55], v[192:195], v[108:111], v[52:55]
    v_mfma_f32_16x16x32_bf16 v[56:59], v[248:251], v[104:107], v[56:59]
    v_mfma_f32_16x16x32_bf16 v[60:63], v[248:251], v[108:111], v[60:63]
    s_waitcnt vmcnt(0)
    v_mfma_f32_16x16x32_bf16 v[8:11], a[52:55], v[112:115], v[8:11]
    v_mfma_f32_16x16x32_bf16 v[12:15], a[52:55], v[116:119], v[12:15]
    v_mfma_f32_16x16x32_bf16 v[16:19], a[108:111], v[112:115], v[16:19]
    v_mfma_f32_16x16x32_bf16 v[20:23], a[108:111], v[116:119], v[20:23]
    v_mfma_f32_16x16x32_bf16 v[24:27], a[164:167], v[112:115], v[24:27]
    v_mfma_f32_16x16x32_bf16 v[28:31], a[164:167], v[116:119], v[28:31]
    v_mfma_f32_16x16x32_bf16 v[32:35], a[220:223], v[112:115], v[32:35]
    v_mfma_f32_16x16x32_bf16 v[36:39], a[220:223], v[116:119], v[36:39]
    v_mfma_f32_16x16x32_bf16 v[40:43], v[140:143], v[112:115], v[40:43]
    v_mfma_f32_16x16x32_bf16 v[44:47], v[140:143], v[116:119], v[44:47]
    v_mfma_f32_16x16x32_bf16 v[48:51], v[196:199], v[112:115], v[48:51]
    v_mfma_f32_16x16x32_bf16 v[52:55], v[196:199], v[116:119], v[52:55]
    v_mfma_f32_16x16x32_bf16 v[56:59], v[252:255], v[112:115], v[56:59]
    v_mfma_f32_16x16x32_bf16 v[60:63], v[252:255], v[116:119], v[60:63]
    s_mul_i32 s26, s18, 14336
    v_add_u32 v3, s26, v2
    ds_write_b128 v3, v[8:11] offset:0
    ds_write_b128 v3, v[12:15] offset:1024
    ds_write_b128 v3, v[16:19] offset:2048
    ds_write_b128 v3, v[20:23] offset:3072
    ds_write_b128 v3, v[24:27] offset:4096
    ds_write_b128 v3, v[28:31] offset:5120
    ds_write_b128 v3, v[32:35] offset:6144
    ds_write_b128 v3, v[36:39] offset:7168
    ds_write_b128 v3, v[40:43] offset:8192
    ds_write_b128 v3, v[44:47] offset:9216
    ds_write_b128 v3, v[48:51] offset:10240
    ds_write_b128 v3, v[52:55] offset:11264
    ds_write_b128 v3, v[56:59] offset:12288
    ds_write_b128 v3, v[60:63] offset:13312
    v_and_b32 v4, 15, v1
    v_lshrrev_b32 v5, 4, v1
    v_mul_u32_u24 v6, 1792, v4
    v_lshl_add_u32 v6, v5, 4, v6
    v_mul_u32_u24 v7, 896, v4
    v_lshl_add_u32 v7, v5, 3, v7
    v_lshlrev_b32 v8, 3, v5
    s_add_u32 s30, s18, 0
    s_min_u32 s30, s30, 13
    s_lshr_b32 s31, s30, 1
    s_and_b32 s32, s30, 1
    s_mul_i32 s33, s21, 7
    s_add_u32 s33, s33, s31
    s_lshl_b32 s34, s20, 1
    s_add_u32 s34, s34, s32
    s_mul_i32 s35, s34, 28672
    s_lshl_b32 s40, s33, 6
    s_add_u32 s35, s35, s40
    s_add_u32 s35, s35, 113246208
    buffer_load_dwordx4 v[64:67], v6, s[8:11], s35 offen sc1
    s_lshl_b32 s40, s33, 5
    buffer_load_dwordx2 v[68:69], v8, s[12:15], s40 offen
    s_mul_i32 s35, s34, 14336
    s_add_u32 s35, s35, s40
    s_mov_b32 s48, s35
    buffer_load_dwordx2 v[70:71], v7, s[44:47], s35 offen
    s_add_u32 s30, s18, 4
    s_min_u32 s30, s30, 13
    s_lshr_b32 s31, s30, 1
    s_and_b32 s32, s30, 1
    s_mul_i32 s33, s21, 7
    s_add_u32 s33, s33, s31
    s_lshl_b32 s34, s20, 1
    s_add_u32 s34, s34, s32
    s_mul_i32 s35, s34, 28672
    s_lshl_b32 s40, s33, 6
    s_add_u32 s35, s35, s40
    s_add_u32 s35, s35, 113246208
    buffer_load_dwordx4 v[72:75], v6, s[8:11], s35 offen sc1
    s_lshl_b32 s40, s33, 5
    buffer_load_dwordx2 v[76:77], v8, s[12:15], s40 offen
    s_mul_i32 s35, s34, 14336
    s_add_u32 s35, s35, s40
    s_mov_b32 s49, s35
    buffer_load_dwordx2 v[78:79], v7, s[44:47], s35 offen
    s_add_u32 s30, s18, 8
    s_min_u32 s30, s30, 13
    s_lshr_b32 s31, s30, 1
    s_and_b32 s32, s30, 1
    s_mul_i32 s33, s21, 7
    s_add_u32 s33, s33, s31
    s_lshl_b32 s34, s20, 1
    s_add_u32 s34, s34, s32
    s_mul_i32 s35, s34, 28672
    s_lshl_b32 s40, s33, 6
    s_add_u32 s35, s35, s40
    s_add_u32 s35, s35, 113246208
    buffer_load_dwordx4 v[80:83], v6, s[8:11], s35 offen sc1
    s_lshl_b32 s40, s33, 5
    buffer_load_dwordx2 v[84:85], v8, s[12:15], s40 offen
    s_mul_i32 s35, s34, 14336
    s_add_u32 s35, s35, s40
    s_mov_b32 s50, s35
    buffer_load_dwordx2 v[86:87], v7, s[44:47], s35 offen
    s_add_u32 s30, s18, 12
    s_min_u32 s30, s30, 13
    s_lshr_b32 s31, s30, 1
    s_and_b32 s32, s30, 1
    s_mul_i32 s33, s21, 7
    s_add_u32 s33, s33, s31
    s_lshl_b32 s34, s20, 1
    s_add_u32 s34, s34, s32
    s_mul_i32 s35, s34, 28672
    s_lshl_b32 s40, s33, 6
    s_add_u32 s35, s35, s40
    s_add_u32 s35, s35, 113246208
    buffer_load_dwordx4 v[88:91], v6, s[8:11], s35 offen sc1
    s_lshl_b32 s40, s33, 5
    buffer_load_dwordx2 v[92:93], v8, s[12:15], s40 offen
    s_mul_i32 s35, s34, 14336
    s_add_u32 s35, s35, s40
    s_mov_b32 s51, s35
    buffer_load_dwordx2 v[94:95], v7, s[44:47], s35 offen
    s_waitcnt lgkmcnt(0)
    s_barrier
    s_add_u32 s30, s18, 0
    s_lshl_b32 s33, s30, 10
    v_add_u32 v9, s33, v2
    ds_read_b128 v[96:99], v9 offset:0
    ds_read_b128 v[100:103], v9 offset:14336
    ds_read_b128 v[104:107], v9 offset:28672
    ds_read_b128 v[108:111], v9 offset:43008
    s_waitcnt lgkmcnt(0)
    v_add_f32 v96, v96, v100
    v_add_f32 v104, v104, v108
    v_add_f32 v96, v96, v104
    v_add_f32 v97, v97, v101
    v_add_f32 v105, v105, v109
    v_add_f32 v97, v97, v105
    v_add_f32 v98, v98, v102
    v_add_f32 v106, v106, v110
    v_add_f32 v98, v98, v106
    v_add_f32 v99, v99, v103
    v_add_f32 v107, v107, v111
    v_add_f32 v99, v99, v107
    s_waitcnt vmcnt(9)
    v_lshlrev_b32 v112, 16, v68
    v_and_b32 v113, 0xffff0000, v68
    v_add_f32 v96, v96, v112
    v_add_f32 v97, v97, v113
    v_lshlrev_b32 v112, 16, v69
    v_and_b32 v113, 0xffff0000, v69
    v_add_f32 v98, v98, v112
    v_add_f32 v99, v99, v113
    v_lshlrev_b32 v112, 16, v70
    v_and_b32 v113, 0xffff0000, v70
    v_add_f32 v96, v96, v112
    v_add_f32 v97, v97, v113
    v_lshlrev_b32 v112, 16, v71
    v_and_b32 v113, 0xffff0000, v71
    v_add_f32 v98, v98, v112
    v_add_f32 v99, v99, v113
    v_add_f32 v96, v96, v64
    v_add_f32 v97, v97, v65
    v_add_f32 v98, v98, v66
    v_add_f32 v99, v99, v67
    v_cvt_pk_bf16_f32 v114, v96, v97
    v_cvt_pk_bf16_f32 v115, v98, v99
    buffer_store_dwordx2 v[114:115], v7, s[36:39], s48 offen
    s_add_u32 s30, s18, 4
    s_lshl_b32 s33, s30, 10
    v_add_u32 v9, s33, v2
    ds_read_b128 v[96:99], v9 offset:0
    ds_read_b128 v[100:103], v9 offset:14336
    ds_read_b128 v[104:107], v9 offset:28672
    ds_read_b128 v[108:111], v9 offset:43008
    s_waitcnt lgkmcnt(0)
    v_add_f32 v96, v96, v100
    v_add_f32 v104, v104, v108
    v_add_f32 v96, v96, v104
    v_add_f32 v97, v97, v101
    v_add_f32 v105, v105, v109
    v_add_f32 v97, v97, v105
    v_add_f32 v98, v98, v102
    v_add_f32 v106, v106, v110
    v_add_f32 v98, v98, v106
    v_add_f32 v99, v99, v103
    v_add_f32 v107, v107, v111
    v_add_f32 v99, v99, v107
    s_waitcnt vmcnt(6)
    v_lshlrev_b32 v112, 16, v76
    v_and_b32 v113, 0xffff0000, v76
    v_add_f32 v96, v96, v112
    v_add_f32 v97, v97, v113
    v_lshlrev_b32 v112, 16, v77
    v_and_b32 v113, 0xffff0000, v77
    v_add_f32 v98, v98, v112
    v_add_f32 v99, v99, v113
    v_lshlrev_b32 v112, 16, v78
    v_and_b32 v113, 0xffff0000, v78
    v_add_f32 v96, v96, v112
    v_add_f32 v97, v97, v113
    v_lshlrev_b32 v112, 16, v79
    v_and_b32 v113, 0xffff0000, v79
    v_add_f32 v98, v98, v112
    v_add_f32 v99, v99, v113
    v_add_f32 v96, v96, v72
    v_add_f32 v97, v97, v73
    v_add_f32 v98, v98, v74
    v_add_f32 v99, v99, v75
    v_cvt_pk_bf16_f32 v114, v96, v97
    v_cvt_pk_bf16_f32 v115, v98, v99
    buffer_store_dwordx2 v[114:115], v7, s[36:39], s49 offen
    s_add_u32 s30, s18, 8
    s_lshl_b32 s33, s30, 10
    v_add_u32 v9, s33, v2
    ds_read_b128 v[96:99], v9 offset:0
    ds_read_b128 v[100:103], v9 offset:14336
    ds_read_b128 v[104:107], v9 offset:28672
    ds_read_b128 v[108:111], v9 offset:43008
    s_waitcnt lgkmcnt(0)
    v_add_f32 v96, v96, v100
    v_add_f32 v104, v104, v108
    v_add_f32 v96, v96, v104
    v_add_f32 v97, v97, v101
    v_add_f32 v105, v105, v109
    v_add_f32 v97, v97, v105
    v_add_f32 v98, v98, v102
    v_add_f32 v106, v106, v110
    v_add_f32 v98, v98, v106
    v_add_f32 v99, v99, v103
    v_add_f32 v107, v107, v111
    v_add_f32 v99, v99, v107
    s_waitcnt vmcnt(3)
    v_lshlrev_b32 v112, 16, v84
    v_and_b32 v113, 0xffff0000, v84
    v_add_f32 v96, v96, v112
    v_add_f32 v97, v97, v113
    v_lshlrev_b32 v112, 16, v85
    v_and_b32 v113, 0xffff0000, v85
    v_add_f32 v98, v98, v112
    v_add_f32 v99, v99, v113
    v_lshlrev_b32 v112, 16, v86
    v_and_b32 v113, 0xffff0000, v86
    v_add_f32 v96, v96, v112
    v_add_f32 v97, v97, v113
    v_lshlrev_b32 v112, 16, v87
    v_and_b32 v113, 0xffff0000, v87
    v_add_f32 v98, v98, v112
    v_add_f32 v99, v99, v113
    v_add_f32 v96, v96, v80
    v_add_f32 v97, v97, v81
    v_add_f32 v98, v98, v82
    v_add_f32 v99, v99, v83
    v_cvt_pk_bf16_f32 v114, v96, v97
    v_cvt_pk_bf16_f32 v115, v98, v99
    buffer_store_dwordx2 v[114:115], v7, s[36:39], s50 offen
    s_cmp_ge_u32 s18, 2
    s_cbranch_scc1 F2_END
    s_add_u32 s30, s18, 12
    s_lshl_b32 s33, s30, 10
    v_add_u32 v9, s33, v2
    ds_read_b128 v[96:99], v9 offset:0
    ds_read_b128 v[100:103], v9 offset:14336
    ds_read_b128 v[104:107], v9 offset:28672
    ds_read_b128 v[108:111], v9 offset:43008
    s_waitcnt lgkmcnt(0)
    v_add_f32 v96, v96, v100
    v_add_f32 v104, v104, v108
    v_add_f32 v96, v96, v104
    v_add_f32 v97, v97, v101
    v_add_f32 v105, v105, v109
    v_add_f32 v97, v97, v105
    v_add_f32 v98, v98, v102
    v_add_f32 v106, v106, v110
    v_add_f32 v98, v98, v106
    v_add_f32 v99, v99, v103
    v_add_f32 v107, v107, v111
    v_add_f32 v99, v99, v107
    s_waitcnt vmcnt(0)
    v_lshlrev_b32 v112, 16, v92
    v_and_b32 v113, 0xffff0000, v92
    v_add_f32 v96, v96, v112
    v_add_f32 v97, v97, v113
    v_lshlrev_b32 v112, 16, v93
    v_and_b32 v113, 0xffff0000, v93
    v_add_f32 v98, v98, v112
    v_add_f32 v99, v99, v113
    v_lshlrev_b32 v112, 16, v94
    v_and_b32 v113, 0xffff0000, v94
    v_add_f32 v96, v96, v112
    v_add_f32 v97, v97, v113
    v_lshlrev_b32 v112, 16, v95
    v_and_b32 v113, 0xffff0000, v95
    v_add_f32 v98, v98, v112
    v_add_f32 v99, v99, v113
    v_add_f32 v96, v96, v88
    v_add_f32 v97, v97, v89
    v_add_f32 v98, v98, v90
    v_add_f32 v99, v99, v91
    v_cvt_pk_bf16_f32 v114, v96, v97
    v_cvt_pk_bf16_f32 v115, v98, v99
    buffer_store_dwordx2 v[114:115], v7, s[36:39], s51 offen
    s_nop 0
F2_END:
    s_waitcnt vmcnt(0)
    s_branch BK_NEXT
BK_F1:
    s_mul_i32 s85, s82, 14
    s_add_u32 s85, s85, s83
    s_sub_u32 s85, s85, 8
    s_mul_hi_u32 s21, s85, 613566757
    s_mul_i32 s22, s21, 7
    s_sub_u32 s20, s85, s22
    v_lshlrev_b32 v2, 4, v1
    s_lshl_b32 s24, s20, 4
    s_lshl_b32 s25, s18, 2
    s_add_u32 s24, s24, s25
    s_mul_i32 s25, s24, 14336
    s_add_u32 s25, s25, 97517568
    s_mov_b32 s87, 112256640
    s_cmp_lg_u32 s18, 0
    s_cbranch_scc1 F1I_W
    v_mov_b32 v10, 0
    s_nop 1
F1I_P:
    buffer_load_dword v9, v10, s[8:11], s87 offen sc1
    s_waitcnt vmcnt(0)
    v_readfirstlane_b32 s86, v9
    s_nop 0
    s_cmp_ge_u32 s86, 28
    s_nop 2
    s_cbranch_scc1 F1I_W
    s_sleep 4
    s_sub_u32 s84, s84, 1
    s_cbranch_scc0 F1I_P
    s_mov_b32 s84, 0
F1I_W:
    s_barrier
    buffer_load_dwordx4 a[0:3], v2, s[8:11], s25 offen offset:0 sc1
    buffer_load_dwordx4 a[4:7], v2, s[8:11], s25 offen offset:1024 sc1
    buffer_load_dwordx4 a[8:11], v2, s[8:11], s25 offen offset:2048 sc1
    buffer_load_dwordx4 a[12:15], v2, s[8:11], s25 offen offset:3072 sc1
    s_add_u32 s25, s25, 4096
    buffer_load_dwordx4 a[16:19], v2, s[8:11], s25 offen offset:0 sc1
    buffer_load_dwordx4 a[20:23], v2, s[8:11], s25 offen offset:1024 sc1
    buffer_load_dwordx4 a[24:27], v2, s[8:11], s25 offen offset:2048 sc1
    buffer_load_dwordx4 a[28:31], v2, s[8:11], s25 offen offset:3072 sc1
    s_add_u32 s25, s25, 4096
    buffer_load_dwordx4 a[32:35], v2, s[8:11], s25 offen offset:0 sc1
    buffer_load_dwordx4 a[36:39], v2, s[8:11], s25 offen offset:1024 sc1
    buffer_load_dwordx4 a[40:43], v2, s[8:11], s25 offen offset:2048 sc1
    buffer_load_dwordx4 a[44:47], v2, s[8:11], s25 offen offset:3072 sc1
    s_add_u32 s25, s25, 4096
    buffer_load_dwordx4 a[48:51], v2, s[8:11], s25 offen offset:0 sc1
    buffer_load_dwordx4 a[52:55], v2, s[8:11], s25 offen offset:1024 sc1
    s_add_u32 s25, s25, 2048
    buffer_load_dwordx4 a[56:59], v2, s[8:11], s25 offen offset:0 sc1
    buffer_load_dwordx4 a[60:63], v2, s[8:11], s25 offen offset:1024 sc1
    buffer_load_dwordx4 a[64:67], v2, s[8:11], s25 offen offset:2048 sc1
    buffer_load_dwordx4 a[68:71], v2, s[8:11], s25 offen offset:3072 sc1
    s_add_u32 s25, s25, 4096
    buffer_load_dwordx4 a[72:75], v2, s[8:11], s25 offen offset:0 sc1
    buffer_load_dwordx4 a[76:79], v2, s[8:11], s25 offen offset:1024 sc1
    buffer_load_dwordx4 a[80:83], v2, s[8:11], s25 offen offset:2048 sc1
    buffer_load_dwordx4 a[84:87], v2, s[8:11], s25 offen offset:3072 sc1
    s_add_u32 s25, s25, 4096
    buffer_load_dwordx4 a[88:91], v2, s[8:11], s25 offen offset:0 sc1
    buffer_load_dwordx4 a[92:95], v2, s[8:11], s25 offen offset:1024 sc1
    buffer_load_dwordx4 a[96:99], v2, s[8:11], s25 offen offset:2048 sc1
    buffer_load_dwordx4 a[100:103], v2, s[8:11], s25 offen offset:3072 sc1
    s_add_u32 s25, s25, 4096
    buffer_load_dwordx4 a[104:107], v2, s[8:11], s25 offen offset:0 sc1
    buffer_load_dwordx4 a[108:111], v2, s[8:11], s25 offen offset:1024 sc1
    s_add_u32 s25, s25, 2048
    buffer_load_dwordx4 a[112:115], v2, s[8:11], s25 offen offset:0 sc1
    buffer_load_dwordx4 a[116:119], v2, s[8:11], s25 offen offset:1024 sc1
    buffer_load_dwordx4 a[120:123], v2, s[8:11], s25 offen offset:2048 sc1
    buffer_load_dwordx4 a[124:127], v2, s[8:11], s25 offen offset:3072 sc1
    s_add_u32 s25, s25, 4096
    buffer_load_dwordx4 a[128:131], v2, s[8:11], s25 offen offset:0 sc1
    buffer_load_dwordx4 a[132:135], v2, s[8:11], s25 offen offset:1024 sc1
    buffer_load_dwordx4 a[136:139], v2, s[8:11], s25 offen offset:2048 sc1
    buffer_load_dwordx4 a[140:143], v2, s[8:11], s25 offen offset:3072 sc1
    s_add_u32 s25, s25, 4096
    buffer_load_dwordx4 a[144:147], v2, s[8:11], s25 offen offset:0 sc1
    buffer_load_dwordx4 a[148:151], v2, s[8:11], s25 offen offset:1024 sc1
    buffer_load_dwordx4 a[152:155], v2, s[8:11], s25 offen offset:2048 sc1
    buffer_load_dwordx4 a[156:159], v2, s[8:11], s25 offen offset:3072 sc1
    s_add_u32 s25, s25, 4096
    buffer_load_dwordx4 a[160:163], v2, s[8:11], s25 offen offset:0 sc1
    buffer_load_dwordx4 a[164:167], v2, s[8:11], s25 offen offset:1024 sc1
    s_add_u32 s25, s25, 2048
    buffer_load_dwordx4 a[168:171], v2, s[8:11], s25 offen offset:0 sc1
    buffer_load_dwordx4 a[172:175], v2, s[8:11], s25 offen offset:1024 sc1
    buffer_load_dwordx4 a[176:179], v2, s[8:11], s25 offen offset:2048 sc1
    buffer_load_dwordx4 a[180:183], v2, s[8:11], s25 offen offset:3072 sc1
    s_add_u32 s25, s25, 4096
    buffer_load_dwordx4 a[184:187], v2, s[8:11], s25 offen offset:0 sc1
    buffer_load_dwordx4 a[188:191], v2, s[8:11], s25 offen offset:1024 sc1
    buffer_load_dwordx4 a[192:195], v2, s[8:11], s25 offen offset:2048 sc1
    buffer_load_dwordx4 a[196:199], v2, s[8:11], s25 offen offset:3072 sc1
    s_add_u32 s25, s25, 4096
    buffer_load_dwordx4 a[200:203], v2, s[8:11], s25 offen offset:0 sc1
    buffer_load_dwordx4 a[204:207], v2, s[8:11], s25 offen offset:1024 sc1
    buffer_load_dwordx4 a[208:211], v2, s[8:11], s25 offen offset:2048 sc1
    buffer_load_dwordx4 a[212:215], v2, s[8:11], s25 offen offset:3072 sc1
    s_add_u32 s25, s25, 4096
    buffer_load_dwordx4 a[216:219], v2, s[8:11], s25 offen offset:0 sc1
    buffer_load_dwordx4 a[220:223], v2, s[8:11], s25 offen offset:1024 sc1
    s_add_u32 s25, s25, 2048
    s_load_dwordx2 s[16:17], s[0:1], 72
    s_load_dwordx2 s[28:29], s[0:1], 0
    s_waitcnt lgkmcnt(0)
    s_mov_b32 s12, s16
    s_and_b32 s13, s17, 0xffff
    s_mov_b32 s14, 3584
    s_mov_b32 s15, 0x00020000
    s_mov_b32 s36, s28
    s_and_b32 s37, s29, 0xffff
    s_mov_b32 s38, 1835008
    s_mov_b32 s39, 0x00020000
    v_lshrrev_b32 v4, 4, v1
    v_lshlrev_b32 v5, 3, v4
    s_lshl_b32 s26, s24, 5
    buffer_load_dwordx2 v[216:217], v5, s[12:15], s26 offen offset:0
    buffer_load_dwordx2 v[218:219], v5, s[12:15], s26 offen offset:32
    buffer_load_dwordx2 v[220:221], v5, s[12:15], s26 offen offset:64
    buffer_load_dwordx2 v[222:223], v5, s[12:15], s26 offen offset:96
    v_and_b32 v6, 15, v1
    v_mul_u32_u24 v7, 896, v6
    v_lshl_add_u32 v7, v4, 3, v7
    v_mul_u32_u24 v8, 1792, v6
    v_lshl_add_u32 v8, v4, 4, v8
    s_lshr_b32 s33, s18, 1
    s_and_b32 s34, s18, 1
    s_lshl_b32 s30, s21, 1
    s_add_u32 s30, s30, s33
    s_mul_i32 s31, s30, 14336
    s_mul_i32 s35, s34, 448
    s_add_u32 s31, s31, s35
    s_mul_i32 s32, s30, 28672
    s_mul_i32 s35, s34, 896
    s_add_u32 s32, s32, s35
    s_add_u32 s32, s32, 113246208
    s_waitcnt vmcnt(0)
    v_lshlrev_b32 v200, 16, v216
    v_and_b32 v201, 0xffff0000, v216
    v_lshlrev_b32 v202, 16, v217
    v_and_b32 v203, 0xffff0000, v217
    v_lshlrev_b32 v204, 16, v218
    v_and_b32 v205, 0xffff0000, v218
    v_lshlrev_b32 v206, 16, v219
    v_and_b32 v207, 0xffff0000, v219
    v_lshlrev_b32 v208, 16, v220
    v_and_b32 v209, 0xffff0000, v220
    v_lshlrev_b32 v210, 16, v221
    v_and_b32 v211, 0xffff0000, v221
    v_lshlrev_b32 v212, 16, v222
    v_and_b32 v213, 0xffff0000, v222
    v_lshlrev_b32 v214, 16, v223
    v_and_b32 v215, 0xffff0000, v223
    buffer_load_dwordx2 v[72:73], v7, s[36:39], s31 offen offset:0
    buffer_load_dwordx2 v[74:75], v7, s[36:39], s31 offen offset:32
    buffer_load_dwordx2 v[76:77], v7, s[36:39], s31 offen offset:64
    buffer_load_dwordx2 v[78:79], v7, s[36:39], s31 offen offset:96
    buffer_load_dwordx2 v[80:81], v7, s[36:39], s31 offen offset:128
    buffer_load_dwordx2 v[82:83], v7, s[36:39], s31 offen offset:160
    buffer_load_dwordx2 v[84:85], v7, s[36:39], s31 offen offset:192
    buffer_load_dwordx2 v[86:87], v7, s[36:39], s31 offen offset:224
    buffer_load_dwordx2 v[88:89], v7, s[36:39], s31 offen offset:256
    buffer_load_dwordx2 v[90:91], v7, s[36:39], s31 offen offset:288
    buffer_load_dwordx2 v[92:93], v7, s[36:39], s31 offen offset:320
    buffer_load_dwordx2 v[94:95], v7, s[36:39], s31 offen offset:352
    buffer_load_dwordx2 v[96:97], v7, s[36:39], s31 offen offset:384
    buffer_load_dwordx2 v[98:99], v7, s[36:39], s31 offen offset:416
    s_waitcnt vmcnt(0)
    v_lshlrev_b32 v100, 16, v72
    v_and_b32 v101, 0xffff0000, v72
    v_lshlrev_b32 v102, 16, v73
    v_and_b32 v103, 0xffff0000, v73
    v_lshlrev_b32 v104, 16, v74
    v_and_b32 v105, 0xffff0000, v74
    v_lshlrev_b32 v106, 16, v75
    v_and_b32 v107, 0xffff0000, v75
    v_lshlrev_b32 v108, 16, v76
    v_and_b32 v109, 0xffff0000, v76
    v_lshlrev_b32 v110, 16, v77
    v_and_b32 v111, 0xffff0000, v77
    v_lshlrev_b32 v112, 16, v78
    v_and_b32 v113, 0xffff0000, v78
    v_lshlrev_b32 v114, 16, v79
    v_and_b32 v115, 0xffff0000, v79
    v_lshlrev_b32 v116, 16, v80
    v_and_b32 v117, 0xffff0000, v80
    v_lshlrev_b32 v118, 16, v81
    v_and_b32 v119, 0xffff0000, v81
    v_lshlrev_b32 v120, 16, v82
    v_and_b32 v121, 0xffff0000, v82
    v_lshlrev_b32 v122, 16, v83
    v_and_b32 v123, 0xffff0000, v83
    v_lshlrev_b32 v124, 16, v84
    v_and_b32 v125, 0xffff0000, v84
    v_lshlrev_b32 v126, 16, v85
    v_and_b32 v127, 0xffff0000, v85
    v_lshlrev_b32 v128, 16, v86
    v_and_b32 v129, 0xffff0000, v86
    v_lshlrev_b32 v130, 16, v87
    v_and_b32 v131, 0xffff0000, v87
    v_lshlrev_b32 v132, 16, v88
    v_and_b32 v133, 0xffff0000, v88
    v_lshlrev_b32 v134, 16, v89
    v_and_b32 v135, 0xffff0000, v89
    v_lshlrev_b32 v136, 16, v90
    v_and_b32 v137, 0xffff0000, v90
    v_lshlrev_b32 v138, 16, v91
    v_and_b32 v139, 0xffff0000, v91
    v_lshlrev_b32 v140, 16, v92
    v_and_b32 v141, 0xffff0000, v92
    v_lshlrev_b32 v142, 16, v93
    v_and_b32 v143, 0xffff0000, v93
    v_lshlrev_b32 v144, 16, v94
    v_and_b32 v145, 0xffff0000, v94
    v_lshlrev_b32 v146, 16, v95
    v_and_b32 v147, 0xffff0000, v95
    v_lshlrev_b32 v148, 16, v96
    v_and_b32 v149, 0xffff0000, v96
    v_lshlrev_b32 v150, 16, v97
    v_and_b32 v151, 0xffff0000, v97
    v_lshlrev_b32 v152, 16, v98
    v_and_b32 v153, 0xffff0000, v98
    v_lshlrev_b32 v154, 16, v99
    v_and_b32 v155, 0xffff0000, v99
    s_lshl_b32 s87, s21, 7
    s_add_u32 s87, s87, 112222208
    s_cmp_lg_u32 s18, 0
    s_cbranch_scc1 F1A_W
    v_mov_b32 v10, 0
    s_nop 1
F1A_P:
    buffer_load_dword v9, v10, s[8:11], s87 offen sc1
    s_waitcnt vmcnt(0)
    v_readfirstlane_b32 s86, v9
    s_nop 0
    s_cmp_ge_u32 s86, 4
    s_nop 2
    s_cbranch_scc1 F1A_W
    s_sleep 1
    s_sub_u32 s84, s84, 1
    s_cbranch_scc0 F1A_P
    s_mov_b32 s84, 0
F1A_W:
    s_barrier
    buffer_load_dwordx4 v[16:19], v8, s[8:11], s32 offen offset:0 sc1
    buffer_load_dwordx4 v[20:23], v8, s[8:11], s32 offen offset:64 sc1
    buffer_load_dwordx4 v[24:27], v8, s[8:11], s32 offen offset:128 sc1
    buffer_load_dwordx4 v[28:31], v8, s[8:11], s32 offen offset:192 sc1
    buffer_load_dwordx4 v[32:35], v8, s[8:11], s32 offen offset:256 sc1
    buffer_load_dwordx4 v[36:39], v8, s[8:11], s32 offen offset:320 sc1
    buffer_load_dwordx4 v[40:43], v8, s[8:11], s32 offen offset:384 sc1
    buffer_load_dwordx4 v[44:47], v8, s[8:11], s32 offen offset:448 sc1
    buffer_load_dwordx4 v[48:51], v8, s[8:11], s32 offen offset:512 sc1
    buffer_load_dwordx4 v[52:55], v8, s[8:11], s32 offen offset:576 sc1
    buffer_load_dwordx4 v[56:59], v8, s[8:11], s32 offen offset:640 sc1
    buffer_load_dwordx4 v[60:63], v8, s[8:11], s32 offen offset:704 sc1
    buffer_load_dwordx4 v[64:67], v8, s[8:11], s32 offen offset:768 sc1
    buffer_load_dwordx4 v[68:71], v8, s[8:11], s32 offen offset:832 sc1
    v_mov_b32 v10, 0
    v_mov_b32 v11, 0
    v_mov_b32 v12, 0
    v_mov_b32 v13, 0
    s_waitcnt vmcnt(13)
    v_pk_add_f32 v[16:17], v[16:17], v[100:101]
    v_pk_add_f32 v[18:19], v[18:19], v[102:103]
    v_pk_add_f32 v[10:11], v[10:11], v[16:17]
    v_pk_fma_f32 v[12:13], v[16:17], v[16:17], v[12:13]
    v_pk_add_f32 v[10:11], v[10:11], v[18:19]
    v_pk_fma_f32 v[12:13], v[18:19], v[18:19], v[12:13]
    s_waitcnt vmcnt(12)
    v_pk_add_f32 v[20:21], v[20:21], v[104:105]
    v_pk_add_f32 v[22:23], v[22:23], v[106:107]
    v_pk_add_f32 v[10:11], v[10:11], v[20:21]
    v_pk_fma_f32 v[12:13], v[20:21], v[20:21], v[12:13]
    v_pk_add_f32 v[10:11], v[10:11], v[22:23]
    v_pk_fma_f32 v[12:13], v[22:23], v[22:23], v[12:13]
    s_waitcnt vmcnt(11)
    v_pk_add_f32 v[24:25], v[24:25], v[108:109]
    v_pk_add_f32 v[26:27], v[26:27], v[110:111]
    v_pk_add_f32 v[10:11], v[10:11], v[24:25]
    v_pk_fma_f32 v[12:13], v[24:25], v[24:25], v[12:13]
    v_pk_add_f32 v[10:11], v[10:11], v[26:27]
    v_pk_fma_f32 v[12:13], v[26:27], v[26:27], v[12:13]
    s_waitcnt vmcnt(10)
    v_pk_add_f32 v[28:29], v[28:29], v[112:113]
    v_pk_add_f32 v[30:31], v[30:31], v[114:115]
    v_pk_add_f32 v[10:11], v[10:11], v[28:29]
    v_pk_fma_f32 v[12:13], v[28:29], v[28:29], v[12:13]
    v_pk_add_f32 v[10:11], v[10:11], v[30:31]
    v_pk_fma_f32 v[12:13], v[30:31], v[30:31], v[12:13]
    s_waitcnt vmcnt(9)
    v_pk_add_f32 v[32:33], v[32:33], v[116:117]
    v_pk_add_f32 v[34:35], v[34:35], v[118:119]
    v_pk_add_f32 v[10:11], v[10:11], v[32:33]
    v_pk_fma_f32 v[12:13], v[32:33], v[32:33], v[12:13]
    v_pk_add_f32 v[10:11], v[10:11], v[34:35]
    v_pk_fma_f32 v[12:13], v[34:35], v[34:35], v[12:13]
    s_waitcnt vmcnt(8)
    v_pk_add_f32 v[36:37], v[36:37], v[120:121]
    v_pk_add_f32 v[38:39], v[38:39], v[122:123]
    v_pk_add_f32 v[10:11], v[10:11], v[36:37]
    v_pk_fma_f32 v[12:13], v[36:37], v[36:37], v[12:13]
    v_pk_add_f32 v[10:11], v[10:11], v[38:39]
    v_pk_fma_f32 v[12:13], v[38:39], v[38:39], v[12:13]
    s_waitcnt vmcnt(7)
    v_pk_add_f32 v[40:41], v[40:41], v[124:125]
    v_pk_add_f32 v[42:43], v[42:43], v[126:127]
    v_pk_add_f32 v[10:11], v[10:11], v[40:41]
    v_pk_fma_f32 v[12:13], v[40:41], v[40:41], v[12:13]
    v_pk_add_f32 v[10:11], v[10:11], v[42:43]
    v_pk_fma_f32 v[12:13], v[42:43], v[42:43], v[12:13]
    s_waitcnt vmcnt(6)
    v_pk_add_f32 v[44:45], v[44:45], v[128:129]
    v_pk_add_f32 v[46:47], v[46:47], v[130:131]
    v_pk_add_f32 v[10:11], v[10:11], v[44:45]
    v_pk_fma_f32 v[12:13], v[44:45], v[44:45], v[12:13]
    v_pk_add_f32 v[10:11], v[10:11], v[46:47]
    v_pk_fma_f32 v[12:13], v[46:47], v[46:47], v[12:13]
    s_waitcnt vmcnt(5)
    v_pk_add_f32 v[48:49], v[48:49], v[132:133]
    v_pk_add_f32 v[50:51], v[50:51], v[134:135]
    v_pk_add_f32 v[10:11], v[10:11], v[48:49]
    v_pk_fma_f32 v[12:13], v[48:49], v[48:49], v[12:13]
    v_pk_add_f32 v[10:11], v[10:11], v[50:51]
    v_pk_fma_f32 v[12:13], v[50:51], v[50:51], v[12:13]
    s_waitcnt vmcnt(4)
    v_pk_add_f32 v[52:53], v[52:53], v[136:137]
    v_pk_add_f32 v[54:55], v[54:55], v[138:139]
    v_pk_add_f32 v[10:11], v[10:11], v[52:53]
    v_pk_fma_f32 v[12:13], v[52:53], v[52:53], v[12:13]
    v_pk_add_f32 v[10:11], v[10:11], v[54:55]
    v_pk_fma_f32 v[12:13], v[54:55], v[54:55], v[12:13]
    s_waitcnt vmcnt(3)
    v_pk_add_f32 v[56:57], v[56:57], v[140:141]
    v_pk_add_f32 v[58:59], v[58:59], v[142:143]
    v_pk_add_f32 v[10:11], v[10:11], v[56:57]
    v_pk_fma_f32 v[12:13], v[56:57], v[56:57], v[12:13]
    v_pk_add_f32 v[10:11], v[10:11], v[58:59]
    v_pk_fma_f32 v[12:13], v[58:59], v[58:59], v[12:13]
    s_waitcnt vmcnt(2)
    v_pk_add_f32 v[60:61], v[60:61], v[144:145]
    v_pk_add_f32 v[62:63], v[62:63], v[146:147]
    v_pk_add_f32 v[10:11], v[10:11], v[60:61]
    v_pk_fma_f32 v[12:13], v[60:61], v[60:61], v[12:13]
    v_pk_add_f32 v[10:11], v[10:11], v[62:63]
    v_pk_fma_f32 v[12:13], v[62:63], v[62:63], v[12:13]
    s_waitcnt vmcnt(1)
    v_pk_add_f32 v[64:65], v[64:65], v[148:149]
    v_pk_add_f32 v[66:67], v[66:67], v[150:151]
    v_pk_add_f32 v[10:11], v[10:11], v[64:65]
    v_pk_fma_f32 v[12:13], v[64:65], v[64:65], v[12:13]
    v_pk_add_f32 v[10:11], v[10:11], v[66:67]
    v_pk_fma_f32 v[12:13], v[66:67], v[66:67], v[12:13]
    s_waitcnt vmcnt(0)
    v_pk_add_f32 v[68:69], v[68:69], v[152:153]
    v_pk_add_f32 v[70:71], v[70:71], v[154:155]
    v_pk_add_f32 v[10:11], v[10:11], v[68:69]
    v_pk_fma_f32 v[12:13], v[68:69], v[68:69], v[12:13]
    v_pk_add_f32 v[10:11], v[10:11], v[70:71]
    v_pk_fma_f32 v[12:13], v[70:71], v[70:71], v[12:13]
    v_add_f32 v10, v10, v11
    v_add_f32 v11, v12, v13
    v_mov_b32 v12, v10
    v_mov_b32 v13, v11
    s_nop 0
    v_permlane16_swap_b32 v10, v12
    v_permlane16_swap_b32 v11, v13
    v_add_f32 v10, v10, v12
    v_add_f32 v11, v11, v13
    v_mov_b32 v12, v10
    v_mov_b32 v13, v11
    s_nop 0
    v_permlane32_swap_b32 v10, v12
    v_permlane32_swap_b32 v11, v13
    v_add_f32 v10, v10, v12
    v_add_f32 v11, v11, v13
    s_lshl_b32 s33, s18, 7
    s_add_u32 s33, s33, 32768
    v_lshl_add_u32 v9, v6, 3, s33
    ds_write_b64 v9, v[10:11]
    s_waitcnt lgkmcnt(0)
    s_barrier
    v_xor_b32 v9, 128, v9
    ds_read_b64 v[12:13], v9
    s_waitcnt lgkmcnt(0)
    v_add_f32 v10, v10, v12
    v_add_f32 v11, v11, v13
    s_mov_b32 s33, 0x3b124925
    v_mov_b32 v12, 0x3727c5ac
    v_mul_f32 v10, s33, v10
    v_mul_f32 v11, s33, v11
    v_fma_f32 v11, -v10, v10, v11
    v_max_f32 v11, 0, v11
    v_add_f32 v11, v11, v12
    v_rsq_f32 v11, v11
    s_nop 0
    v_mul_f32 v10, v10, v11
    v_sub_f32 v12, 0, v10
    v_mov_b32 v13, v12
    v_mov_b32 v10, v11
    s_lshr_b32 s33, s18, 1
    s_mul_i32 s33, s33, 14336
    s_mul_i32 s35, s34, 7168
    s_add_u32 s33, s33, s35
    v_add_u32 v9, s33, v2
    v_pk_fma_f32 v[16:17], v[16:17], v[10:11], v[12:13]
    v_pk_fma_f32 v[18:19], v[18:19], v[10:11], v[12:13]
    v_pk_fma_f32 v[20:21], v[20:21], v[10:11], v[12:13]
    v_pk_fma_f32 v[22:23], v[22:23], v[10:11], v[12:13]
    v_cvt_pk_bf16_f32 v72, v16, v17
    v_cvt_pk_bf16_f32 v73, v18, v19
    v_cvt_pk_bf16_f32 v74, v20, v21
    v_cvt_pk_bf16_f32 v75, v22, v23
    ds_write_b128 v9, v[72:75] offset:0
    v_pk_fma_f32 v[24:25], v[24:25], v[10:11], v[12:13]
    v_pk_fma_f32 v[26:27], v[26:27], v[10:11], v[12:13]
    v_pk_fma_f32 v[28:29], v[28:29], v[10:11], v[12:13]
    v_pk_fma_f32 v[30:31], v[30:31], v[10:11], v[12:13]
    v_cvt_pk_bf16_f32 v76, v24, v25
    v_cvt_pk_bf16_f32 v77, v26, v27
    v_cvt_pk_bf16_f32 v78, v28, v29
    v_cvt_pk_bf16_f32 v79, v30, v31
    ds_write_b128 v9, v[76:79] offset:1024
    v_pk_fma_f32 v[32:33], v[32:33], v[10:11], v[12:13]
    v_pk_fma_f32 v[34:35], v[34:35], v[10:11], v[12:13]
    v_pk_fma_f32 v[36:37], v[36:37], v[10:11], v[12:13]
    v_pk_fma_f32 v[38:39], v[38:39], v[10:11], v[12:13]
    v_cvt_pk_bf16_f32 v80, v32, v33
    v_cvt_pk_bf16_f32 v81, v34, v35
    v_cvt_pk_bf16_f32 v82, v36, v37
    v_cvt_pk_bf16_f32 v83, v38, v39
    ds_write_b128 v9, v[80:83] offset:2048
    v_pk_fma_f32 v[40:41], v[40:41], v[10:11], v[12:13]
    v_pk_fma_f32 v[42:43], v[42:43], v[10:11], v[12:13]
    v_pk_fma_f32 v[44:45], v[44:45], v[10:11], v[12:13]
    v_pk_fma_f32 v[46:47], v[46:47], v[10:11], v[12:13]
    v_cvt_pk_bf16_f32 v84, v40, v41
    v_cvt_pk_bf16_f32 v85, v42, v43
    v_cvt_pk_bf16_f32 v86, v44, v45
    v_cvt_pk_bf16_f32 v87, v46, v47
    ds_write_b128 v9, v[84:87] offset:3072
    v_pk_fma_f32 v[48:49], v[48:49], v[10:11], v[12:13]
    v_pk_fma_f32 v[50:51], v[50:51], v[10:11], v[12:13]
    v_pk_fma_f32 v[52:53], v[52:53], v[10:11], v[12:13]
    v_pk_fma_f32 v[54:55], v[54:55], v[10:11], v[12:13]
    v_cvt_pk_bf16_f32 v72, v48, v49
    v_cvt_pk_bf16_f32 v73, v50, v51
    v_cvt_pk_bf16_f32 v74, v52, v53
    v_cvt_pk_bf16_f32 v75, v54, v55
    ds_write_b128 v9, v[72:75] offset:4096
    v_pk_fma_f32 v[56:57], v[56:57], v[10:11], v[12:13]
    v_pk_fma_f32 v[58:59], v[58:59], v[10:11], v[12:13]
    v_pk_fma_f32 v[60:61], v[60:61], v[10:11], v[12:13]
    v_pk_fma_f32 v[62:63], v[62:63], v[10:11], v[12:13]
    v_cvt_pk_bf16_f32 v76, v56, v57
    v_cvt_pk_bf16_f32 v77, v58, v59
    v_cvt_pk_bf16_f32 v78, v60, v61
    v_cvt_pk_bf16_f32 v79, v62, v63
    ds_write_b128 v9, v[76:79] offset:5120
    v_pk_fma_f32 v[64:65], v[64:65], v[10:11], v[12:13]
    v_pk_fma_f32 v[66:67], v[66:67], v[10:11], v[12:13]
    v_pk_fma_f32 v[68:69], v[68:69], v[10:11], v[12:13]
    v_pk_fma_f32 v[70:71], v[70:71], v[10:11], v[12:13]
    v_cvt_pk_bf16_f32 v80, v64, v65
    v_cvt_pk_bf16_f32 v81, v66, v67
    v_cvt_pk_bf16_f32 v82, v68, v69
    v_cvt_pk_bf16_f32 v83, v70, v71
    ds_write_b128 v9, v[80:83] offset:6144
    s_waitcnt lgkmcnt(0)
    s_barrier
    s_lshr_b32 s27, s24, 1
    s_lshl_b32 s27, s27, 10
    s_mul_i32 s28, s21, 114688
    s_add_u32 s28, s28, s27
    s_add_u32 s28, s28, 101711872
    v_mov_b32 v32, 0
    v_mov_b32 v33, 0
    v_mov_b32 v34, 0
    v_mov_b32 v35, 0
    v_mov_b32 v36, 0
    v_mov_b32 v37, 0
    v_mov_b32 v38, 0
    v_mov_b32 v39, 0
    v_mov_b32 v40, 0
    v_mov_b32 v41, 0
    v_mov_b32 v42, 0
    v_mov_b32 v43, 0
    v_mov_b32 v44, 0
    v_mov_b32 v45, 0
    v_mov_b32 v46, 0
    v_mov_b32 v47, 0
    v_mov_b32 v48, 0
    v_mov_b32 v49, 0
    v_mov_b32 v50, 0
    v_mov_b32 v51, 0
    v_mov_b32 v52, 0
    v_mov_b32 v53, 0
    v_mov_b32 v54, 0
    v_mov_b32 v55, 0
    v_mov_b32 v56, 0
    v_mov_b32 v57, 0
    v_mov_b32 v58, 0
    v_mov_b32 v59, 0
    v_mov_b32 v60, 0
    v_mov_b32 v61, 0
    v_mov_b32 v62, 0
    v_mov_b32 v63, 0
    ds_read_b128 v[8:11], v2 offset:0
    ds_read_b128 v[12:15], v2 offset:14336
    ds_read_b128 v[16:19], v2 offset:1024
    ds_read_b128 v[20:23], v2 offset:15360
    s_waitcnt lgkmcnt(2)
    v_mfma_f32_16x16x32_bf16 v[32:35], a[0:3], v[8:11], v[32:35]
    v_mfma_f32_16x16x32_bf16 v[36:39], a[0:3], v[12:15], v[36:39]
    v_mfma_f32_16x16x32_bf16 v[40:43], a[56:59], v[8:11], v[40:43]
    v_mfma_f32_16x16x32_bf16 v[44:47], a[56:59], v[12:15], v[44:47]
    v_mfma_f32_16x16x32_bf16 v[48:51], a[112:115], v[8:11], v[48:51]
    v_mfma_f32_16x16x32_bf16 v[52:55], a[112:115], v[12:15], v[52:55]
    v_mfma_f32_16x16x32_bf16 v[56:59], a[168:171], v[8:11], v[56:59]
    v_mfma_f32_16x16x32_bf16 v[60:63], a[168:171], v[12:15], v[60:63]
    ds_read_b128 v[8:11], v2 offset:2048
    ds_read_b128 v[12:15], v2 offset:16384
    s_waitcnt lgkmcnt(2)
    v_mfma_f32_16x16x32_bf16 v[32:35], a[4:7], v[16:19], v[32:35]
    v_mfma_f32_16x16x32_bf16 v[36:39], a[4:7], v[20:23], v[36:39]
    v_mfma_f32_16x16x32_bf16 v[40:43], a[60:63], v[16:19], v[40:43]
    v_mfma_f32_16x16x32_bf16 v[44:47], a[60:63], v[20:23], v[44:47]
    v_mfma_f32_16x16x32_bf16 v[48:51], a[116:119], v[16:19], v[48:51]
    v_mfma_f32_16x16x32_bf16 v[52:55], a[116:119], v[20:23], v[52:55]
    v_mfma_f32_16x16x32_bf16 v[56:59], a[172:175], v[16:19], v[56:59]
    v_mfma_f32_16x16x32_bf16 v[60:63], a[172:175], v[20:23], v[60:63]
    ds_read_b128 v[16:19], v2 offset:3072
    ds_read_b128 v[20:23], v2 offset:17408
    s_waitcnt lgkmcnt(2)
    v_mfma_f32_16x16x32_bf16 v[32:35], a[8:11], v[8:11], v[32:35]
    v_mfma_f32_16x16x32_bf16 v[36:39], a[8:11], v[12:15], v[36:39]
    v_mfma_f32_16x16x32_bf16 v[40:43], a[64:67], v[8:11], v[40:43]
    v_mfma_f32_16x16x32_bf16 v[44:47], a[64:67], v[12:15], v[44:47]
    v_mfma_f32_16x16x32_bf16 v[48:51], a[120:123], v[8:11], v[48:51]
    v_mfma_f32_16x16x32_bf16 v[52:55], a[120:123], v[12:15], v[52:55]
    v_mfma_f32_16x16x32_bf16 v[56:59], a[176:179], v[8:11], v[56:59]
    v_mfma_f32_16x16x32_bf16 v[60:63], a[176:179], v[12:15], v[60:63]
    ds_read_b128 v[8:11], v2 offset:4096
    ds_read_b128 v[12:15], v2 offset:18432
    s_waitcnt lgkmcnt(2)
    v_mfma_f32_16x16x32_bf16 v[32:35], a[12:15], v[16:19], v[32:35]
    v_mfma_f32_16x16x32_bf16 v[36:39], a[12:15], v[20:23], v[36:39]
    v_mfma_f32_16x16x32_bf16 v[40:43], a[68:71], v[16:19], v[40:43]
    v_mfma_f32_16x16x32_bf16 v[44:47], a[68:71], v[20:23], v[44:47]
    v_mfma_f32_16x16x32_bf16 v[48:51], a[124:127], v[16:19], v[48:51]
    v_mfma_f32_16x16x32_bf16 v[52:55], a[124:127], v[20:23], v[52:55]
    v_mfma_f32_16x16x32_bf16 v[56:59], a[180:183], v[16:19], v[56:59]
    v_mfma_f32_16x16x32_bf16 v[60:63], a[180:183], v[20:23], v[60:63]
    ds_read_b128 v[16:19], v2 offset:5120
    ds_read_b128 v[20:23], v2 offset:19456
    s_waitcnt lgkmcnt(2)
    v_mfma_f32_16x16x32_bf16 v[32:35], a[16:19], v[8:11], v[32:35]
    v_mfma_f32_16x16x32_bf16 v[36:39], a[16:19], v[12:15], v[36:39]
    v_mfma_f32_16x16x32_bf16 v[40:43], a[72:75], v[8:11], v[40:43]
    v_mfma_f32_16x16x32_bf16 v[44:47], a[72:75], v[12:15], v[44:47]
    v_mfma_f32_16x16x32_bf16 v[48:51], a[128:131], v[8:11], v[48:51]
    v_mfma_f32_16x16x32_bf16 v[52:55], a[128:131], v[12:15], v[52:55]
    v_mfma_f32_16x16x32_bf16 v[56:59], a[184:187], v[8:11], v[56:59]
    v_mfma_f32_16x16x32_bf16 v[60:63], a[184:187], v[12:15], v[60:63]
    ds_read_b128 v[8:11], v2 offset:6144
    ds_read_b128 v[12:15], v2 offset:20480
    s_waitcnt lgkmcnt(2)
    v_mfma_f32_16x16x32_bf16 v[32:35], a[20:23], v[16:19], v[32:35]
    v_mfma_f32_16x16x32_bf16 v[36:39], a[20:23], v[20:23], v[36:39]
    v_mfma_f32_16x16x32_bf16 v[40:43], a[76:79], v[16:19], v[40:43]
    v_mfma_f32_16x16x32_bf16 v[44:47], a[76:79], v[20:23], v[44:47]
    v_mfma_f32_16x16x32_bf16 v[48:51], a[132:135], v[16:19], v[48:51]
    v_mfma_f32_16x16x32_bf16 v[52:55], a[132:135], v[20:23], v[52:55]
    v_mfma_f32_16x16x32_bf16 v[56:59], a[188:191], v[16:19], v[56:59]
    v_mfma_f32_16x16x32_bf16 v[60:63], a[188:191], v[20:23], v[60:63]
    ds_read_b128 v[16:19], v2 offset:7168
    ds_read_b128 v[20:23], v2 offset:21504
    s_waitcnt lgkmcnt(2)
    v_mfma_f32_16x16x32_bf16 v[32:35], a[24:27], v[8:11], v[32:35]
    v_mfma_f32_16x16x32_bf16 v[36:39], a[24:27], v[12:15], v[36:39]
    v_mfma_f32_16x16x32_bf16 v[40:43], a[80:83], v[8:11], v[40:43]
    v_mfma_f32_16x16x32_bf16 v[44:47], a[80:83], v[12:15], v[44:47]
    v_mfma_f32_16x16x32_bf16 v[48:51], a[136:139], v[8:11], v[48:51]
    v_mfma_f32_16x16x32_bf16 v[52:55], a[136:139], v[12:15], v[52:55]
    v_mfma_f32_16x16x32_bf16 v[56:59], a[192:195], v[8:11], v[56:59]
    v_mfma_f32_16x16x32_bf16 v[60:63], a[192:195], v[12:15], v[60:63]
    ds_read_b128 v[8:11], v2 offset:8192
    ds_read_b128 v[12:15], v2 offset:22528
    s_waitcnt lgkmcnt(2)
    v_mfma_f32_16x16x32_bf16 v[32:35], a[28:31], v[16:19], v[32:35]
    v_mfma_f32_16x16x32_bf16 v[36:39], a[28:31], v[20:23], v[36:39]
    v_mfma_f32_16x16x32_bf16 v[40:43], a[84:87], v[16:19], v[40:43]
    v_mfma_f32_16x16x32_bf16 v[44:47], a[84:87], v[20:23], v[44:47]
    v_mfma_f32_16x16x32_bf16 v[48:51], a[140:143], v[16:19], v[48:51]
    v_mfma_f32_16x16x32_bf16 v[52:55], a[140:143], v[20:23], v[52:55]
    v_mfma_f32_16x16x32_bf16 v[56:59], a[196:199], v[16:19], v[56:59]
    v_mfma_f32_16x16x32_bf16 v[60:63], a[196:199], v[20:23], v[60:63]
    ds_read_b128 v[16:19], v2 offset:9216
    ds_read_b128 v[20:23], v2 offset:23552
    s_waitcnt lgkmcnt(2)
    v_mfma_f32_16x16x32_bf16 v[32:35], a[32:35], v[8:11], v[32:35]
    v_mfma_f32_16x16x32_bf16 v[36:39], a[32:35], v[12:15], v[36:39]
    v_mfma_f32_16x16x32_bf16 v[40:43], a[88:91], v[8:11], v[40:43]
    v_mfma_f32_16x16x32_bf16 v[44:47], a[88:91], v[12:15], v[44:47]
    v_mfma_f32_16x16x32_bf16 v[48:51], a[144:147], v[8:11], v[48:51]
    v_mfma_f32_16x16x32_bf16 v[52:55], a[144:147], v[12:15], v[52:55]
    v_mfma_f32_16x16x32_bf16 v[56:59], a[200:203], v[8:11], v[56:59]
    v_mfma_f32_16x16x32_bf16 v[60:63], a[200:203], v[12:15], v[60:63]
    ds_read_b128 v[8:11], v2 offset:10240
    ds_read_b128 v[12:15], v2 offset:24576
    s_waitcnt lgkmcnt(2)
    v_mfma_f32_16x16x32_bf16 v[32:35], a[36:39], v[16:19], v[32:35]
    v_mfma_f32_16x16x32_bf16 v[36:39], a[36:39], v[20:23], v[36:39]
    v_mfma_f32_16x16x32_bf16 v[40:43], a[92:95], v[16:19], v[40:43]
    v_mfma_f32_16x16x32_bf16 v[44:47], a[92:95], v[20:23], v[44:47]
    v_mfma_f32_16x16x32_bf16 v[48:51], a[148:151], v[16:19], v[48:51]
    v_mfma_f32_16x16x32_bf16 v[52:55], a[148:151], v[20:23], v[52:55]
    v_mfma_f32_16x16x32_bf16 v[56:59], a[204:207], v[16:19], v[56:59]
    v_mfma_f32_16x16x32_bf16 v[60:63], a[204:207], v[20:23], v[60:63]
    ds_read_b128 v[16:19], v2 offset:11264
    ds_read_b128 v[20:23], v2 offset:25600
    s_waitcnt lgkmcnt(2)
    v_mfma_f32_16x16x32_bf16 v[32:35], a[40:43], v[8:11], v[32:35]
    v_mfma_f32_16x16x32_bf16 v[36:39], a[40:43], v[12:15], v[36:39]
    v_mfma_f32_16x16x32_bf16 v[40:43], a[96:99], v[8:11], v[40:43]
    v_mfma_f32_16x16x32_bf16 v[44:47], a[96:99], v[12:15], v[44:47]
    v_mfma_f32_16x16x32_bf16 v[48:51], a[152:155], v[8:11], v[48:51]
    v_mfma_f32_16x16x32_bf16 v[52:55], a[152:155], v[12:15], v[52:55]
    v_mfma_f32_16x16x32_bf16 v[56:59], a[208:211], v[8:11], v[56:59]
    v_mfma_f32_16x16x32_bf16 v[60:63], a[208:211], v[12:15], v[60:63]
    ds_read_b128 v[8:11], v2 offset:12288
    ds_read_b128 v[12:15], v2 offset:26624
    s_waitcnt lgkmcnt(2)
    v_mfma_f32_16x16x32_bf16 v[32:35], a[44:47], v[16:19], v[32:35]
    v_mfma_f32_16x16x32_bf16 v[36:39], a[44:47], v[20:23], v[36:39]
    v_mfma_f32_16x16x32_bf16 v[40:43], a[100:103], v[16:19], v[40:43]
    v_mfma_f32_16x16x32_bf16 v[44:47], a[100:103], v[20:23], v[44:47]
    v_mfma_f32_16x16x32_bf16 v[48:51], a[156:159], v[16:19], v[48:51]
    v_mfma_f32_16x16x32_bf16 v[52:55], a[156:159], v[20:23], v[52:55]
    v_mfma_f32_16x16x32_bf16 v[56:59], a[212:215], v[16:19], v[56:59]
    v_mfma_f32_16x16x32_bf16 v[60:63], a[212:215], v[20:23], v[60:63]
    ds_read_b128 v[16:19], v2 offset:13312
    ds_read_b128 v[20:23], v2 offset:27648
    s_waitcnt lgkmcnt(2)
    v_mfma_f32_16x16x32_bf16 v[32:35], a[48:51], v[8:11], v[32:35]
    v_mfma_f32_16x16x32_bf16 v[36:39], a[48:51], v[12:15], v[36:39]
    v_mfma_f32_16x16x32_bf16 v[40:43], a[104:107], v[8:11], v[40:43]
    v_mfma_f32_16x16x32_bf16 v[44:47], a[104:107], v[12:15], v[44:47]
    v_mfma_f32_16x16x32_bf16 v[48:51], a[160:163], v[8:11], v[48:51]
    v_mfma_f32_16x16x32_bf16 v[52:55], a[160:163], v[12:15], v[52:55]
    v_mfma_f32_16x16x32_bf16 v[56:59], a[216:219], v[8:11], v[56:59]
    v_mfma_f32_16x16x32_bf16 v[60:63], a[216:219], v[12:15], v[60:63]
    s_waitcnt lgkmcnt(0)
    v_mfma_f32_16x16x32_bf16 v[32:35], a[52:55], v[16:19], v[32:35]
    v_mfma_f32_16x16x32_bf16 v[36:39], a[52:55], v[20:23], v[36:39]
    v_mfma_f32_16x16x32_bf16 v[40:43], a[108:111], v[16:19], v[40:43]
    v_mfma_f32_16x16x32_bf16 v[44:47], a[108:111], v[20:23], v[44:47]
    v_mfma_f32_16x16x32_bf16 v[48:51], a[164:167], v[16:19], v[48:51]
    v_mfma_f32_16x16x32_bf16 v[52:55], a[164:167], v[20:23], v[52:55]
    v_mfma_f32_16x16x32_bf16 v[56:59], a[220:223], v[16:19], v[56:59]
    v_mfma_f32_16x16x32_bf16 v[60:63], a[220:223], v[20:23], v[60:63]
    s_nop 0
    v_pk_add_f32 v[32:33], v[32:33], v[200:201]
    v_pk_add_f32 v[34:35], v[34:35], v[202:203]
    v_max_f32 v32, 0, v32
    v_max_f32 v33, 0, v33
    v_max_f32 v34, 0, v34
    v_max_f32 v35, 0, v35
    v_pk_mul_f32 v[32:33], v[32:33], v[32:33]
    v_pk_mul_f32 v[34:35], v[34:35], v[34:35]
    v_cvt_pk_bf16_f32 v64, v32, v33
    v_cvt_pk_bf16_f32 v65, v34, v35
    v_pk_add_f32 v[40:41], v[40:41], v[204:205]
    v_pk_add_f32 v[42:43], v[42:43], v[206:207]
    v_max_f32 v40, 0, v40
    v_max_f32 v41, 0, v41
    v_max_f32 v42, 0, v42
    v_max_f32 v43, 0, v43
    v_pk_mul_f32 v[40:41], v[40:41], v[40:41]
    v_pk_mul_f32 v[42:43], v[42:43], v[42:43]
    v_cvt_pk_bf16_f32 v66, v40, v41
    v_cvt_pk_bf16_f32 v67, v42, v43
    buffer_store_dwordx4 v[64:67], v2, s[8:11], s28 offen offset:0 sc1
    v_pk_add_f32 v[48:49], v[48:49], v[208:209]
    v_pk_add_f32 v[50:51], v[50:51], v[210:211]
    v_max_f32 v48, 0, v48
    v_max_f32 v49, 0, v49
    v_max_f32 v50, 0, v50
    v_max_f32 v51, 0, v51
    v_pk_mul_f32 v[48:49], v[48:49], v[48:49]
    v_pk_mul_f32 v[50:51], v[50:51], v[50:51]
    v_cvt_pk_bf16_f32 v68, v48, v49
    v_cvt_pk_bf16_f32 v69, v50, v51
    v_pk_add_f32 v[56:57], v[56:57], v[212:213]
    v_pk_add_f32 v[58:59], v[58:59], v[214:215]
    v_max_f32 v56, 0, v56
    v_max_f32 v57, 0, v57
    v_max_f32 v58, 0, v58
    v_max_f32 v59, 0, v59
    v_pk_mul_f32 v[56:57], v[56:57], v[56:57]
    v_pk_mul_f32 v[58:59], v[58:59], v[58:59]
    v_cvt_pk_bf16_f32 v70, v56, v57
    v_cvt_pk_bf16_f32 v71, v58, v59
    buffer_store_dwordx4 v[68:71], v2, s[8:11], s28 offen offset:1024 sc1
    s_add_u32 s28, s28, 57344
    v_pk_add_f32 v[36:37], v[36:37], v[200:201]
    v_pk_add_f32 v[38:39], v[38:39], v[202:203]
    v_max_f32 v36, 0, v36
    v_max_f32 v37, 0, v37
    v_max_f32 v38, 0, v38
    v_max_f32 v39, 0, v39
    v_pk_mul_f32 v[36:37], v[36:37], v[36:37]
    v_pk_mul_f32 v[38:39], v[38:39], v[38:39]
    v_cvt_pk_bf16_f32 v72, v36, v37
    v_cvt_pk_bf16_f32 v73, v38, v39
    v_pk_add_f32 v[44:45], v[44:45], v[204:205]
    v_pk_add_f32 v[46:47], v[46:47], v[206:207]
    v_max_f32 v44, 0, v44
    v_max_f32 v45, 0, v45
    v_max_f32 v46, 0, v46
    v_max_f32 v47, 0, v47
    v_pk_mul_f32 v[44:45], v[44:45], v[44:45]
    v_pk_mul_f32 v[46:47], v[46:47], v[46:47]
    v_cvt_pk_bf16_f32 v74, v44, v45
    v_cvt_pk_bf16_f32 v75, v46, v47
    buffer_store_dwordx4 v[72:75], v2, s[8:11], s28 offen offset:0 sc1
    v_pk_add_f32 v[52:53], v[52:53], v[208:209]
    v_pk_add_f32 v[54:55], v[54:55], v[210:211]
    v_max_f32 v52, 0, v52
    v_max_f32 v53, 0, v53
    v_max_f32 v54, 0, v54
    v_max_f32 v55, 0, v55
    v_pk_mul_f32 v[52:53], v[52:53], v[52:53]
    v_pk_mul_f32 v[54:55], v[54:55], v[54:55]
    v_cvt_pk_bf16_f32 v76, v52, v53
    v_cvt_pk_bf16_f32 v77, v54, v55
    v_pk_add_f32 v[60:61], v[60:61], v[212:213]
    v_pk_add_f32 v[62:63], v[62:63], v[214:215]
    v_max_f32 v60, 0, v60
    v_max_f32 v61, 0, v61
    v_max_f32 v62, 0, v62
    v_max_f32 v63, 0, v63
    v_pk_mul_f32 v[60:61], v[60:61], v[60:61]
    v_pk_mul_f32 v[62:63], v[62:63], v[62:63]
    v_cvt_pk_bf16_f32 v78, v60, v61
    v_cvt_pk_bf16_f32 v79, v62, v63
    buffer_store_dwordx4 v[76:79], v2, s[8:11], s28 offen offset:1024 sc1
    s_add_u32 s28, s28, 57344
    s_lshl_b32 s87, s21, 7
    s_add_u32 s87, s87, 112230400
    s_waitcnt vmcnt(0)
    s_barrier
    s_cmp_lg_u32 s18, 0
    s_cbranch_scc1 F1S_S
    v_mov_b32 v10, 0
    v_mov_b32 v9, 1
    s_mov_b64 exec, 1
    buffer_atomic_add v9, v10, s[8:11], s87 offen
    s_mov_b64 exec, -1
F1S_S:
    s_branch BK_NEXT
BK_ATT:
    s_lshl_b32 s85, s82, 3
    s_add_u32 s85, s85, s83
    v_lshlrev_b32 v2, 4, v1
    v_and_b32 v3, 15, v1
    v_lshrrev_b32 v4, 4, v1
    s_lshr_b32 s20, s85, 2
    s_and_b32 s27, s85, 3
    s_lshl_b32 s88, s20, 7
    s_add_u32 s87, s88, 112205824
    s_cmp_lg_u32 s18, 0
    s_cbranch_scc1 ATT_W
    v_mov_b32 v189, 0
    s_nop 1
ATT_P:
    buffer_load_dword v188, v189, s[8:11], s87 offen sc1
    s_waitcnt vmcnt(0)
    v_readfirstlane_b32 s86, v188
    s_nop 0
    s_cmp_ge_u32 s86, 28
    s_nop 2
    s_cbranch_scc1 ATT_W
    s_sleep 4
    s_sub_u32 s84, s84, 1
    s_cbranch_scc0 ATT_P
    s_mov_b32 s84, 0
ATT_W:
    s_mov_b32 s87, 112256896
    s_cmp_lg_u32 s18, 0
    s_cbranch_scc1 ATZ_W
    v_mov_b32 v189, 0
    s_nop 1
ATZ_P:
    buffer_load_dword v188, v189, s[8:11], s87 offen sc1
    s_waitcnt vmcnt(0)
    v_readfirstlane_b32 s86, v188
    s_nop 0
    s_cmp_ge_u32 s86, 32
    s_nop 2
    s_cbranch_scc1 ATZ_W
    s_sleep 4
    s_sub_u32 s84, s84, 1
    s_cbranch_scc0 ATZ_P
    s_mov_b32 s84, 0
ATZ_W:
    s_add_u32 s87, s88, 112197632
    s_cmp_lg_u32 s18, 0
    s_cbranch_scc1 ATD_W
    v_mov_b32 v189, 0
    s_nop 1
ATD_P:
    buffer_load_dword v188, v189, s[8:11], s87 offen sc1
    s_waitcnt vmcnt(0)
    v_readfirstlane_b32 s86, v188
    s_nop 0
    s_cmp_ge_u32 s86, 28
    s_nop 2
    s_cbranch_scc1 ATD_W
    s_sleep 4
    s_sub_u32 s84, s84, 1
    s_cbranch_scc0 ATD_P
    s_mov_b32 s84, 0
ATD_W:
    s_barrier
    s_mul_i32 s21, s20, 28672
    s_mul_i32 s22, s18, 7168
    s_add_u32 s21, s21, s22
    s_add_u32 s21, s21, 58720256
    s_add_u32 m0, s22, 0
    s_add_u32 s23, s21, 0
    buffer_load_dwordx4 v2, s[8:11], s23 offen offset:0 lds
    buffer_load_dwordx4 v2, s[8:11], s23 offen offset:1024 lds
    buffer_load_dwordx4 v2, s[8:11], s23 offen offset:2048 lds
    buffer_load_dwordx4 v2, s[8:11], s23 offen offset:3072 lds
    s_add_u32 m0, s22, 4096
    s_add_u32 s23, s21, 4096
    buffer_load_dwordx4 v2, s[8:11], s23 offen offset:0 lds
    buffer_load_dwordx4 v2, s[8:11], s23 offen offset:1024 lds
    buffer_load_dwordx4 v2, s[8:11], s23 offen offset:2048 lds
    s_lshl_b32 s24, s27, 2
    s_add_u32 s24, s24, s18
    s_mul_i32 s24, s24, 1835008
    s_mul_i32 s25, s20, 28672
    s_add_u32 s24, s24, s25
    s_add_u32 s28, s24, 60817408
    buffer_load_dwordx4 a[0:3], v2, s[8:11], s28 offen offset:0 sc1
    buffer_load_dwordx4 a[4:7], v2, s[8:11], s28 offen offset:1024 sc1
    buffer_load_dwordx4 a[8:11], v2, s[8:11], s28 offen offset:2048 sc1
    buffer_load_dwordx4 a[12:15], v2, s[8:11], s28 offen offset:3072 sc1
    s_add_u32 s28, s28, 4096
    buffer_load_dwordx4 a[16:19], v2, s[8:11], s28 offen offset:0 sc1
    buffer_load_dwordx4 a[20:23], v2, s[8:11], s28 offen offset:1024 sc1
    buffer_load_dwordx4 a[24:27], v2, s[8:11], s28 offen offset:2048 sc1
    buffer_load_dwordx4 a[28:31], v2, s[8:11], s28 offen offset:3072 sc1
    s_add_u32 s28, s28, 4096
    buffer_load_dwordx4 a[32:35], v2, s[8:11], s28 offen offset:0 sc1
    buffer_load_dwordx4 a[36:39], v2, s[8:11], s28 offen offset:1024 sc1
    buffer_load_dwordx4 a[40:43], v2, s[8:11], s28 offen offset:2048 sc1
    buffer_load_dwordx4 a[44:47], v2, s[8:11], s28 offen offset:3072 sc1
    s_add_u32 s28, s28, 4096
    buffer_load_dwordx4 a[48:51], v2, s[8:11], s28 offen offset:0 sc1
    buffer_load_dwordx4 a[52:55], v2, s[8:11], s28 offen offset:1024 sc1
    buffer_load_dwordx4 a[56:59], v2, s[8:11], s28 offen offset:2048 sc1
    buffer_load_dwordx4 a[60:63], v2, s[8:11], s28 offen offset:3072 sc1
    s_add_u32 s28, s28, 4096
    buffer_load_dwordx4 a[64:67], v2, s[8:11], s28 offen offset:0 sc1
    buffer_load_dwordx4 a[68:71], v2, s[8:11], s28 offen offset:1024 sc1
    buffer_load_dwordx4 a[72:75], v2, s[8:11], s28 offen offset:2048 sc1
    buffer_load_dwordx4 a[76:79], v2, s[8:11], s28 offen offset:3072 sc1
    s_add_u32 s28, s28, 4096
    buffer_load_dwordx4 a[80:83], v2, s[8:11], s28 offen offset:0 sc1
    buffer_load_dwordx4 a[84:87], v2, s[8:11], s28 offen offset:1024 sc1
    buffer_load_dwordx4 a[88:91], v2, s[8:11], s28 offen offset:2048 sc1
    buffer_load_dwordx4 a[92:95], v2, s[8:11], s28 offen offset:3072 sc1
    s_add_u32 s28, s28, 4096
    buffer_load_dwordx4 a[96:99], v2, s[8:11], s28 offen offset:0 sc1
    buffer_load_dwordx4 a[100:103], v2, s[8:11], s28 offen offset:1024 sc1
    buffer_load_dwordx4 a[104:107], v2, s[8:11], s28 offen offset:2048 sc1
    buffer_load_dwordx4 a[108:111], v2, s[8:11], s28 offen offset:3072 sc1
    s_add_u32 s28, s28, 4096
    s_mul_i32 s25, s20, 458752
    s_add_u32 s25, s25, 17825792
    s_mul_i32 s26, s20, 114688
    s_add_u32 s26, s26, 48234496
    s_mul_i32 s29, s18, 7
    s_add_u32 s29, s29, 0
    s_lshr_b32 s30, s29, 1
    s_and_b32 s31, s29, 1
    s_lshl_b32 s32, s30, 5
    s_add_u32 s32, s32, s31
    s_lshl_b32 s33, s27, 3
    s_add_u32 s32, s32, s33
    s_lshl_b32 s32, s32, 10
    s_add_u32 s32, s32, s25
    s_add_u32 s34, s32, 4096
    buffer_load_dwordx4 a[112:115], v2, s[8:11], s32 offen offset:0 sc1
    buffer_load_dwordx4 a[140:143], v2, s[8:11], s32 offen offset:2048 sc1
    buffer_load_dwordx4 a[168:171], v2, s[8:11], s34 offen offset:0 sc1
    buffer_load_dwordx4 a[196:199], v2, s[8:11], s34 offen offset:2048 sc1
    s_mul_i32 s29, s18, 7
    s_add_u32 s29, s29, 1
    s_lshr_b32 s30, s29, 1
    s_and_b32 s31, s29, 1
    s_lshl_b32 s32, s30, 5
    s_add_u32 s32, s32, s31
    s_lshl_b32 s33, s27, 3
    s_add_u32 s32, s32, s33
    s_lshl_b32 s32, s32, 10
    s_add_u32 s32, s32, s25
    s_add_u32 s34, s32, 4096
    buffer_load_dwordx4 a[116:119], v2, s[8:11], s32 offen offset:0 sc1
    buffer_load_dwordx4 a[144:147], v2, s[8:11], s32 offen offset:2048 sc1
    buffer_load_dwordx4 a[172:175], v2, s[8:11], s34 offen offset:0 sc1
    buffer_load_dwordx4 a[200:203], v2, s[8:11], s34 offen offset:2048 sc1
    s_mul_i32 s29, s18, 7
    s_add_u32 s29, s29, 2
    s_lshr_b32 s30, s29, 1
    s_and_b32 s31, s29, 1
    s_lshl_b32 s32, s30, 5
    s_add_u32 s32, s32, s31
    s_lshl_b32 s33, s27, 3
    s_add_u32 s32, s32, s33
    s_lshl_b32 s32, s32, 10
    s_add_u32 s32, s32, s25
    s_add_u32 s34, s32, 4096
    buffer_load_dwordx4 a[120:123], v2, s[8:11], s32 offen offset:0 sc1
    buffer_load_dwordx4 a[148:151], v2, s[8:11], s32 offen offset:2048 sc1
    buffer_load_dwordx4 a[176:179], v2, s[8:11], s34 offen offset:0 sc1
    buffer_load_dwordx4 a[204:207], v2, s[8:11], s34 offen offset:2048 sc1
    s_mul_i32 s29, s18, 7
    s_add_u32 s29, s29, 3
    s_lshr_b32 s30, s29, 1
    s_and_b32 s31, s29, 1
    s_lshl_b32 s32, s30, 5
    s_add_u32 s32, s32, s31
    s_lshl_b32 s33, s27, 3
    s_add_u32 s32, s32, s33
    s_lshl_b32 s32, s32, 10
    s_add_u32 s32, s32, s25
    s_add_u32 s34, s32, 4096
    buffer_load_dwordx4 a[124:127], v2, s[8:11], s32 offen offset:0 sc1
    buffer_load_dwordx4 a[152:155], v2, s[8:11], s32 offen offset:2048 sc1
    buffer_load_dwordx4 a[180:183], v2, s[8:11], s34 offen offset:0 sc1
    buffer_load_dwordx4 a[208:211], v2, s[8:11], s34 offen offset:2048 sc1
    s_mul_i32 s29, s18, 7
    s_add_u32 s29, s29, 4
    s_lshr_b32 s30, s29, 1
    s_and_b32 s31, s29, 1
    s_lshl_b32 s32, s30, 5
    s_add_u32 s32, s32, s31
    s_lshl_b32 s33, s27, 3
    s_add_u32 s32, s32, s33
    s_lshl_b32 s32, s32, 10
    s_add_u32 s32, s32, s25
    s_add_u32 s34, s32, 4096
    buffer_load_dwordx4 a[128:131], v2, s[8:11], s32 offen offset:0 sc1
    buffer_load_dwordx4 a[156:159], v2, s[8:11], s32 offen offset:2048 sc1
    buffer_load_dwordx4 a[184:187], v2, s[8:11], s34 offen offset:0 sc1
    buffer_load_dwordx4 a[212:215], v2, s[8:11], s34 offen offset:2048 sc1
    s_mul_i32 s29, s18, 7
    s_add_u32 s29, s29, 5
    s_lshr_b32 s30, s29, 1
    s_and_b32 s31, s29, 1
    s_lshl_b32 s32, s30, 5
    s_add_u32 s32, s32, s31
    s_lshl_b32 s33, s27, 3
    s_add_u32 s32, s32, s33
    s_lshl_b32 s32, s32, 10
    s_add_u32 s32, s32, s25
    s_add_u32 s34, s32, 4096
    buffer_load_dwordx4 a[132:135], v2, s[8:11], s32 offen offset:0 sc1
    buffer_load_dwordx4 a[160:163], v2, s[8:11], s32 offen offset:2048 sc1
    buffer_load_dwordx4 a[188:191], v2, s[8:11], s34 offen offset:0 sc1
    buffer_load_dwordx4 a[216:219], v2, s[8:11], s34 offen offset:2048 sc1
    s_mul_i32 s29, s18, 7
    s_add_u32 s29, s29, 6
    s_lshr_b32 s30, s29, 1
    s_and_b32 s31, s29, 1
    s_lshl_b32 s32, s30, 5
    s_add_u32 s32, s32, s31
    s_lshl_b32 s33, s27, 3
    s_add_u32 s32, s32, s33
    s_lshl_b32 s32, s32, 10
    s_add_u32 s32, s32, s25
    s_add_u32 s34, s32, 4096
    buffer_load_dwordx4 a[136:139], v2, s[8:11], s32 offen offset:0 sc1
    buffer_load_dwordx4 a[164:167], v2, s[8:11], s32 offen offset:2048 sc1
    buffer_load_dwordx4 a[192:195], v2, s[8:11], s34 offen offset:0 sc1
    buffer_load_dwordx4 a[220:223], v2, s[8:11], s34 offen offset:2048 sc1
    v_lshrrev_b32 v9, 1, v4
    v_lshlrev_b32 v9, 7, v9
    v_and_b32 v10, 7, v1
    v_lshl_add_u32 v9, v10, 4, v9
    v_and_b32 v10, 1, v4
    v_lshl_add_u32 v9, v10, 3, v9
    v_add_u32 v5, 28672, v9
    s_lshl_b32 s22, s18, 11
    s_add_u32 s22, s22, 36864
    v_add_u32 v6, s22, v2
    s_lshl_b32 s22, s18, 10
    s_add_u32 s22, s22, 45056
    v_lshlrev_b32 v9, 3, v1
    v_add_u32 v7, s22, v9
    v_lshrrev_b32 v10, 1, v4
    v_lshl_add_u32 v8, v10, 10, v9
    v_add_u32 v8, 45056, v8
    v_lshlrev_b32 v9, 2, v4
    v_add_u32 v10, 0, v9
    v_cmp_le_u32 s[40:41], v10, v3
    v_add_u32 v10, 1, v9
    v_cmp_le_u32 s[42:43], v10, v3
    v_add_u32 v10, 2, v9
    v_cmp_le_u32 s[44:45], v10, v3
    v_add_u32 v10, 3, v9
    v_cmp_le_u32 s[46:47], v10, v3
    v_mov_b32 v64, 0
    v_mov_b32 v65, 0
    v_mov_b32 v66, 0
    v_mov_b32 v67, 0
    v_mov_b32 v68, 0
    v_mov_b32 v69, 0
    v_mov_b32 v70, 0
    v_mov_b32 v71, 0
    v_mov_b32 v72, 0
    v_mov_b32 v73, 0
    v_mov_b32 v74, 0
    v_mov_b32 v75, 0
    v_mov_b32 v76, 0
    v_mov_b32 v77, 0
    v_mov_b32 v78, 0
    v_mov_b32 v79, 0
    v_mov_b32 v80, 0
    v_mov_b32 v81, 0
    v_mov_b32 v82, 0
    v_mov_b32 v83, 0
    v_mov_b32 v84, 0
    v_mov_b32 v85, 0
    v_mov_b32 v86, 0
    v_mov_b32 v87, 0
    v_mov_b32 v88, 0
    v_mov_b32 v89, 0
    v_mov_b32 v90, 0
    v_mov_b32 v91, 0
    v_mov_b32 v92, 0
    v_mov_b32 v93, 0
    v_mov_b32 v94, 0
    v_mov_b32 v95, 0
    v_mov_b32 v96, 0
    v_mov_b32 v97, 0
    v_mov_b32 v98, 0
    v_mov_b32 v99, 0
    v_mov_b32 v100, 0
    v_mov_b32 v101, 0
    v_mov_b32 v102, 0
    v_mov_b32 v103, 0
    v_mov_b32 v104, 0
    v_mov_b32 v105, 0
    v_mov_b32 v106, 0
    v_mov_b32 v107, 0
    v_mov_b32 v108, 0
    v_mov_b32 v109, 0
    v_mov_b32 v110, 0
    v_mov_b32 v111, 0
    v_mov_b32 v112, 0
    v_mov_b32 v113, 0
    v_mov_b32 v114, 0
    v_mov_b32 v115, 0
    v_mov_b32 v116, 0
    v_mov_b32 v117, 0
    v_mov_b32 v118, 0
    v_mov_b32 v119, 0
    v_mov_b32 v40, 0
    v_mov_b32 v41, 0
    v_mov_b32 v42, 0
    v_mov_b32 v43, 0
    v_mov_b32 v44, 0
    v_mov_b32 v45, 0
    v_mov_b32 v46, 0
    v_mov_b32 v47, 0
    v_mov_b32 v48, 0
    v_mov_b32 v49, 0
    v_mov_b32 v50, 0
    v_mov_b32 v51, 0
    v_mov_b32 v52, 0
    v_mov_b32 v53, 0
    v_mov_b32 v54, 0
    v_mov_b32 v55, 0
    v_mov_b32 v56, 0
    v_mov_b32 v57, 0
    v_mov_b32 v58, 0
    v_mov_b32 v59, 0
    v_mov_b32 v60, 0
    v_mov_b32 v61, 0
    v_mov_b32 v62, 0
    v_mov_b32 v63, 0
    s_waitcnt vmcnt(28)
    s_barrier
    ds_read_b128 v[20:23], v2 offset:0
    ds_read_b128 v[24:27], v2 offset:14336
    ds_read_b128 v[32:35], v2 offset:1024
    ds_read_b128 v[36:39], v2 offset:15360
    s_waitcnt lgkmcnt(2)
    v_mfma_f32_16x16x32_bf16 v[48:51], v[20:23], a[0:3], v[48:51]
    v_mfma_f32_16x16x32_bf16 v[52:55], v[20:23], a[56:59], v[52:55]
    v_mfma_f32_16x16x32_bf16 v[60:63], v[24:27], a[56:59], v[60:63]
    ds_read_b128 v[20:23], v2 offset:2048
    ds_read_b128 v[24:27], v2 offset:16384
    s_waitcnt lgkmcnt(2)
    v_mfma_f32_16x16x32_bf16 v[48:51], v[32:35], a[4:7], v[48:51]
    v_mfma_f32_16x16x32_bf16 v[52:55], v[32:35], a[60:63], v[52:55]
    v_mfma_f32_16x16x32_bf16 v[60:63], v[36:39], a[60:63], v[60:63]
    ds_read_b128 v[32:35], v2 offset:3072
    ds_read_b128 v[36:39], v2 offset:17408
    s_waitcnt lgkmcnt(2)
    v_mfma_f32_16x16x32_bf16 v[48:51], v[20:23], a[8:11], v[48:51]
    v_mfma_f32_16x16x32_bf16 v[52:55], v[20:23], a[64:67], v[52:55]
    v_mfma_f32_16x16x32_bf16 v[60:63], v[24:27], a[64:67], v[60:63]
    ds_read_b128 v[20:23], v2 offset:4096
    ds_read_b128 v[24:27], v2 offset:18432
    s_waitcnt lgkmcnt(2)
    v_mfma_f32_16x16x32_bf16 v[48:51], v[32:35], a[12:15], v[48:51]
    v_mfma_f32_16x16x32_bf16 v[52:55], v[32:35], a[68:71], v[52:55]
    v_mfma_f32_16x16x32_bf16 v[60:63], v[36:39], a[68:71], v[60:63]
    ds_read_b128 v[32:35], v2 offset:5120
    ds_read_b128 v[36:39], v2 offset:19456
    s_waitcnt lgkmcnt(2)
    v_mfma_f32_16x16x32_bf16 v[48:51], v[20:23], a[16:19], v[48:51]
    v_mfma_f32_16x16x32_bf16 v[52:55], v[20:23], a[72:75], v[52:55]
    v_mfma_f32_16x16x32_bf16 v[60:63], v[24:27], a[72:75], v[60:63]
    ds_read_b128 v[20:23], v2 offset:6144
    ds_read_b128 v[24:27], v2 offset:20480
    s_waitcnt lgkmcnt(2)
    v_mfma_f32_16x16x32_bf16 v[48:51], v[32:35], a[20:23], v[48:51]
    v_mfma_f32_16x16x32_bf16 v[52:55], v[32:35], a[76:79], v[52:55]
    v_mfma_f32_16x16x32_bf16 v[60:63], v[36:39], a[76:79], v[60:63]
    ds_read_b128 v[32:35], v2 offset:7168
    ds_read_b128 v[36:39], v2 offset:21504
    s_waitcnt lgkmcnt(2)
    v_mfma_f32_16x16x32_bf16 v[48:51], v[20:23], a[24:27], v[48:51]
    v_mfma_f32_16x16x32_bf16 v[52:55], v[20:23], a[80:83], v[52:55]
    v_mfma_f32_16x16x32_bf16 v[60:63], v[24:27], a[80:83], v[60:63]
    ds_read_b128 v[20:23], v2 offset:8192
    ds_read_b128 v[24:27], v2 offset:22528
    s_waitcnt lgkmcnt(2)
    v_mfma_f32_16x16x32_bf16 v[48:51], v[32:35], a[28:31], v[48:51]
    v_mfma_f32_16x16x32_bf16 v[52:55], v[32:35], a[84:87], v[52:55]
    v_mfma_f32_16x16x32_bf16 v[60:63], v[36:39], a[84:87], v[60:63]
    ds_read_b128 v[32:35], v2 offset:9216
    ds_read_b128 v[36:39], v2 offset:23552
    s_waitcnt lgkmcnt(2)
    v_mfma_f32_16x16x32_bf16 v[48:51], v[20:23], a[32:35], v[48:51]
    v_mfma_f32_16x16x32_bf16 v[52:55], v[20:23], a[88:91], v[52:55]
    v_mfma_f32_16x16x32_bf16 v[60:63], v[24:27], a[88:91], v[60:63]
    ds_read_b128 v[20:23], v2 offset:10240
    ds_read_b128 v[24:27], v2 offset:24576
    s_waitcnt lgkmcnt(2)
    v_mfma_f32_16x16x32_bf16 v[48:51], v[32:35], a[36:39], v[48:51]
    v_mfma_f32_16x16x32_bf16 v[52:55], v[32:35], a[92:95], v[52:55]
    v_mfma_f32_16x16x32_bf16 v[60:63], v[36:39], a[92:95], v[60:63]
    ds_read_b128 v[32:35], v2 offset:11264
    ds_read_b128 v[36:39], v2 offset:25600
    s_waitcnt lgkmcnt(2)
    v_mfma_f32_16x16x32_bf16 v[48:51], v[20:23], a[40:43], v[48:51]
    v_mfma_f32_16x16x32_bf16 v[52:55], v[20:23], a[96:99], v[52:55]
    v_mfma_f32_16x16x32_bf16 v[60:63], v[24:27], a[96:99], v[60:63]
    ds_read_b128 v[20:23], v2 offset:12288
    ds_read_b128 v[24:27], v2 offset:26624
    s_waitcnt lgkmcnt(2)
    v_mfma_f32_16x16x32_bf16 v[48:51], v[32:35], a[44:47], v[48:51]
    v_mfma_f32_16x16x32_bf16 v[52:55], v[32:35], a[100:103], v[52:55]
    v_mfma_f32_16x16x32_bf16 v[60:63], v[36:39], a[100:103], v[60:63]
    ds_read_b128 v[32:35], v2 offset:13312
    ds_read_b128 v[36:39], v2 offset:27648
    s_waitcnt lgkmcnt(2)
    v_mfma_f32_16x16x32_bf16 v[48:51], v[20:23], a[48:51], v[48:51]
    v_mfma_f32_16x16x32_bf16 v[52:55], v[20:23], a[104:107], v[52:55]
    v_mfma_f32_16x16x32_bf16 v[60:63], v[24:27], a[104:107], v[60:63]
    s_waitcnt lgkmcnt(0)
    v_mfma_f32_16x16x32_bf16 v[48:51], v[32:35], a[52:55], v[48:51]
    v_mfma_f32_16x16x32_bf16 v[52:55], v[32:35], a[108:111], v[52:55]
    v_mfma_f32_16x16x32_bf16 v[60:63], v[36:39], a[108:111], v[60:63]
    s_add_u32 s87, s88, 112257024
    s_cmp_lg_u32 s18, 0
    s_nop 5
    s_cbranch_scc1 ATX_W
    v_mov_b32 v189, 0
    s_nop 1
ATX_P:
    buffer_load_dword v188, v189, s[8:11], s87 offen sc1
    s_waitcnt vmcnt(0)
    v_readfirstlane_b32 s86, v188
    s_nop 0
    s_cmp_ge_u32 s86, 14
    s_nop 2
    s_cbranch_scc1 ATX_W
    s_sleep 1
    s_sub_u32 s84, s84, 1
    s_cbranch_scc0 ATX_P
    s_mov_b32 s84, 0
ATX_W:
    s_barrier
    s_lshl_b32 s21, s20, 13
    s_lshl_b32 s22, s18, 11
    s_add_u32 s21, s21, s22
    s_add_u32 s21, s21, 111149056
    s_add_u32 m0, s22, 28672
    s_nop 0
    buffer_load_dwordx4 v2, s[8:11], s21 offen sc1 lds
    buffer_load_dwordx4 v2, s[8:11], s21 offen offset:1024 sc1 lds
    s_waitcnt vmcnt(0)
    s_barrier
    ds_read_b64 v[16:17], v5 offset:0
    ds_read_b64 v[18:19], v5 offset:256
    ds_read_b64 v[28:29], v5 offset:512
    ds_read_b64 v[30:31], v5 offset:768
    s_waitcnt lgkmcnt(2)
    v_mfma_f32_16x16x32_bf16 v[40:43], v[16:19], a[0:3], v[40:43]
    v_mfma_f32_16x16x32_bf16 v[44:47], v[16:19], a[56:59], v[44:47]
    ds_read_b64 v[16:17], v5 offset:1024
    ds_read_b64 v[18:19], v5 offset:1280
    s_waitcnt lgkmcnt(2)
    v_mfma_f32_16x16x32_bf16 v[40:43], v[28:31], a[4:7], v[40:43]
    v_mfma_f32_16x16x32_bf16 v[44:47], v[28:31], a[60:63], v[44:47]
    ds_read_b64 v[28:29], v5 offset:1536
    ds_read_b64 v[30:31], v5 offset:1792
    s_waitcnt lgkmcnt(2)
    v_mfma_f32_16x16x32_bf16 v[40:43], v[16:19], a[8:11], v[40:43]
    v_mfma_f32_16x16x32_bf16 v[44:47], v[16:19], a[64:67], v[44:47]
    ds_read_b64 v[16:17], v5 offset:2048
    ds_read_b64 v[18:19], v5 offset:2304
    s_waitcnt lgkmcnt(2)
    v_mfma_f32_16x16x32_bf16 v[40:43], v[28:31], a[12:15], v[40:43]
    v_mfma_f32_16x16x32_bf16 v[44:47], v[28:31], a[68:71], v[44:47]
    ds_read_b64 v[28:29], v5 offset:2560
    ds_read_b64 v[30:31], v5 offset:2816
    s_waitcnt lgkmcnt(2)
    v_mfma_f32_16x16x32_bf16 v[40:43], v[16:19], a[16:19], v[40:43]
    v_mfma_f32_16x16x32_bf16 v[44:47], v[16:19], a[72:75], v[44:47]
    ds_read_b64 v[16:17], v5 offset:3072
    ds_read_b64 v[18:19], v5 offset:3328
    s_waitcnt lgkmcnt(2)
    v_mfma_f32_16x16x32_bf16 v[40:43], v[28:31], a[20:23], v[40:43]
    v_mfma_f32_16x16x32_bf16 v[44:47], v[28:31], a[76:79], v[44:47]
    ds_read_b64 v[28:29], v5 offset:3584
    ds_read_b64 v[30:31], v5 offset:3840
    s_waitcnt lgkmcnt(2)
    v_mfma_f32_16x16x32_bf16 v[40:43], v[16:19], a[24:27], v[40:43]
    v_mfma_f32_16x16x32_bf16 v[44:47], v[16:19], a[80:83], v[44:47]
    ds_read_b64 v[16:17], v5 offset:4096
    ds_read_b64 v[18:19], v5 offset:4352
    s_waitcnt lgkmcnt(2)
    v_mfma_f32_16x16x32_bf16 v[40:43], v[28:31], a[28:31], v[40:43]
    v_mfma_f32_16x16x32_bf16 v[44:47], v[28:31], a[84:87], v[44:47]
    ds_read_b64 v[28:29], v5 offset:4608
    ds_read_b64 v[30:31], v5 offset:4864
    s_waitcnt lgkmcnt(2)
    v_mfma_f32_16x16x32_bf16 v[40:43], v[16:19], a[32:35], v[40:43]
    v_mfma_f32_16x16x32_bf16 v[44:47], v[16:19], a[88:91], v[44:47]
    ds_read_b64 v[16:17], v5 offset:5120
    ds_read_b64 v[18:19], v5 offset:5376
    s_waitcnt lgkmcnt(2)
    v_mfma_f32_16x16x32_bf16 v[40:43], v[28:31], a[36:39], v[40:43]
    v_mfma_f32_16x16x32_bf16 v[44:47], v[28:31], a[92:95], v[44:47]
    ds_read_b64 v[28:29], v5 offset:5632
    ds_read_b64 v[30:31], v5 offset:5888
    s_waitcnt lgkmcnt(2)
    v_mfma_f32_16x16x32_bf16 v[40:43], v[16:19], a[40:43], v[40:43]
    v_mfma_f32_16x16x32_bf16 v[44:47], v[16:19], a[96:99], v[44:47]
    ds_read_b64 v[16:17], v5 offset:6144
    ds_read_b64 v[18:19], v5 offset:6400
    s_waitcnt lgkmcnt(2)
    v_mfma_f32_16x16x32_bf16 v[40:43], v[28:31], a[44:47], v[40:43]
    v_mfma_f32_16x16x32_bf16 v[44:47], v[28:31], a[100:103], v[44:47]
    ds_read_b64 v[28:29], v5 offset:6656
    ds_read_b64 v[30:31], v5 offset:6912
    s_waitcnt lgkmcnt(2)
    v_mfma_f32_16x16x32_bf16 v[40:43], v[16:19], a[48:51], v[40:43]
    v_mfma_f32_16x16x32_bf16 v[44:47], v[16:19], a[104:107], v[44:47]
    s_waitcnt lgkmcnt(0)
    v_mfma_f32_16x16x32_bf16 v[40:43], v[28:31], a[52:55], v[40:43]
    v_mfma_f32_16x16x32_bf16 v[44:47], v[28:31], a[108:111], v[44:47]
    v_mov_b32 v218, 0xff800000
    v_cndmask_b32 v48, v218, v48, s[40:41]
    v_cndmask_b32 v49, v218, v49, s[42:43]
    v_cndmask_b32 v50, v218, v50, s[44:45]
    v_cndmask_b32 v51, v218, v51, s[46:47]
    s_nop 1
    v_max3_f32 v188, v40, v41, v42
    v_max3_f32 v188, v188, v43, v48
    v_max3_f32 v188, v188, v49, v50
    v_max_f32 v188, v188, v51
    v_mov_b32 v189, v188
    s_nop 1
    v_permlane16_swap_b32 v188, v189
    v_max_f32 v188, v188, v189
    v_mov_b32 v189, v188
    s_nop 1
    v_permlane32_swap_b32 v188, v189
    v_max_f32 v188, v188, v189
    v_sub_f32 v40, v40, v188
    v_sub_f32 v41, v41, v188
    v_sub_f32 v42, v42, v188
    v_sub_f32 v43, v43, v188
    v_sub_f32 v48, v48, v188
    v_sub_f32 v49, v49, v188
    v_sub_f32 v50, v50, v188
    v_sub_f32 v51, v51, v188
    v_exp_f32 v40, v40
    v_exp_f32 v41, v41
    v_exp_f32 v42, v42
    v_exp_f32 v43, v43
    v_exp_f32 v48, v48
    v_exp_f32 v49, v49
    v_exp_f32 v50, v50
    v_exp_f32 v51, v51
    v_add_f32 v190, v40, v41
    v_add_f32 v190, v190, v42
    v_add_f32 v190, v190, v43
    v_mul_f32 v190, 0.5, v190
    v_add_f32 v190, v190, v48
    v_add_f32 v190, v190, v49
    v_add_f32 v190, v190, v50
    v_add_f32 v190, v190, v51
    v_mov_b32 v189, v190
    s_nop 1
    v_permlane16_swap_b32 v190, v189
    v_add_f32 v190, v190, v189
    v_mov_b32 v189, v190
    s_nop 1
    v_permlane32_swap_b32 v190, v189
    v_add_f32 v190, v190, v189
    v_rcp_f32 v190, v190
    s_nop 0
    v_mul_f32 v40, v40, v190
    v_mul_f32 v41, v41, v190
    v_mul_f32 v42, v42, v190
    v_mul_f32 v43, v43, v190
    v_mul_f32 v48, v48, v190
    v_mul_f32 v49, v49, v190
    v_mul_f32 v50, v50, v190
    v_mul_f32 v51, v51, v190
    v_cvt_pk_bf16_f32 v196, v48, v49
    v_cvt_pk_bf16_f32 v197, v50, v51
    v_mov_b32 v198, 0
    v_mov_b32 v199, 0
    v_cvt_pk_bf16_f32 v200, v40, v41
    v_cvt_pk_bf16_f32 v201, v42, v43
    ds_write_b128 v6, v[196:199] offset:0
    ds_write_b64 v7, v[200:201] offset:0
    v_cndmask_b32 v60, v218, v60, s[40:41]
    v_cndmask_b32 v61, v218, v61, s[42:43]
    v_cndmask_b32 v62, v218, v62, s[44:45]
    v_cndmask_b32 v63, v218, v63, s[46:47]
    v_max3_f32 v192, v44, v45, v46
    v_max3_f32 v192, v192, v47, v52
    v_max3_f32 v192, v192, v53, v54
    v_max3_f32 v192, v192, v55, v60
    v_max3_f32 v192, v192, v61, v62
    v_max_f32 v192, v192, v63
    v_mov_b32 v193, v192
    s_nop 1
    v_permlane16_swap_b32 v192, v193
    v_max_f32 v192, v192, v193
    v_mov_b32 v193, v192
    s_nop 1
    v_permlane32_swap_b32 v192, v193
    v_max_f32 v192, v192, v193
    v_sub_f32 v44, v44, v192
    v_sub_f32 v45, v45, v192
    v_sub_f32 v46, v46, v192
    v_sub_f32 v47, v47, v192
    v_sub_f32 v52, v52, v192
    v_sub_f32 v53, v53, v192
    v_sub_f32 v54, v54, v192
    v_sub_f32 v55, v55, v192
    v_sub_f32 v60, v60, v192
    v_sub_f32 v61, v61, v192
    v_sub_f32 v62, v62, v192
    v_sub_f32 v63, v63, v192
    v_exp_f32 v44, v44
    v_exp_f32 v45, v45
    v_exp_f32 v46, v46
    v_exp_f32 v47, v47
    v_exp_f32 v52, v52
    v_exp_f32 v53, v53
    v_exp_f32 v54, v54
    v_exp_f32 v55, v55
    v_exp_f32 v60, v60
    v_exp_f32 v61, v61
    v_exp_f32 v62, v62
    v_exp_f32 v63, v63
    v_add_f32 v194, v44, v45
    v_add_f32 v194, v194, v46
    v_add_f32 v194, v194, v47
    v_mul_f32 v194, 0.5, v194
    v_add_f32 v194, v194, v52
    v_add_f32 v194, v194, v53
    v_add_f32 v194, v194, v54
    v_add_f32 v194, v194, v55
    v_add_f32 v194, v194, v60
    v_add_f32 v194, v194, v61
    v_add_f32 v194, v194, v62
    v_add_f32 v194, v194, v63
    v_mov_b32 v193, v194
    s_nop 1
    v_permlane16_swap_b32 v194, v193
    v_add_f32 v194, v194, v193
    v_mov_b32 v193, v194
    s_nop 1
    v_permlane32_swap_b32 v194, v193
    v_add_f32 v194, v194, v193
    v_rcp_f32 v194, v194
    s_nop 0
    v_mul_f32 v44, v44, v194
    v_mul_f32 v45, v45, v194
    v_mul_f32 v46, v46, v194
    v_mul_f32 v47, v47, v194
    v_mul_f32 v52, v52, v194
    v_mul_f32 v53, v53, v194
    v_mul_f32 v54, v54, v194
    v_mul_f32 v55, v55, v194
    v_mul_f32 v60, v60, v194
    v_mul_f32 v61, v61, v194
    v_mul_f32 v62, v62, v194
    v_mul_f32 v63, v63, v194
    v_cvt_pk_bf16_f32 v204, v52, v53
    v_cvt_pk_bf16_f32 v205, v54, v55
    v_cvt_pk_bf16_f32 v206, v60, v61
    v_cvt_pk_bf16_f32 v207, v62, v63
    v_cvt_pk_bf16_f32 v208, v44, v45
    v_cvt_pk_bf16_f32 v209, v46, v47
    ds_write_b128 v6, v[204:207] offset:1024
    ds_write_b64 v7, v[208:209] offset:512
    s_waitcnt lgkmcnt(0)
    s_barrier
    ds_read_b128 v[148:151], v2 offset:36864
    ds_read_b128 v[152:155], v2 offset:37888
    ds_read_b128 v[156:159], v2 offset:38912
    ds_read_b128 v[160:163], v2 offset:39936
    ds_read_b128 v[164:167], v2 offset:40960
    ds_read_b128 v[168:171], v2 offset:41984
    ds_read_b128 v[172:175], v2 offset:43008
    ds_read_b128 v[176:179], v2 offset:44032
    ds_read_b64 v[180:181], v8 offset:0
    ds_read_b64 v[182:183], v8 offset:2048
    ds_read_b64 v[184:185], v8 offset:512
    ds_read_b64 v[186:187], v8 offset:2560
    s_waitcnt lgkmcnt(0)
    v_mfma_f32_16x16x32_bf16 v[64:67], a[112:115], v[148:151], v[64:67]
    v_mfma_f32_16x16x32_bf16 v[68:71], a[112:115], v[152:155], v[68:71]
    v_mfma_f32_16x16x32_bf16 v[72:75], a[116:119], v[148:151], v[72:75]
    v_mfma_f32_16x16x32_bf16 v[76:79], a[116:119], v[152:155], v[76:79]
    v_mfma_f32_16x16x32_bf16 v[80:83], a[120:123], v[148:151], v[80:83]
    v_mfma_f32_16x16x32_bf16 v[84:87], a[120:123], v[152:155], v[84:87]
    v_mfma_f32_16x16x32_bf16 v[88:91], a[124:127], v[148:151], v[88:91]
    v_mfma_f32_16x16x32_bf16 v[92:95], a[124:127], v[152:155], v[92:95]
    v_mfma_f32_16x16x32_bf16 v[96:99], a[128:131], v[148:151], v[96:99]
    v_mfma_f32_16x16x32_bf16 v[100:103], a[128:131], v[152:155], v[100:103]
    v_mfma_f32_16x16x32_bf16 v[104:107], a[132:135], v[148:151], v[104:107]
    v_mfma_f32_16x16x32_bf16 v[108:111], a[132:135], v[152:155], v[108:111]
    v_mfma_f32_16x16x32_bf16 v[112:115], a[136:139], v[148:151], v[112:115]
    v_mfma_f32_16x16x32_bf16 v[116:119], a[136:139], v[152:155], v[116:119]
    v_mfma_f32_16x16x32_bf16 v[64:67], a[140:143], v[156:159], v[64:67]
    v_mfma_f32_16x16x32_bf16 v[68:71], a[140:143], v[160:163], v[68:71]
    v_mfma_f32_16x16x32_bf16 v[72:75], a[144:147], v[156:159], v[72:75]
    v_mfma_f32_16x16x32_bf16 v[76:79], a[144:147], v[160:163], v[76:79]
    v_mfma_f32_16x16x32_bf16 v[80:83], a[148:151], v[156:159], v[80:83]
    v_mfma_f32_16x16x32_bf16 v[84:87], a[148:151], v[160:163], v[84:87]
    v_mfma_f32_16x16x32_bf16 v[88:91], a[152:155], v[156:159], v[88:91]
    v_mfma_f32_16x16x32_bf16 v[92:95], a[152:155], v[160:163], v[92:95]
    v_mfma_f32_16x16x32_bf16 v[96:99], a[156:159], v[156:159], v[96:99]
    v_mfma_f32_16x16x32_bf16 v[100:103], a[156:159], v[160:163], v[100:103]
    v_mfma_f32_16x16x32_bf16 v[104:107], a[160:163], v[156:159], v[104:107]
    v_mfma_f32_16x16x32_bf16 v[108:111], a[160:163], v[160:163], v[108:111]
    v_mfma_f32_16x16x32_bf16 v[112:115], a[164:167], v[156:159], v[112:115]
    v_mfma_f32_16x16x32_bf16 v[116:119], a[164:167], v[160:163], v[116:119]
    v_mfma_f32_16x16x32_bf16 v[64:67], a[168:171], v[164:167], v[64:67]
    v_mfma_f32_16x16x32_bf16 v[68:71], a[168:171], v[168:171], v[68:71]
    v_mfma_f32_16x16x32_bf16 v[72:75], a[172:175], v[164:167], v[72:75]
    v_mfma_f32_16x16x32_bf16 v[76:79], a[172:175], v[168:171], v[76:79]
    v_mfma_f32_16x16x32_bf16 v[80:83], a[176:179], v[164:167], v[80:83]
    v_mfma_f32_16x16x32_bf16 v[84:87], a[176:179], v[168:171], v[84:87]
    v_mfma_f32_16x16x32_bf16 v[88:91], a[180:183], v[164:167], v[88:91]
    v_mfma_f32_16x16x32_bf16 v[92:95], a[180:183], v[168:171], v[92:95]
    v_mfma_f32_16x16x32_bf16 v[96:99], a[184:187], v[164:167], v[96:99]
    v_mfma_f32_16x16x32_bf16 v[100:103], a[184:187], v[168:171], v[100:103]
    v_mfma_f32_16x16x32_bf16 v[104:107], a[188:191], v[164:167], v[104:107]
    v_mfma_f32_16x16x32_bf16 v[108:111], a[188:191], v[168:171], v[108:111]
    v_mfma_f32_16x16x32_bf16 v[112:115], a[192:195], v[164:167], v[112:115]
    v_mfma_f32_16x16x32_bf16 v[116:119], a[192:195], v[168:171], v[116:119]
    v_mfma_f32_16x16x32_bf16 v[64:67], a[196:199], v[172:175], v[64:67]
    v_mfma_f32_16x16x32_bf16 v[68:71], a[196:199], v[176:179], v[68:71]
    v_mfma_f32_16x16x32_bf16 v[72:75], a[200:203], v[172:175], v[72:75]
    v_mfma_f32_16x16x32_bf16 v[76:79], a[200:203], v[176:179], v[76:79]
    v_mfma_f32_16x16x32_bf16 v[80:83], a[204:207], v[172:175], v[80:83]
    v_mfma_f32_16x16x32_bf16 v[84:87], a[204:207], v[176:179], v[84:87]
    v_mfma_f32_16x16x32_bf16 v[88:91], a[208:211], v[172:175], v[88:91]
    v_mfma_f32_16x16x32_bf16 v[92:95], a[208:211], v[176:179], v[92:95]
    v_mfma_f32_16x16x32_bf16 v[96:99], a[212:215], v[172:175], v[96:99]
    v_mfma_f32_16x16x32_bf16 v[100:103], a[212:215], v[176:179], v[100:103]
    v_mfma_f32_16x16x32_bf16 v[104:107], a[216:219], v[172:175], v[104:107]
    v_mfma_f32_16x16x32_bf16 v[108:111], a[216:219], v[176:179], v[108:111]
    v_mfma_f32_16x16x32_bf16 v[112:115], a[220:223], v[172:175], v[112:115]
    v_mfma_f32_16x16x32_bf16 v[116:119], a[220:223], v[176:179], v[116:119]
    s_add_u32 s87, s88, 112214016
    s_cmp_lg_u32 s18, 0
    s_nop 5
    s_cbranch_scc1 ATM_W
    v_mov_b32 v189, 0
    s_nop 1
ATM_P:
    buffer_load_dword v188, v189, s[8:11], s87 offen sc1
    s_waitcnt vmcnt(0)
    v_readfirstlane_b32 s86, v188
    s_nop 0
    s_cmp_ge_u32 s86, 14
    s_nop 2
    s_cbranch_scc1 ATM_W
    s_sleep 1
    s_sub_u32 s84, s84, 1
    s_cbranch_scc0 ATM_P
    s_mov_b32 s84, 0
ATM_W:
    s_barrier
    s_mul_i32 s29, s18, 7
    s_add_u32 s29, s29, 0
    s_lshr_b32 s30, s29, 1
    s_and_b32 s31, s29, 1
    s_lshl_b32 s32, s30, 3
    s_add_u32 s32, s32, s31
    s_lshl_b32 s33, s27, 1
    s_add_u32 s32, s32, s33
    s_lshl_b32 s32, s32, 10
    s_add_u32 s32, s32, s26
    buffer_load_dwordx4 v[120:123], v2, s[8:11], s32 offen sc1
    s_mul_i32 s29, s18, 7
    s_add_u32 s29, s29, 1
    s_lshr_b32 s30, s29, 1
    s_and_b32 s31, s29, 1
    s_lshl_b32 s32, s30, 3
    s_add_u32 s32, s32, s31
    s_lshl_b32 s33, s27, 1
    s_add_u32 s32, s32, s33
    s_lshl_b32 s32, s32, 10
    s_add_u32 s32, s32, s26
    buffer_load_dwordx4 v[124:127], v2, s[8:11], s32 offen sc1
    s_mul_i32 s29, s18, 7
    s_add_u32 s29, s29, 2
    s_lshr_b32 s30, s29, 1
    s_and_b32 s31, s29, 1
    s_lshl_b32 s32, s30, 3
    s_add_u32 s32, s32, s31
    s_lshl_b32 s33, s27, 1
    s_add_u32 s32, s32, s33
    s_lshl_b32 s32, s32, 10
    s_add_u32 s32, s32, s26
    buffer_load_dwordx4 v[128:131], v2, s[8:11], s32 offen sc1
    s_mul_i32 s29, s18, 7
    s_add_u32 s29, s29, 3
    s_lshr_b32 s30, s29, 1
    s_and_b32 s31, s29, 1
    s_lshl_b32 s32, s30, 3
    s_add_u32 s32, s32, s31
    s_lshl_b32 s33, s27, 1
    s_add_u32 s32, s32, s33
    s_lshl_b32 s32, s32, 10
    s_add_u32 s32, s32, s26
    buffer_load_dwordx4 v[132:135], v2, s[8:11], s32 offen sc1
    s_mul_i32 s29, s18, 7
    s_add_u32 s29, s29, 4
    s_lshr_b32 s30, s29, 1
    s_and_b32 s31, s29, 1
    s_lshl_b32 s32, s30, 3
    s_add_u32 s32, s32, s31
    s_lshl_b32 s33, s27, 1
    s_add_u32 s32, s32, s33
    s_lshl_b32 s32, s32, 10
    s_add_u32 s32, s32, s26
    buffer_load_dwordx4 v[136:139], v2, s[8:11], s32 offen sc1
    s_mul_i32 s29, s18, 7
    s_add_u32 s29, s29, 5
    s_lshr_b32 s30, s29, 1
    s_and_b32 s31, s29, 1
    s_lshl_b32 s32, s30, 3
    s_add_u32 s32, s32, s31
    s_lshl_b32 s33, s27, 1
    s_add_u32 s32, s32, s33
    s_lshl_b32 s32, s32, 10
    s_add_u32 s32, s32, s26
    buffer_load_dwordx4 v[140:143], v2, s[8:11], s32 offen sc1
    s_mul_i32 s29, s18, 7
    s_add_u32 s29, s29, 6
    s_lshr_b32 s30, s29, 1
    s_and_b32 s31, s29, 1
    s_lshl_b32 s32, s30, 3
    s_add_u32 s32, s32, s31
    s_lshl_b32 s33, s27, 1
    s_add_u32 s32, s32, s33
    s_lshl_b32 s32, s32, 10
    s_add_u32 s32, s32, s26
    buffer_load_dwordx4 v[144:147], v2, s[8:11], s32 offen sc1
    s_waitcnt vmcnt(0)
    v_mfma_f32_16x16x32_bf16 v[64:67], v[120:123], v[180:183], v[64:67]
    v_mfma_f32_16x16x32_bf16 v[68:71], v[120:123], v[184:187], v[68:71]
    v_mfma_f32_16x16x32_bf16 v[72:75], v[124:127], v[180:183], v[72:75]
    v_mfma_f32_16x16x32_bf16 v[76:79], v[124:127], v[184:187], v[76:79]
    v_mfma_f32_16x16x32_bf16 v[80:83], v[128:131], v[180:183], v[80:83]
    v_mfma_f32_16x16x32_bf16 v[84:87], v[128:131], v[184:187], v[84:87]
    v_mfma_f32_16x16x32_bf16 v[88:91], v[132:135], v[180:183], v[88:91]
    v_mfma_f32_16x16x32_bf16 v[92:95], v[132:135], v[184:187], v[92:95]
    v_mfma_f32_16x16x32_bf16 v[96:99], v[136:139], v[180:183], v[96:99]
    v_mfma_f32_16x16x32_bf16 v[100:103], v[136:139], v[184:187], v[100:103]
    v_mfma_f32_16x16x32_bf16 v[104:107], v[140:143], v[180:183], v[104:107]
    v_mfma_f32_16x16x32_bf16 v[108:111], v[140:143], v[184:187], v[108:111]
    v_mfma_f32_16x16x32_bf16 v[112:115], v[144:147], v[180:183], v[112:115]
    v_mfma_f32_16x16x32_bf16 v[116:119], v[144:147], v[184:187], v[116:119]
    v_mul_u32_u24 v9, 1808, v3
    v_lshl_add_u32 v9, v4, 4, v9
    s_mul_i32 s22, s18, 448
    s_add_u32 s22, s22, 49152
    v_add_u32 v9, s22, v9
    ds_write_b128 v9, v[64:67] offset:0
    ds_write_b128 v9, v[68:71] offset:28928
    ds_write_b128 v9, v[72:75] offset:64
    ds_write_b128 v9, v[76:79] offset:28992
    ds_write_b128 v9, v[80:83] offset:128
    ds_write_b128 v9, v[84:87] offset:29056
    ds_write_b128 v9, v[88:91] offset:192
    ds_write_b128 v9, v[92:95] offset:29120
    ds_write_b128 v9, v[96:99] offset:256
    ds_write_b128 v9, v[100:103] offset:29184
    ds_write_b128 v9, v[104:107] offset:320
    ds_write_b128 v9, v[108:111] offset:29248
    ds_write_b128 v9, v[112:115] offset:384
    ds_write_b128 v9, v[116:119] offset:29312
    s_waitcnt lgkmcnt(0)
    s_barrier
    v_lshlrev_b32 v9, 2, v1
    s_mul_i32 s22, s18, 14464
    s_add_u32 s22, s22, 49152
    v_add_u32 v10, s22, v9
    s_lshl_b32 s21, s20, 5
    s_lshl_b32 s23, s18, 3
    s_add_u32 s21, s21, s23
    s_mul_i32 s21, s21, 1792
    s_add_u32 s21, s21, 113246208
    ds_read_b32 v16, v10 offset:0
    ds_read_b32 v17, v10 offset:256
    ds_read_b32 v18, v10 offset:512
    ds_read_b32 v19, v10 offset:768
    ds_read_b32 v20, v10 offset:1024
    ds_read_b32 v21, v10 offset:1280
    ds_read_b32 v22, v10 offset:1536
    s_waitcnt lgkmcnt(6)
    buffer_atomic_add_f32 v16, v9, s[8:11], s21 offen offset:0
    s_waitcnt lgkmcnt(5)
    buffer_atomic_add_f32 v17, v9, s[8:11], s21 offen offset:256
    s_waitcnt lgkmcnt(4)
    buffer_atomic_add_f32 v18, v9, s[8:11], s21 offen offset:512
    s_waitcnt lgkmcnt(3)
    buffer_atomic_add_f32 v19, v9, s[8:11], s21 offen offset:768
    s_waitcnt lgkmcnt(2)
    buffer_atomic_add_f32 v20, v9, s[8:11], s21 offen offset:1024
    s_waitcnt lgkmcnt(1)
    buffer_atomic_add_f32 v21, v9, s[8:11], s21 offen offset:1280
    s_waitcnt lgkmcnt(0)
    buffer_atomic_add_f32 v22, v9, s[8:11], s21 offen offset:1536
    s_add_u32 s21, s21, 1792
    ds_read_b32 v24, v10 offset:1808
    ds_read_b32 v25, v10 offset:2064
    ds_read_b32 v26, v10 offset:2320
    ds_read_b32 v27, v10 offset:2576
    ds_read_b32 v28, v10 offset:2832
    ds_read_b32 v29, v10 offset:3088
    ds_read_b32 v30, v10 offset:3344
    s_waitcnt lgkmcnt(6)
    buffer_atomic_add_f32 v24, v9, s[8:11], s21 offen offset:0
    s_waitcnt lgkmcnt(5)
    buffer_atomic_add_f32 v25, v9, s[8:11], s21 offen offset:256
    s_waitcnt lgkmcnt(4)
    buffer_atomic_add_f32 v26, v9, s[8:11], s21 offen offset:512
    s_waitcnt lgkmcnt(3)
    buffer_atomic_add_f32 v27, v9, s[8:11], s21 offen offset:768
    s_waitcnt lgkmcnt(2)
    buffer_atomic_add_f32 v28, v9, s[8:11], s21 offen offset:1024
    s_waitcnt lgkmcnt(1)
    buffer_atomic_add_f32 v29, v9, s[8:11], s21 offen offset:1280
    s_waitcnt lgkmcnt(0)
    buffer_atomic_add_f32 v30, v9, s[8:11], s21 offen offset:1536
    s_add_u32 s21, s21, 1792
    ds_read_b32 v16, v10 offset:3616
    ds_read_b32 v17, v10 offset:3872
    ds_read_b32 v18, v10 offset:4128
    ds_read_b32 v19, v10 offset:4384
    ds_read_b32 v20, v10 offset:4640
    ds_read_b32 v21, v10 offset:4896
    ds_read_b32 v22, v10 offset:5152
    s_waitcnt lgkmcnt(6)
    buffer_atomic_add_f32 v16, v9, s[8:11], s21 offen offset:0
    s_waitcnt lgkmcnt(5)
    buffer_atomic_add_f32 v17, v9, s[8:11], s21 offen offset:256
    s_waitcnt lgkmcnt(4)
    buffer_atomic_add_f32 v18, v9, s[8:11], s21 offen offset:512
    s_waitcnt lgkmcnt(3)
    buffer_atomic_add_f32 v19, v9, s[8:11], s21 offen offset:768
    s_waitcnt lgkmcnt(2)
    buffer_atomic_add_f32 v20, v9, s[8:11], s21 offen offset:1024
    s_waitcnt lgkmcnt(1)
    buffer_atomic_add_f32 v21, v9, s[8:11], s21 offen offset:1280
    s_waitcnt lgkmcnt(0)
    buffer_atomic_add_f32 v22, v9, s[8:11], s21 offen offset:1536
    s_add_u32 s21, s21, 1792
    ds_read_b32 v24, v10 offset:5424
    ds_read_b32 v25, v10 offset:5680
    ds_read_b32 v26, v10 offset:5936
    ds_read_b32 v27, v10 offset:6192
    ds_read_b32 v28, v10 offset:6448
    ds_read_b32 v29, v10 offset:6704
    ds_read_b32 v30, v10 offset:6960
    s_waitcnt lgkmcnt(6)
    buffer_atomic_add_f32 v24, v9, s[8:11], s21 offen offset:0
    s_waitcnt lgkmcnt(5)
    buffer_atomic_add_f32 v25, v9, s[8:11], s21 offen offset:256
    s_waitcnt lgkmcnt(4)
    buffer_atomic_add_f32 v26, v9, s[8:11], s21 offen offset:512
    s_waitcnt lgkmcnt(3)
    buffer_atomic_add_f32 v27, v9, s[8:11], s21 offen offset:768
    s_waitcnt lgkmcnt(2)
    buffer_atomic_add_f32 v28, v9, s[8:11], s21 offen offset:1024
    s_waitcnt lgkmcnt(1)
    buffer_atomic_add_f32 v29, v9, s[8:11], s21 offen offset:1280
    s_waitcnt lgkmcnt(0)
    buffer_atomic_add_f32 v30, v9, s[8:11], s21 offen offset:1536
    s_add_u32 s21, s21, 1792
    ds_read_b32 v16, v10 offset:7232
    ds_read_b32 v17, v10 offset:7488
    ds_read_b32 v18, v10 offset:7744
    ds_read_b32 v19, v10 offset:8000
    ds_read_b32 v20, v10 offset:8256
    ds_read_b32 v21, v10 offset:8512
    ds_read_b32 v22, v10 offset:8768
    s_waitcnt lgkmcnt(6)
    buffer_atomic_add_f32 v16, v9, s[8:11], s21 offen offset:0
    s_waitcnt lgkmcnt(5)
    buffer_atomic_add_f32 v17, v9, s[8:11], s21 offen offset:256
    s_waitcnt lgkmcnt(4)
    buffer_atomic_add_f32 v18, v9, s[8:11], s21 offen offset:512
    s_waitcnt lgkmcnt(3)
    buffer_atomic_add_f32 v19, v9, s[8:11], s21 offen offset:768
    s_waitcnt lgkmcnt(2)
    buffer_atomic_add_f32 v20, v9, s[8:11], s21 offen offset:1024
    s_waitcnt lgkmcnt(1)
    buffer_atomic_add_f32 v21, v9, s[8:11], s21 offen offset:1280
    s_waitcnt lgkmcnt(0)
    buffer_atomic_add_f32 v22, v9, s[8:11], s21 offen offset:1536
    s_add_u32 s21, s21, 1792
    ds_read_b32 v24, v10 offset:9040
    ds_read_b32 v25, v10 offset:9296
    ds_read_b32 v26, v10 offset:9552
    ds_read_b32 v27, v10 offset:9808
    ds_read_b32 v28, v10 offset:10064
    ds_read_b32 v29, v10 offset:10320
    ds_read_b32 v30, v10 offset:10576
    s_waitcnt lgkmcnt(6)
    buffer_atomic_add_f32 v24, v9, s[8:11], s21 offen offset:0
    s_waitcnt lgkmcnt(5)
    buffer_atomic_add_f32 v25, v9, s[8:11], s21 offen offset:256
    s_waitcnt lgkmcnt(4)
    buffer_atomic_add_f32 v26, v9, s[8:11], s21 offen offset:512
    s_waitcnt lgkmcnt(3)
    buffer_atomic_add_f32 v27, v9, s[8:11], s21 offen offset:768
    s_waitcnt lgkmcnt(2)
    buffer_atomic_add_f32 v28, v9, s[8:11], s21 offen offset:1024
    s_waitcnt lgkmcnt(1)
    buffer_atomic_add_f32 v29, v9, s[8:11], s21 offen offset:1280
    s_waitcnt lgkmcnt(0)
    buffer_atomic_add_f32 v30, v9, s[8:11], s21 offen offset:1536
    s_add_u32 s21, s21, 1792
    ds_read_b32 v16, v10 offset:10848
    ds_read_b32 v17, v10 offset:11104
    ds_read_b32 v18, v10 offset:11360
    ds_read_b32 v19, v10 offset:11616
    ds_read_b32 v20, v10 offset:11872
    ds_read_b32 v21, v10 offset:12128
    ds_read_b32 v22, v10 offset:12384
    s_waitcnt lgkmcnt(6)
    buffer_atomic_add_f32 v16, v9, s[8:11], s21 offen offset:0
    s_waitcnt lgkmcnt(5)
    buffer_atomic_add_f32 v17, v9, s[8:11], s21 offen offset:256
    s_waitcnt lgkmcnt(4)
    buffer_atomic_add_f32 v18, v9, s[8:11], s21 offen offset:512
    s_waitcnt lgkmcnt(3)
    buffer_atomic_add_f32 v19, v9, s[8:11], s21 offen offset:768
    s_waitcnt lgkmcnt(2)
    buffer_atomic_add_f32 v20, v9, s[8:11], s21 offen offset:1024
    s_waitcnt lgkmcnt(1)
    buffer_atomic_add_f32 v21, v9, s[8:11], s21 offen offset:1280
    s_waitcnt lgkmcnt(0)
    buffer_atomic_add_f32 v22, v9, s[8:11], s21 offen offset:1536
    s_add_u32 s21, s21, 1792
    ds_read_b32 v24, v10 offset:12656
    ds_read_b32 v25, v10 offset:12912
    ds_read_b32 v26, v10 offset:13168
    ds_read_b32 v27, v10 offset:13424
    ds_read_b32 v28, v10 offset:13680
    ds_read_b32 v29, v10 offset:13936
    ds_read_b32 v30, v10 offset:14192
    s_waitcnt lgkmcnt(6)
    buffer_atomic_add_f32 v24, v9, s[8:11], s21 offen offset:0
    s_waitcnt lgkmcnt(5)
    buffer_atomic_add_f32 v25, v9, s[8:11], s21 offen offset:256
    s_waitcnt lgkmcnt(4)
    buffer_atomic_add_f32 v26, v9, s[8:11], s21 offen offset:512
    s_waitcnt lgkmcnt(3)
    buffer_atomic_add_f32 v27, v9, s[8:11], s21 offen offset:768
    s_waitcnt lgkmcnt(2)
    buffer_atomic_add_f32 v28, v9, s[8:11], s21 offen offset:1024
    s_waitcnt lgkmcnt(1)
    buffer_atomic_add_f32 v29, v9, s[8:11], s21 offen offset:1280
    s_waitcnt lgkmcnt(0)
    buffer_atomic_add_f32 v30, v9, s[8:11], s21 offen offset:1536
    s_add_u32 s21, s21, 1792
    s_add_u32 s87, s88, 112222208
    s_waitcnt vmcnt(0)
    s_barrier
    s_cmp_lg_u32 s18, 0
    s_cbranch_scc1 ATS_S
    v_mov_b32 v189, 0
    v_mov_b32 v188, 1
    s_mov_b64 exec, 1
    buffer_atomic_add v188, v189, s[8:11], s87 offen
    s_mov_b64 exec, -1
ATS_S:
    s_branch BK_NEXT
BK_PRE:
    s_cmp_lt_u32 s81, 32
    s_cbranch_scc1 BK_PZ
    s_cmp_lt_u32 s81, 60
    s_cbranch_scc1 BK_P1
    s_sub_u32 s85, s81, 60
    s_mov_b32 s20, s85
    s_load_dwordx2 s[16:17], s[0:1], 80
    s_waitcnt lgkmcnt(0)
    s_mov_b32 s12, s16
    s_and_b32 s13, s17, 0xffff
    s_mov_b32 s14, 1605632
    s_mov_b32 s15, 0x00020000
    v_lshlrev_b32 v2, 4, v1
    v_mov_b32 v3, 0x7ffffff0
    v_cmp_gt_u32 vcc, 56, v1
    s_nop 1
    v_cndmask_b32 v3, v3, v2, vcc
    s_lshl_b32 s21, s20, 6
    s_lshl_b32 s22, s18, 4
    s_add_u32 s21, s21, s22
    s_mul_i32 s21, s21, 896
    s_mul_i32 s22, s18, 14592
    v_add_u32 v4, s22, v2
    buffer_load_dwordx4 v[16:19], v3, s[12:15], s21 offen
    s_add_u32 s21, s21, 896
    buffer_load_dwordx4 v[20:23], v3, s[12:15], s21 offen
    s_add_u32 s21, s21, 896
    buffer_load_dwordx4 v[24:27], v3, s[12:15], s21 offen
    s_add_u32 s21, s21, 896
    buffer_load_dwordx4 v[28:31], v3, s[12:15], s21 offen
    s_add_u32 s21, s21, 896
    buffer_load_dwordx4 v[32:35], v3, s[12:15], s21 offen
    s_add_u32 s21, s21, 896
    buffer_load_dwordx4 v[36:39], v3, s[12:15], s21 offen
    s_add_u32 s21, s21, 896
    buffer_load_dwordx4 v[40:43], v3, s[12:15], s21 offen
    s_add_u32 s21, s21, 896
    buffer_load_dwordx4 v[44:47], v3, s[12:15], s21 offen
    s_add_u32 s21, s21, 896
    buffer_load_dwordx4 v[48:51], v3, s[12:15], s21 offen
    s_add_u32 s21, s21, 896
    buffer_load_dwordx4 v[52:55], v3, s[12:15], s21 offen
    s_add_u32 s21, s21, 896
    buffer_load_dwordx4 v[56:59], v3, s[12:15], s21 offen
    s_add_u32 s21, s21, 896
    buffer_load_dwordx4 v[60:63], v3, s[12:15], s21 offen
    s_add_u32 s21, s21, 896
    buffer_load_dwordx4 v[64:67], v3, s[12:15], s21 offen
    s_add_u32 s21, s21, 896
    buffer_load_dwordx4 v[68:71], v3, s[12:15], s21 offen
    s_add_u32 s21, s21, 896
    buffer_load_dwordx4 v[72:75], v3, s[12:15], s21 offen
    s_add_u32 s21, s21, 896
    buffer_load_dwordx4 v[76:79], v3, s[12:15], s21 offen
    s_add_u32 s21, s21, 896
    s_mov_b64 s[26:27], exec
    s_mov_b32 exec_hi, 0x00ffffff
    s_waitcnt vmcnt(15)
    ds_write_b128 v4, v[16:19] offset:0
    s_waitcnt vmcnt(14)
    ds_write_b128 v4, v[20:23] offset:912
    s_waitcnt vmcnt(13)
    ds_write_b128 v4, v[24:27] offset:1824
    s_waitcnt vmcnt(12)
    ds_write_b128 v4, v[28:31] offset:2736
    s_waitcnt vmcnt(11)
    ds_write_b128 v4, v[32:35] offset:3648
    s_waitcnt vmcnt(10)
    ds_write_b128 v4, v[36:39] offset:4560
    s_waitcnt vmcnt(9)
    ds_write_b128 v4, v[40:43] offset:5472
    s_waitcnt vmcnt(8)
    ds_write_b128 v4, v[44:47] offset:6384
    s_waitcnt vmcnt(7)
    ds_write_b128 v4, v[48:51] offset:7296
    s_waitcnt vmcnt(6)
    ds_write_b128 v4, v[52:55] offset:8208
    s_waitcnt vmcnt(5)
    ds_write_b128 v4, v[56:59] offset:9120
    s_waitcnt vmcnt(4)
    ds_write_b128 v4, v[60:63] offset:10032
    s_waitcnt vmcnt(3)
    ds_write_b128 v4, v[64:67] offset:10944
    s_waitcnt vmcnt(2)
    ds_write_b128 v4, v[68:71] offset:11856
    s_waitcnt vmcnt(1)
    ds_write_b128 v4, v[72:75] offset:12768
    s_waitcnt vmcnt(0)
    ds_write_b128 v4, v[76:79] offset:13680
    s_mov_b64 exec, s[26:27]
    s_waitcnt lgkmcnt(0)
    s_barrier
    v_and_b32 v5, 15, v1
    v_lshrrev_b32 v6, 4, v1
    v_lshrrev_b32 v7, 2, v5
    v_lshl_add_u32 v7, v6, 2, v7
    v_mul_u32_u24 v7, 912, v7
    v_and_b32 v8, 3, v1
    v_lshl_add_u32 v7, v8, 3, v7
    s_lshr_b32 s22, s18, 1
    s_and_b32 s24, s18, 1
    s_mul_i32 s25, s22, 29184
    s_mul_i32 s26, s24, 448
    s_add_u32 s25, s25, s26
    v_add_u32 v7, s25, v7
    s_lshl_b32 s23, s20, 1
    s_add_u32 s23, s23, s22
    s_lshl_b32 s23, s23, 10
    s_mul_i32 s26, s24, 802816
    s_add_u32 s23, s23, s26
    s_add_u32 s23, s23, 99614720
    ds_read_b64_tr_b16 v[16:17], v7 offset:0
    ds_read_b64_tr_b16 v[18:19], v7 offset:14592
    s_waitcnt lgkmcnt(0)
    buffer_store_dwordx4 v[16:19], v2, s[8:11], s23 offen sc1
    s_add_u32 s23, s23, 57344
    ds_read_b64_tr_b16 v[20:21], v7 offset:32
    ds_read_b64_tr_b16 v[22:23], v7 offset:14624
    s_waitcnt lgkmcnt(0)
    buffer_store_dwordx4 v[20:23], v2, s[8:11], s23 offen sc1
    s_add_u32 s23, s23, 57344
    ds_read_b64_tr_b16 v[24:25], v7 offset:64
    ds_read_b64_tr_b16 v[26:27], v7 offset:14656
    s_waitcnt lgkmcnt(0)
    buffer_store_dwordx4 v[24:27], v2, s[8:11], s23 offen sc1
    s_add_u32 s23, s23, 57344
    ds_read_b64_tr_b16 v[28:29], v7 offset:96
    ds_read_b64_tr_b16 v[30:31], v7 offset:14688
    s_waitcnt lgkmcnt(0)
    buffer_store_dwordx4 v[28:31], v2, s[8:11], s23 offen sc1
    s_add_u32 s23, s23, 57344
    ds_read_b64_tr_b16 v[16:17], v7 offset:128
    ds_read_b64_tr_b16 v[18:19], v7 offset:14720
    s_waitcnt lgkmcnt(0)
    buffer_store_dwordx4 v[16:19], v2, s[8:11], s23 offen sc1
    s_add_u32 s23, s23, 57344
    ds_read_b64_tr_b16 v[20:21], v7 offset:160
    ds_read_b64_tr_b16 v[22:23], v7 offset:14752
    s_waitcnt lgkmcnt(0)
    buffer_store_dwordx4 v[20:23], v2, s[8:11], s23 offen sc1
    s_add_u32 s23, s23, 57344
    ds_read_b64_tr_b16 v[24:25], v7 offset:192
    ds_read_b64_tr_b16 v[26:27], v7 offset:14784
    s_waitcnt lgkmcnt(0)
    buffer_store_dwordx4 v[24:27], v2, s[8:11], s23 offen sc1
    s_add_u32 s23, s23, 57344
    ds_read_b64_tr_b16 v[28:29], v7 offset:224
    ds_read_b64_tr_b16 v[30:31], v7 offset:14816
    s_waitcnt lgkmcnt(0)
    buffer_store_dwordx4 v[28:31], v2, s[8:11], s23 offen sc1
    s_add_u32 s23, s23, 57344
    ds_read_b64_tr_b16 v[16:17], v7 offset:256
    ds_read_b64_tr_b16 v[18:19], v7 offset:14848
    s_waitcnt lgkmcnt(0)
    buffer_store_dwordx4 v[16:19], v2, s[8:11], s23 offen sc1
    s_add_u32 s23, s23, 57344
    ds_read_b64_tr_b16 v[20:21], v7 offset:288
    ds_read_b64_tr_b16 v[22:23], v7 offset:14880
    s_waitcnt lgkmcnt(0)
    buffer_store_dwordx4 v[20:23], v2, s[8:11], s23 offen sc1
    s_add_u32 s23, s23, 57344
    ds_read_b64_tr_b16 v[24:25], v7 offset:320
    ds_read_b64_tr_b16 v[26:27], v7 offset:14912
    s_waitcnt lgkmcnt(0)
    buffer_store_dwordx4 v[24:27], v2, s[8:11], s23 offen sc1
    s_add_u32 s23, s23, 57344
    ds_read_b64_tr_b16 v[28:29], v7 offset:352
    ds_read_b64_tr_b16 v[30:31], v7 offset:14944
    s_waitcnt lgkmcnt(0)
    buffer_store_dwordx4 v[28:31], v2, s[8:11], s23 offen sc1
    s_add_u32 s23, s23, 57344
    ds_read_b64_tr_b16 v[16:17], v7 offset:384
    ds_read_b64_tr_b16 v[18:19], v7 offset:14976
    s_waitcnt lgkmcnt(0)
    buffer_store_dwordx4 v[16:19], v2, s[8:11], s23 offen sc1
    s_add_u32 s23, s23, 57344
    ds_read_b64_tr_b16 v[20:21], v7 offset:416
    ds_read_b64_tr_b16 v[22:23], v7 offset:15008
    s_waitcnt lgkmcnt(0)
    buffer_store_dwordx4 v[20:23], v2, s[8:11], s23 offen sc1
    s_add_u32 s23, s23, 57344
    s_nop 0
    s_mov_b32 s87, 112256768
    s_waitcnt vmcnt(0)
    s_barrier
    s_cmp_lg_u32 s18, 0
    s_cbranch_scc1 BKP2_S
    v_mov_b32 v10, 0
    v_mov_b32 v9, 1
    s_mov_b64 exec, 1
    buffer_atomic_add v9, v10, s[8:11], s87 offen
    s_mov_b64 exec, -1
BKP2_S:
    s_branch BK_NEXT
BK_P1:
    s_sub_u32 s85, s81, 32
    s_mov_b32 s20, s85
    v_lshl_add_u32 v0, s18, 6, v1
    s_load_dwordx2 s[16:17], s[0:1], 64
    s_waitcnt lgkmcnt(0)
    s_mov_b32 s12, s16
    s_and_b32 s13, s17, 0xffff
    s_mov_b32 s14, 1605632
    s_mov_b32 s15, 0x00020000
    v_lshrrev_b32 v5, 3, v0
    v_and_b32 v6, 7, v0
    v_mul_u32_u24 v7, 3584, v5
    v_lshl_add_u32 v7, v6, 4, v7
    v_mul_u32_u24 v8, 144, v5
    v_lshl_add_u32 v8, v6, 4, v8
    s_lshl_b32 s21, s20, 7
    buffer_load_dwordx4 v[16:19], v7, s[12:15], s21 offen
    s_add_u32 s21, s21, 114688
    buffer_load_dwordx4 v[20:23], v7, s[12:15], s21 offen
    s_add_u32 s21, s21, 114688
    buffer_load_dwordx4 v[24:27], v7, s[12:15], s21 offen
    s_add_u32 s21, s21, 114688
    buffer_load_dwordx4 v[28:31], v7, s[12:15], s21 offen
    s_add_u32 s21, s21, 114688
    buffer_load_dwordx4 v[32:35], v7, s[12:15], s21 offen
    s_add_u32 s21, s21, 114688
    buffer_load_dwordx4 v[36:39], v7, s[12:15], s21 offen
    s_add_u32 s21, s21, 114688
    buffer_load_dwordx4 v[40:43], v7, s[12:15], s21 offen
    s_add_u32 s21, s21, 114688
    buffer_load_dwordx4 v[44:47], v7, s[12:15], s21 offen
    s_add_u32 s21, s21, 114688
    buffer_load_dwordx4 v[48:51], v7, s[12:15], s21 offen
    s_add_u32 s21, s21, 114688
    buffer_load_dwordx4 v[52:55], v7, s[12:15], s21 offen
    s_add_u32 s21, s21, 114688
    buffer_load_dwordx4 v[56:59], v7, s[12:15], s21 offen
    s_add_u32 s21, s21, 114688
    buffer_load_dwordx4 v[60:63], v7, s[12:15], s21 offen
    s_add_u32 s21, s21, 114688
    buffer_load_dwordx4 v[64:67], v7, s[12:15], s21 offen
    s_add_u32 s21, s21, 114688
    buffer_load_dwordx4 v[68:71], v7, s[12:15], s21 offen
    s_add_u32 s21, s21, 114688
    s_waitcnt vmcnt(13)
    ds_write_b128 v8, v[16:19] offset:0
    s_waitcnt vmcnt(12)
    ds_write_b128 v8, v[20:23] offset:4608
    s_waitcnt vmcnt(11)
    ds_write_b128 v8, v[24:27] offset:9216
    s_waitcnt vmcnt(10)
    ds_write_b128 v8, v[28:31] offset:13824
    s_waitcnt vmcnt(9)
    ds_write_b128 v8, v[32:35] offset:18432
    s_waitcnt vmcnt(8)
    ds_write_b128 v8, v[36:39] offset:23040
    s_waitcnt vmcnt(7)
    ds_write_b128 v8, v[40:43] offset:27648
    s_waitcnt vmcnt(6)
    ds_write_b128 v8, v[44:47] offset:32256
    s_waitcnt vmcnt(5)
    ds_write_b128 v8, v[48:51] offset:36864
    s_waitcnt vmcnt(4)
    ds_write_b128 v8, v[52:55] offset:41472
    s_waitcnt vmcnt(3)
    ds_write_b128 v8, v[56:59] offset:46080
    s_waitcnt vmcnt(2)
    ds_write_b128 v8, v[60:63] offset:50688
    s_waitcnt vmcnt(1)
    ds_write_b128 v8, v[64:67] offset:55296
    s_waitcnt vmcnt(0)
    ds_write_b128 v8, v[68:71] offset:59904
    s_waitcnt lgkmcnt(0)
    s_barrier
    v_and_b32 v5, 15, v1
    v_lshrrev_b32 v6, 4, v1
    v_lshrrev_b32 v7, 2, v5
    v_lshl_add_u32 v7, v6, 2, v7
    v_mul_u32_u24 v7, 144, v7
    v_and_b32 v8, 3, v1
    v_lshl_add_u32 v7, v8, 3, v7
    s_lshl_b32 s21, s18, 5
    v_add_u32 v7, s21, v7
    v_lshlrev_b32 v2, 4, v1
    s_lshl_b32 s22, s20, 2
    s_add_u32 s22, s22, s18
    s_mul_i32 s22, s22, 14336
    s_add_u32 s22, s22, 97517568
    ds_read_b64_tr_b16 v[16:17], v7 offset:0
    ds_read_b64_tr_b16 v[18:19], v7 offset:2304
    s_waitcnt lgkmcnt(0)
    buffer_store_dwordx4 v[16:19], v2, s[8:11], s22 offen offset:0 sc1
    ds_read_b64_tr_b16 v[20:21], v7 offset:4608
    ds_read_b64_tr_b16 v[22:23], v7 offset:6912
    s_waitcnt lgkmcnt(0)
    buffer_store_dwordx4 v[20:23], v2, s[8:11], s22 offen offset:1024 sc1
    ds_read_b64_tr_b16 v[24:25], v7 offset:9216
    ds_read_b64_tr_b16 v[26:27], v7 offset:11520
    s_waitcnt lgkmcnt(0)
    buffer_store_dwordx4 v[24:27], v2, s[8:11], s22 offen offset:2048 sc1
    ds_read_b64_tr_b16 v[28:29], v7 offset:13824
    ds_read_b64_tr_b16 v[30:31], v7 offset:16128
    s_waitcnt lgkmcnt(0)
    buffer_store_dwordx4 v[28:31], v2, s[8:11], s22 offen offset:3072 sc1
    ds_read_b64_tr_b16 v[16:17], v7 offset:18432
    ds_read_b64_tr_b16 v[18:19], v7 offset:20736
    s_waitcnt lgkmcnt(0)
    s_add_u32 s22, s22, 4096
    buffer_store_dwordx4 v[16:19], v2, s[8:11], s22 offen offset:0 sc1
    ds_read_b64_tr_b16 v[20:21], v7 offset:23040
    ds_read_b64_tr_b16 v[22:23], v7 offset:25344
    s_waitcnt lgkmcnt(0)
    buffer_store_dwordx4 v[20:23], v2, s[8:11], s22 offen offset:1024 sc1
    ds_read_b64_tr_b16 v[24:25], v7 offset:27648
    ds_read_b64_tr_b16 v[26:27], v7 offset:29952
    s_waitcnt lgkmcnt(0)
    buffer_store_dwordx4 v[24:27], v2, s[8:11], s22 offen offset:2048 sc1
    ds_read_b64_tr_b16 v[28:29], v7 offset:32256
    ds_read_b64_tr_b16 v[30:31], v7 offset:34560
    s_waitcnt lgkmcnt(0)
    buffer_store_dwordx4 v[28:31], v2, s[8:11], s22 offen offset:3072 sc1
    ds_read_b64_tr_b16 v[16:17], v7 offset:36864
    ds_read_b64_tr_b16 v[18:19], v7 offset:39168
    s_waitcnt lgkmcnt(0)
    s_add_u32 s22, s22, 4096
    buffer_store_dwordx4 v[16:19], v2, s[8:11], s22 offen offset:0 sc1
    ds_read_b64_tr_b16 v[20:21], v7 offset:41472
    ds_read_b64_tr_b16 v[22:23], v7 offset:43776
    s_waitcnt lgkmcnt(0)
    buffer_store_dwordx4 v[20:23], v2, s[8:11], s22 offen offset:1024 sc1
    ds_read_b64_tr_b16 v[24:25], v7 offset:46080
    ds_read_b64_tr_b16 v[26:27], v7 offset:48384
    s_waitcnt lgkmcnt(0)
    buffer_store_dwordx4 v[24:27], v2, s[8:11], s22 offen offset:2048 sc1
    ds_read_b64_tr_b16 v[28:29], v7 offset:50688
    ds_read_b64_tr_b16 v[30:31], v7 offset:52992
    s_waitcnt lgkmcnt(0)
    buffer_store_dwordx4 v[28:31], v2, s[8:11], s22 offen offset:3072 sc1
    ds_read_b64_tr_b16 v[16:17], v7 offset:55296
    ds_read_b64_tr_b16 v[18:19], v7 offset:57600
    s_waitcnt lgkmcnt(0)
    s_add_u32 s22, s22, 4096
    buffer_store_dwordx4 v[16:19], v2, s[8:11], s22 offen offset:0 sc1
    ds_read_b64_tr_b16 v[20:21], v7 offset:59904
    ds_read_b64_tr_b16 v[22:23], v7 offset:62208
    s_waitcnt lgkmcnt(0)
    buffer_store_dwordx4 v[20:23], v2, s[8:11], s22 offen offset:1024 sc1
    s_nop 0
    s_mov_b32 s87, 112256640
    s_waitcnt vmcnt(0)
    s_barrier
    s_cmp_lg_u32 s18, 0
    s_cbranch_scc1 BKP1_S
    v_mov_b32 v10, 0
    v_mov_b32 v9, 1
    s_mov_b64 exec, 1
    buffer_atomic_add v9, v10, s[8:11], s87 offen
    s_mov_b64 exec, -1
BKP1_S:
    s_branch BK_NEXT
BK_PZ:
    v_lshl_add_u32 v2, s18, 6, v1
    v_lshlrev_b32 v2, 4, v2
    v_mov_b32 v24, 0
    v_mov_b32 v25, 0
    v_mov_b32 v26, 0
    v_mov_b32 v27, 0
    s_mul_i32 s21, s81, 114688
    s_add_u32 s21, s21, 113246208
    buffer_store_dwordx4 v[24:27], v2, s[8:11], s21 offen sc1
    s_add_u32 s21, s21, 4096
    buffer_store_dwordx4 v[24:27], v2, s[8:11], s21 offen sc1
    s_add_u32 s21, s21, 4096
    buffer_store_dwordx4 v[24:27], v2, s[8:11], s21 offen sc1
    s_add_u32 s21, s21, 4096
    buffer_store_dwordx4 v[24:27], v2, s[8:11], s21 offen sc1
    s_add_u32 s21, s21, 4096
    buffer_store_dwordx4 v[24:27], v2, s[8:11], s21 offen sc1
    s_add_u32 s21, s21, 4096
    buffer_store_dwordx4 v[24:27], v2, s[8:11], s21 offen sc1
    s_add_u32 s21, s21, 4096
    buffer_store_dwordx4 v[24:27], v2, s[8:11], s21 offen sc1
    s_add_u32 s21, s21, 4096
    buffer_store_dwordx4 v[24:27], v2, s[8:11], s21 offen sc1
    s_add_u32 s21, s21, 4096
    buffer_store_dwordx4 v[24:27], v2, s[8:11], s21 offen sc1
    s_add_u32 s21, s21, 4096
    buffer_store_dwordx4 v[24:27], v2, s[8:11], s21 offen sc1
    s_add_u32 s21, s21, 4096
    buffer_store_dwordx4 v[24:27], v2, s[8:11], s21 offen sc1
    s_add_u32 s21, s21, 4096
    buffer_store_dwordx4 v[24:27], v2, s[8:11], s21 offen sc1
    s_add_u32 s21, s21, 4096
    buffer_store_dwordx4 v[24:27], v2, s[8:11], s21 offen sc1
    s_add_u32 s21, s21, 4096
    buffer_store_dwordx4 v[24:27], v2, s[8:11], s21 offen sc1
    s_add_u32 s21, s21, 4096
    buffer_store_dwordx4 v[24:27], v2, s[8:11], s21 offen sc1
    s_add_u32 s21, s21, 4096
    buffer_store_dwordx4 v[24:27], v2, s[8:11], s21 offen sc1
    s_add_u32 s21, s21, 4096
    buffer_store_dwordx4 v[24:27], v2, s[8:11], s21 offen sc1
    s_add_u32 s21, s21, 4096
    buffer_store_dwordx4 v[24:27], v2, s[8:11], s21 offen sc1
    s_add_u32 s21, s21, 4096
    buffer_store_dwordx4 v[24:27], v2, s[8:11], s21 offen sc1
    s_add_u32 s21, s21, 4096
    buffer_store_dwordx4 v[24:27], v2, s[8:11], s21 offen sc1
    s_add_u32 s21, s21, 4096
    buffer_store_dwordx4 v[24:27], v2, s[8:11], s21 offen sc1
    s_add_u32 s21, s21, 4096
    buffer_store_dwordx4 v[24:27], v2, s[8:11], s21 offen sc1
    s_add_u32 s21, s21, 4096
    buffer_store_dwordx4 v[24:27], v2, s[8:11], s21 offen sc1
    s_add_u32 s21, s21, 4096
    buffer_store_dwordx4 v[24:27], v2, s[8:11], s21 offen sc1
    s_add_u32 s21, s21, 4096
    buffer_store_dwordx4 v[24:27], v2, s[8:11], s21 offen sc1
    s_add_u32 s21, s21, 4096
    buffer_store_dwordx4 v[24:27], v2, s[8:11], s21 offen sc1
    s_add_u32 s21, s21, 4096
    buffer_store_dwordx4 v[24:27], v2, s[8:11], s21 offen sc1
    s_add_u32 s21, s21, 4096
    buffer_store_dwordx4 v[24:27], v2, s[8:11], s21 offen sc1
    s_add_u32 s21, s21, 4096
    s_mov_b32 s87, 112256896
    s_waitcnt vmcnt(0)
    s_barrier
    s_cmp_lg_u32 s18, 0
    s_cbranch_scc1 BKPZ_S
    v_mov_b32 v10, 0
    v_mov_b32 v9, 1
    s_mov_b64 exec, 1
    buffer_atomic_add v9, v10, s[8:11], s87 offen
    s_mov_b64 exec, -1
BKPZ_S:
    s_branch BK_NEXT
BK_END:
    s_waitcnt vmcnt(0)
    s_endpgm
CH_EXIT:
    s_endpgm
.section .rodata,"a"
.p2align 6
.amdhsa_kernel prep_kernel
  .amdhsa_next_free_vgpr 256
  .amdhsa_next_free_sgpr 96
  .amdhsa_accum_offset 256
  .amdhsa_group_segment_fixed_size 0
  .amdhsa_kernarg_size 120
  .amdhsa_user_sgpr_count 2
  .amdhsa_user_sgpr_kernarg_segment_ptr 1
  .amdhsa_system_sgpr_workgroup_id_x 1
.end_amdhsa_kernel
.p2align 6
.amdhsa_kernel mega_kernel
  .amdhsa_next_free_vgpr 512
  .amdhsa_next_free_sgpr 96
  .amdhsa_accum_offset 256
  .amdhsa_group_segment_fixed_size 0
  .amdhsa_kernarg_size 120
  .amdhsa_user_sgpr_count 2
  .amdhsa_user_sgpr_kernarg_segment_ptr 1
  .amdhsa_system_sgpr_workgroup_id_x 1
.end_amdhsa_kernel
```
